```python
import torch

def _softmax(x, axis=-1):
    return torch.softmax(x, dim=axis)

def _gelu(x):
    return torch.nn.functional.gelu(x, approximate='tanh')

def _silu(x):
    return torch.nn.functional.silu(x)

def _sigmoid(x):
    return torch.sigmoid(x)

def _layernorm(x, axis=-1, eps=1e-05):
    m = x.mean(dim=axis, keepdim=True)
    v = x.var(dim=axis, keepdim=True, unbiased=False)
    return (x - m) / torch.sqrt(v + eps)

def _scatter_add(tgt, idx, src, axis=0):
    return tgt.clone().index_add_(axis, idx, src)

def _segment_sum(src, seg, n):
    out = torch.zeros((n,) + src.shape[1:], dtype=src.dtype)
    return out.index_add_(0, seg, src)

def _pad(x, pw):
    flat = tuple((v for pair in reversed(pw) for v in pair))
    return torch.nn.functional.pad(x, flat)
kernel_name = 'standalone__autoregressive_conv_wavenet__speech'

def setup_inputs():

    _w = lambda a: (lambda t: t.to(torch.bfloat16) if t.is_floating_point() else t)(torch.as_tensor(a))
    B, T, D, K = (2, 4000, 256, 31)
    return {'x': _w((lambda *s: torch.randn(*s, dtype=torch.bfloat16) * 0.1)(B, T, D)), 'w': _w((lambda *s: torch.randn(*s, dtype=torch.bfloat16) * 0.1)(K, D, 2 * D)), 'w_o': _w((lambda *s: torch.randn(*s, dtype=torch.bfloat16) * 0.05)(D, D))}

def reference(x, w, w_o):
    B, T, D = x.shape
    K = w.shape[0]
    dil = 2
    pad = (K - 1) * dil
    xp = _pad(x, ((0, 0), (pad, 0), (0, 0)))
    h = torch.einsum('btc,cd->btd', xp[:, pad:pad + T, :], w[0])
    for i in range(1, K):
        off = pad - i * dil
        h = h + torch.einsum('btc,cd->btd', xp[:, off:off + T, :], w[i])
    f = h[..., :D].clone()
    g = h[..., D:].clone()
    z = torch.tanh(f) * _sigmoid(g)
    return z @ w_o
```

```asm
; @launch grid=(256,1,1) block=(512,1,1) lds=163840
.amdgcn_target "amdgcn-amd-amdhsa--gfx950"
.text
.globl standalone__autoregressive_conv_wavenet__speech_kernel
.p2align 8
.type standalone__autoregressive_conv_wavenet__speech_kernel,@function
standalone__autoregressive_conv_wavenet__speech_kernel:
    s_cmp_ge_u32 s2, 256
    s_cbranch_scc1 L_end
    s_load_dwordx8 s[4:11], s[0:1], 0
    s_load_dwordx4 s[12:15], s[0:1], 32
    s_add_u32 s17, s2, 0
    s_and_b32 s17, s17, 7
    s_lshl_b32 s72, s17, 7
    s_mul_i32 s74, s17, 1081344
    s_sub_u32 s66, s2, 24
    s_cmp_lt_u32 s2, 24
    s_cselect_b32 s66, s2, s66
    s_cselect_b32 s63, 1, 0
    s_lshr_b32 s18, s66, 3
    s_lshl_b32 s66, s18, 3
    s_add_u32 s66, s66, s17
    s_mul_i32 s19, s18, 37
    s_lshr_b32 s19, s19, 8
    s_mul_i32 s20, s19, 7
    s_sub_u32 s20, s18, s20
    s_cmp_eq_u32 s18, 28
    s_cselect_b32 s21, 1, 0
    s_mul_i32 s73, s20, 95
    s_sub_u32 s73, s73, 1
    v_lshrrev_b32 v1, 6, v0
    s_nop 0
    v_readfirstlane_b32 s16, v1
    s_memrealtime s[64:65]
    s_cmp_eq_u32 s63, 1
    s_cbranch_scc1 L_service
    s_cmp_ge_u32 s16, 6
    s_cbranch_scc1 L_helper
    s_cmp_lt_u32 s16, 4
    s_cbranch_scc1 L_compute
    s_setprio 3
    s_sub_u32 s23, s16, 4
    s_lshl_b32 s71, s23, 10
    v_and_b32 v1, 63, v0
    v_lshrrev_b32 v2, 3, v1
    v_and_b32 v3, 7, v1
    v_lshrrev_b32 v4, 4, v1
    v_and_b32 v4, 1, v4
    s_lshl_b32 s52, s23, 1
    v_or_b32 v4, s52, v4
    v_lshlrev_b32 v4, 1, v4
    v_xor_b32 v4, v4, v3
    s_lshl_b32 s52, s23, 3
    v_add_u32 v5, s52, v2
    v_lshlrev_b32 v6, 7, v5
    v_lshl_add_u32 v21, v4, 4, v6
    v_lshlrev_b32 v5, 10, v5
    v_lshl_add_u32 v20, v4, 4, v5
    s_mul_i32 s58, s23, 5
    v_mul_u32_u24 v36, 43, v1
    v_lshrrev_b32 v36, 9, v36
    v_mul_u32_u24 v37, 12, v36
    v_sub_u32 v37, v1, v37
    s_mul_i32 s52, s18, 12
    v_add_u32 v37, s52, v37
    s_movk_i32 s52, 320
    v_cmp_gt_u32 s[56:57], s52, v37
    v_lshrrev_b32 v38, 5, v37
    v_and_b32 v37, 31, v37
    v_mul_u32_u24 v38, 3, v38
    v_add_u32 v39, s58, v36
    v_lshrrev_b32 v43, 3, v39
    v_sub_u32 v44, v38, v43
    v_add_u32 v44, 2, v44
    v_and_b32 v45, 7, v39
    v_lshl_add_u32 v45, v45, 5, v37
    v_lshlrev_b32 v45, 10, v45
    v_lshl_add_u32 v45, v44, 18, v45
    v_add_u32 v45, s72, v45
    v_cmp_gt_u32 vcc, 16, v39
    s_and_b64 vcc, vcc, s[56:57]
    v_cmp_gt_u32 s[56:57], 60, v1
    s_and_b64 vcc, vcc, s[56:57]
    v_mov_b32 v46, 0x40000000
    s_nop 1
    v_cndmask_b32 v22, v46, v45, vcc
    s_waitcnt lgkmcnt(0)
    s_mov_b32 s28, s6
    s_mov_b32 s29, s7
    s_mov_b32 s30, 8126464
    s_mov_b32 s31, 0x20000
    buffer_load_dword v18, v22, s[28:31], 0 offen
    s_cmp_eq_u32 s21, 1
    s_cbranch_scc1 L_xs_1
    s_lshl_b32 s52, s23, 3
    s_add_u32 s52, s52, 0
    v_add_u32 v5, s52, v2
    v_mul_u32_u24 v6, 57, v5
    v_lshrrev_b32 v6, 10, v6
    v_mul_u32_u24 v7, 18, v6
    v_sub_u32 v7, v5, v7
    v_and_b32 v8, 6, v7
    v_xor_b32 v8, v8, v3
    v_lshlrev_b32 v56, 4, v8
    v_mul_u32_u24 v9, 6, v7
    v_add_u32 v9, v9, v6
    v_subrev_u32 v48, 12, v9
    s_lshl_b32 s52, s23, 3
    s_add_u32 s52, s52, 16
    v_add_u32 v5, s52, v2
    v_mul_u32_u24 v6, 57, v5
    v_lshrrev_b32 v6, 10, v6
    v_mul_u32_u24 v7, 18, v6
    v_sub_u32 v7, v5, v7
    v_and_b32 v8, 6, v7
    v_xor_b32 v8, v8, v3
    v_lshlrev_b32 v57, 4, v8
    v_mul_u32_u24 v9, 6, v7
    v_add_u32 v9, v9, v6
    v_subrev_u32 v49, 12, v9
    s_lshl_b32 s52, s23, 3
    s_add_u32 s52, s52, 32
    v_add_u32 v5, s52, v2
    v_mul_u32_u24 v6, 57, v5
    v_lshrrev_b32 v6, 10, v6
    v_mul_u32_u24 v7, 18, v6
    v_sub_u32 v7, v5, v7
    v_and_b32 v8, 6, v7
    v_xor_b32 v8, v8, v3
    v_lshlrev_b32 v58, 4, v8
    v_mul_u32_u24 v9, 6, v7
    v_add_u32 v9, v9, v6
    v_subrev_u32 v50, 12, v9
    s_lshl_b32 s52, s23, 3
    s_add_u32 s52, s52, 48
    v_add_u32 v5, s52, v2
    v_mul_u32_u24 v6, 57, v5
    v_lshrrev_b32 v6, 10, v6
    v_mul_u32_u24 v7, 18, v6
    v_sub_u32 v7, v5, v7
    v_and_b32 v8, 6, v7
    v_xor_b32 v8, v8, v3
    v_lshlrev_b32 v59, 4, v8
    v_mul_u32_u24 v9, 6, v7
    v_add_u32 v9, v9, v6
    v_subrev_u32 v51, 12, v9
    s_lshl_b32 s52, s23, 3
    s_add_u32 s52, s52, 64
    v_add_u32 v5, s52, v2
    v_mul_u32_u24 v6, 57, v5
    v_lshrrev_b32 v6, 10, v6
    v_mul_u32_u24 v7, 18, v6
    v_sub_u32 v7, v5, v7
    v_and_b32 v8, 6, v7
    v_xor_b32 v8, v8, v3
    v_lshlrev_b32 v60, 4, v8
    v_mul_u32_u24 v9, 6, v7
    v_add_u32 v9, v9, v6
    v_subrev_u32 v52, 12, v9
    s_lshl_b32 s52, s23, 3
    s_add_u32 s52, s52, 80
    v_add_u32 v5, s52, v2
    v_mul_u32_u24 v6, 57, v5
    v_lshrrev_b32 v6, 10, v6
    v_mul_u32_u24 v7, 18, v6
    v_sub_u32 v7, v5, v7
    v_and_b32 v8, 6, v7
    v_xor_b32 v8, v8, v3
    v_lshlrev_b32 v61, 4, v8
    v_mul_u32_u24 v9, 6, v7
    v_add_u32 v9, v9, v6
    v_subrev_u32 v53, 12, v9
    s_lshl_b32 s52, s23, 3
    s_add_u32 s52, s52, 96
    v_add_u32 v5, s52, v2
    v_mul_u32_u24 v6, 57, v5
    v_lshrrev_b32 v6, 10, v6
    v_mul_u32_u24 v7, 18, v6
    v_sub_u32 v7, v5, v7
    v_and_b32 v8, 6, v7
    v_xor_b32 v8, v8, v3
    v_lshlrev_b32 v62, 4, v8
    v_mul_u32_u24 v9, 6, v7
    v_add_u32 v9, v9, v6
    v_subrev_u32 v54, 12, v9
    v_cmp_gt_u32 vcc, 6, v6
    v_mov_b32 v10, 1000
    s_nop 0
    v_cndmask_b32 v54, v10, v54, vcc
    s_sub_u32 s52, 1, s73
    s_max_i32 s52, s52, -9
    s_sub_u32 s53, 667, s73
    s_min_i32 s53, s53, 95
    s_sub_u32 s53, s53, s52
    s_sub_u32 s54, s73, 1
    s_mul_i32 s54, s54, 6
    s_and_b32 s55, s19, 1
    s_add_u32 s54, s54, s55
    s_lshr_b32 s55, s19, 1
    s_mul_i32 s55, s55, 4000
    s_add_u32 s54, s54, s55
    s_lshl_b32 s54, s54, 9
    v_mov_b32 v12, 0x40000000
    v_subrev_u32 v10, s52, v48
    v_cmp_ge_u32 vcc, s53, v10
    v_mul_i32_i24 v11, 3072, v48
    v_add3_u32 v11, v11, s54, v56
    v_cndmask_b32 v24, v12, v11, vcc
    v_subrev_u32 v10, s52, v49
    v_cmp_ge_u32 vcc, s53, v10
    v_mul_i32_i24 v11, 3072, v49
    v_add3_u32 v11, v11, s54, v57
    v_cndmask_b32 v25, v12, v11, vcc
    v_subrev_u32 v10, s52, v50
    v_cmp_ge_u32 vcc, s53, v10
    v_mul_i32_i24 v11, 3072, v50
    v_add3_u32 v11, v11, s54, v58
    v_cndmask_b32 v26, v12, v11, vcc
    v_subrev_u32 v10, s52, v51
    v_cmp_ge_u32 vcc, s53, v10
    v_mul_i32_i24 v11, 3072, v51
    v_add3_u32 v11, v11, s54, v59
    v_cndmask_b32 v27, v12, v11, vcc
    v_subrev_u32 v10, s52, v52
    v_cmp_ge_u32 vcc, s53, v10
    v_mul_i32_i24 v11, 3072, v52
    v_add3_u32 v11, v11, s54, v60
    v_cndmask_b32 v28, v12, v11, vcc
    v_subrev_u32 v10, s52, v53
    v_cmp_ge_u32 vcc, s53, v10
    v_mul_i32_i24 v11, 3072, v53
    v_add3_u32 v11, v11, s54, v61
    v_cndmask_b32 v29, v12, v11, vcc
    v_subrev_u32 v10, s52, v54
    v_cmp_ge_u32 vcc, s53, v10
    v_mul_i32_i24 v11, 3072, v54
    v_add3_u32 v11, v11, s54, v62
    v_cndmask_b32 v30, v12, v11, vcc
    s_branch L_xe_2
L_xs_1:
    s_cmp_eq_u32 s21, 1
    s_cselect_b64 s[56:57], -1, 0
    s_lshl_b32 s52, s23, 3
    s_add_u32 s52, s52, 0
    v_add_u32 v5, s52, v2
    v_mul_u32_u24 v6, 57, v5
    v_lshrrev_b32 v6, 10, v6
    v_mul_u32_u24 v7, 18, v6
    v_sub_u32 v7, v5, v7
    v_and_b32 v8, 6, v7
    v_xor_b32 v8, v8, v3
    v_lshlrev_b32 v56, 4, v8
    v_mul_u32_u24 v9, 6, v7
    v_add_u32 v9, v9, v6
    v_subrev_u32 v48, 12, v9
    v_mul_u32_u24 v10, 43, v48
    v_lshrrev_b32 v10, 10, v10
    v_and_b32 v10, 3, v10
    v_mul_u32_u24 v11, 24, v10
    v_sub_u32 v11, v48, v11
    v_add_u32 v11, 653, v11
    v_add_u32 v12, s73, v48
    v_cndmask_b32 v64, v12, v11, s[56:57]
    v_mov_b32 v12, s19
    v_cndmask_b32 v72, v12, v10, s[56:57]
    s_lshl_b32 s52, s23, 3
    s_add_u32 s52, s52, 16
    v_add_u32 v5, s52, v2
    v_mul_u32_u24 v6, 57, v5
    v_lshrrev_b32 v6, 10, v6
    v_mul_u32_u24 v7, 18, v6
    v_sub_u32 v7, v5, v7
    v_and_b32 v8, 6, v7
    v_xor_b32 v8, v8, v3
    v_lshlrev_b32 v57, 4, v8
    v_mul_u32_u24 v9, 6, v7
    v_add_u32 v9, v9, v6
    v_subrev_u32 v49, 12, v9
    v_mul_u32_u24 v10, 43, v49
    v_lshrrev_b32 v10, 10, v10
    v_and_b32 v10, 3, v10
    v_mul_u32_u24 v11, 24, v10
    v_sub_u32 v11, v49, v11
    v_add_u32 v11, 653, v11
    v_add_u32 v12, s73, v49
    v_cndmask_b32 v65, v12, v11, s[56:57]
    v_mov_b32 v12, s19
    v_cndmask_b32 v73, v12, v10, s[56:57]
    s_lshl_b32 s52, s23, 3
    s_add_u32 s52, s52, 32
    v_add_u32 v5, s52, v2
    v_mul_u32_u24 v6, 57, v5
    v_lshrrev_b32 v6, 10, v6
    v_mul_u32_u24 v7, 18, v6
    v_sub_u32 v7, v5, v7
    v_and_b32 v8, 6, v7
    v_xor_b32 v8, v8, v3
    v_lshlrev_b32 v58, 4, v8
    v_mul_u32_u24 v9, 6, v7
    v_add_u32 v9, v9, v6
    v_subrev_u32 v50, 12, v9
    v_mul_u32_u24 v10, 43, v50
    v_lshrrev_b32 v10, 10, v10
    v_and_b32 v10, 3, v10
    v_mul_u32_u24 v11, 24, v10
    v_sub_u32 v11, v50, v11
    v_add_u32 v11, 653, v11
    v_add_u32 v12, s73, v50
    v_cndmask_b32 v66, v12, v11, s[56:57]
    v_mov_b32 v12, s19
    v_cndmask_b32 v74, v12, v10, s[56:57]
    s_lshl_b32 s52, s23, 3
    s_add_u32 s52, s52, 48
    v_add_u32 v5, s52, v2
    v_mul_u32_u24 v6, 57, v5
    v_lshrrev_b32 v6, 10, v6
    v_mul_u32_u24 v7, 18, v6
    v_sub_u32 v7, v5, v7
    v_and_b32 v8, 6, v7
    v_xor_b32 v8, v8, v3
    v_lshlrev_b32 v59, 4, v8
    v_mul_u32_u24 v9, 6, v7
    v_add_u32 v9, v9, v6
    v_subrev_u32 v51, 12, v9
    v_mul_u32_u24 v10, 43, v51
    v_lshrrev_b32 v10, 10, v10
    v_and_b32 v10, 3, v10
    v_mul_u32_u24 v11, 24, v10
    v_sub_u32 v11, v51, v11
    v_add_u32 v11, 653, v11
    v_add_u32 v12, s73, v51
    v_cndmask_b32 v67, v12, v11, s[56:57]
    v_mov_b32 v12, s19
    v_cndmask_b32 v75, v12, v10, s[56:57]
    s_lshl_b32 s52, s23, 3
    s_add_u32 s52, s52, 64
    v_add_u32 v5, s52, v2
    v_mul_u32_u24 v6, 57, v5
    v_lshrrev_b32 v6, 10, v6
    v_mul_u32_u24 v7, 18, v6
    v_sub_u32 v7, v5, v7
    v_and_b32 v8, 6, v7
    v_xor_b32 v8, v8, v3
    v_lshlrev_b32 v60, 4, v8
    v_mul_u32_u24 v9, 6, v7
    v_add_u32 v9, v9, v6
    v_subrev_u32 v52, 12, v9
    v_mul_u32_u24 v10, 43, v52
    v_lshrrev_b32 v10, 10, v10
    v_and_b32 v10, 3, v10
    v_mul_u32_u24 v11, 24, v10
    v_sub_u32 v11, v52, v11
    v_add_u32 v11, 653, v11
    v_add_u32 v12, s73, v52
    v_cndmask_b32 v68, v12, v11, s[56:57]
    v_mov_b32 v12, s19
    v_cndmask_b32 v76, v12, v10, s[56:57]
    s_lshl_b32 s52, s23, 3
    s_add_u32 s52, s52, 80
    v_add_u32 v5, s52, v2
    v_mul_u32_u24 v6, 57, v5
    v_lshrrev_b32 v6, 10, v6
    v_mul_u32_u24 v7, 18, v6
    v_sub_u32 v7, v5, v7
    v_and_b32 v8, 6, v7
    v_xor_b32 v8, v8, v3
    v_lshlrev_b32 v61, 4, v8
    v_mul_u32_u24 v9, 6, v7
    v_add_u32 v9, v9, v6
    v_subrev_u32 v53, 12, v9
    v_mul_u32_u24 v10, 43, v53
    v_lshrrev_b32 v10, 10, v10
    v_and_b32 v10, 3, v10
    v_mul_u32_u24 v11, 24, v10
    v_sub_u32 v11, v53, v11
    v_add_u32 v11, 653, v11
    v_add_u32 v12, s73, v53
    v_cndmask_b32 v69, v12, v11, s[56:57]
    v_mov_b32 v12, s19
    v_cndmask_b32 v77, v12, v10, s[56:57]
    s_lshl_b32 s52, s23, 3
    s_add_u32 s52, s52, 96
    v_add_u32 v5, s52, v2
    v_mul_u32_u24 v6, 57, v5
    v_lshrrev_b32 v6, 10, v6
    v_mul_u32_u24 v7, 18, v6
    v_sub_u32 v7, v5, v7
    v_and_b32 v8, 6, v7
    v_xor_b32 v8, v8, v3
    v_lshlrev_b32 v62, 4, v8
    v_mul_u32_u24 v9, 6, v7
    v_add_u32 v9, v9, v6
    v_subrev_u32 v54, 12, v9
    v_cmp_gt_u32 vcc, 6, v6
    v_mov_b32 v10, 1000
    s_nop 0
    v_cndmask_b32 v54, v10, v54, vcc
    v_mul_u32_u24 v10, 43, v54
    v_lshrrev_b32 v10, 10, v10
    v_and_b32 v10, 3, v10
    v_mul_u32_u24 v11, 24, v10
    v_sub_u32 v11, v54, v11
    v_add_u32 v11, 653, v11
    v_add_u32 v12, s73, v54
    v_cndmask_b32 v70, v12, v11, s[56:57]
    v_mov_b32 v12, s19
    v_cndmask_b32 v78, v12, v10, s[56:57]
    s_cmp_eq_u32 s21, 1
    s_cselect_b32 s52, 0, -9
    s_sub_u32 s53, 95, s52
    v_mov_b32 v12, 0x40000000
    v_subrev_u32 v10, s52, v48
    v_cmp_ge_u32 vcc, s53, v10
    v_subrev_u32 v10, 1, v64
    v_and_b32 v13, 1, v72
    v_mul_i32_i24 v11, 6, v10
    v_add_u32 v11, v11, v13
    s_movk_i32 s54, 4000
    v_cmp_gt_u32 s[56:57], s54, v11
    s_and_b64 vcc, vcc, s[56:57]
    v_lshrrev_b32 v13, 1, v72
    v_mul_u32_u24 v13, 4000, v13
    v_add_u32 v11, v11, v13
    v_lshl_add_u32 v11, v11, 9, v56
    s_nop 0
    v_cndmask_b32 v24, v12, v11, vcc
    v_subrev_u32 v10, s52, v49
    v_cmp_ge_u32 vcc, s53, v10
    v_subrev_u32 v10, 1, v65
    v_and_b32 v13, 1, v73
    v_mul_i32_i24 v11, 6, v10
    v_add_u32 v11, v11, v13
    s_movk_i32 s54, 4000
    v_cmp_gt_u32 s[56:57], s54, v11
    s_and_b64 vcc, vcc, s[56:57]
    v_lshrrev_b32 v13, 1, v73
    v_mul_u32_u24 v13, 4000, v13
    v_add_u32 v11, v11, v13
    v_lshl_add_u32 v11, v11, 9, v57
    s_nop 0
    v_cndmask_b32 v25, v12, v11, vcc
    v_subrev_u32 v10, s52, v50
    v_cmp_ge_u32 vcc, s53, v10
    v_subrev_u32 v10, 1, v66
    v_and_b32 v13, 1, v74
    v_mul_i32_i24 v11, 6, v10
    v_add_u32 v11, v11, v13
    s_movk_i32 s54, 4000
    v_cmp_gt_u32 s[56:57], s54, v11
    s_and_b64 vcc, vcc, s[56:57]
    v_lshrrev_b32 v13, 1, v74
    v_mul_u32_u24 v13, 4000, v13
    v_add_u32 v11, v11, v13
    v_lshl_add_u32 v11, v11, 9, v58
    s_nop 0
    v_cndmask_b32 v26, v12, v11, vcc
    v_subrev_u32 v10, s52, v51
    v_cmp_ge_u32 vcc, s53, v10
    v_subrev_u32 v10, 1, v67
    v_and_b32 v13, 1, v75
    v_mul_i32_i24 v11, 6, v10
    v_add_u32 v11, v11, v13
    s_movk_i32 s54, 4000
    v_cmp_gt_u32 s[56:57], s54, v11
    s_and_b64 vcc, vcc, s[56:57]
    v_lshrrev_b32 v13, 1, v75
    v_mul_u32_u24 v13, 4000, v13
    v_add_u32 v11, v11, v13
    v_lshl_add_u32 v11, v11, 9, v59
    s_nop 0
    v_cndmask_b32 v27, v12, v11, vcc
    v_subrev_u32 v10, s52, v52
    v_cmp_ge_u32 vcc, s53, v10
    v_subrev_u32 v10, 1, v68
    v_and_b32 v13, 1, v76
    v_mul_i32_i24 v11, 6, v10
    v_add_u32 v11, v11, v13
    s_movk_i32 s54, 4000
    v_cmp_gt_u32 s[56:57], s54, v11
    s_and_b64 vcc, vcc, s[56:57]
    v_lshrrev_b32 v13, 1, v76
    v_mul_u32_u24 v13, 4000, v13
    v_add_u32 v11, v11, v13
    v_lshl_add_u32 v11, v11, 9, v60
    s_nop 0
    v_cndmask_b32 v28, v12, v11, vcc
    v_subrev_u32 v10, s52, v53
    v_cmp_ge_u32 vcc, s53, v10
    v_subrev_u32 v10, 1, v69
    v_and_b32 v13, 1, v77
    v_mul_i32_i24 v11, 6, v10
    v_add_u32 v11, v11, v13
    s_movk_i32 s54, 4000
    v_cmp_gt_u32 s[56:57], s54, v11
    s_and_b64 vcc, vcc, s[56:57]
    v_lshrrev_b32 v13, 1, v77
    v_mul_u32_u24 v13, 4000, v13
    v_add_u32 v11, v11, v13
    v_lshl_add_u32 v11, v11, 9, v61
    s_nop 0
    v_cndmask_b32 v29, v12, v11, vcc
    v_subrev_u32 v10, s52, v54
    v_cmp_ge_u32 vcc, s53, v10
    v_subrev_u32 v10, 1, v70
    v_and_b32 v13, 1, v78
    v_mul_i32_i24 v11, 6, v10
    v_add_u32 v11, v11, v13
    s_movk_i32 s54, 4000
    v_cmp_gt_u32 s[56:57], s54, v11
    s_and_b64 vcc, vcc, s[56:57]
    v_lshrrev_b32 v13, 1, v78
    v_mul_u32_u24 v13, 4000, v13
    v_add_u32 v11, v11, v13
    v_lshl_add_u32 v11, v11, 9, v62
    s_nop 0
    v_cndmask_b32 v30, v12, v11, vcc
L_xe_2:
    s_waitcnt lgkmcnt(0)
    s_or_b32 s75, s64, 1
    s_mov_b32 s0, s14
    s_mov_b32 s1, s15
    s_mov_b32 s2, 25198592
    s_mov_b32 s3, 0x20000
    s_mov_b32 s24, s4
    s_mov_b32 s25, s5
    s_mov_b32 s26, 4096000
    s_mov_b32 s27, 0x20000
    s_mov_b32 s28, s6
    s_mov_b32 s29, s7
    s_mov_b32 s30, 8126464
    s_mov_b32 s31, 0x20000
    s_mov_b32 s32, s14
    s_mov_b32 s33, s15
    s_mov_b32 s34, 12779520
    s_mov_b32 s35, 0x20000
    s_mov_b32 s36, s14
    s_mov_b32 s37, s15
    s_mov_b32 s38, 1376256
    s_mov_b32 s39, 0x20000
    s_add_u32 s40, s14, 13631488
    s_addc_u32 s41, s15, 0
    s_mov_b32 s42, 8552448
    s_mov_b32 s43, 0x20000
    s_mov_b32 s44, s8
    s_mov_b32 s45, s9
    s_mov_b32 s46, 131072
    s_mov_b32 s47, 0x20000
    s_mov_b32 s48, s10
    s_mov_b32 s49, s11
    s_mov_b32 s50, 4096000
    s_mov_b32 s51, 0x20000
    s_movk_i32 s53, 0
    s_add_u32 m0, s71, 0
    s_nop 0
    buffer_load_dwordx4 v24, s[24:27], s53 offen lds
    s_add_u32 m0, s71, 2048
    s_nop 0
    buffer_load_dwordx4 v25, s[24:27], s53 offen lds
    s_add_u32 m0, s71, 4096
    s_nop 0
    buffer_load_dwordx4 v26, s[24:27], s53 offen lds
    s_add_u32 m0, s71, 6144
    s_nop 0
    buffer_load_dwordx4 v27, s[24:27], s53 offen lds
    s_add_u32 m0, s71, 8192
    s_nop 0
    buffer_load_dwordx4 v28, s[24:27], s53 offen lds
    s_add_u32 m0, s71, 10240
    s_nop 0
    buffer_load_dwordx4 v29, s[24:27], s53 offen lds
    s_add_u32 m0, s71, 12288
    s_nop 0
    buffer_load_dwordx4 v30, s[24:27], s53 offen lds
    s_waitcnt vmcnt(7)
    s_add_u32 m0, s71, 28672
    s_add_u32 s52, s72, 524288
    buffer_load_dwordx4 v20, s[28:31], s52 offen lds
    s_add_u32 s52, s72, 538624
    buffer_load_dwordx4 v20, s[28:31], s52 offen offset:2048 lds
    s_add_u32 m0, s71, 32768
    s_add_u32 s52, s72, 1310720
    buffer_load_dwordx4 v20, s[28:31], s52 offen lds
    s_add_u32 s52, s72, 1325056
    buffer_load_dwordx4 v20, s[28:31], s52 offen offset:2048 lds
    s_add_u32 m0, s71, 36864
    s_add_u32 s52, s72, 2097152
    buffer_load_dwordx4 v20, s[28:31], s52 offen lds
    s_add_u32 s52, s72, 2111488
    buffer_load_dwordx4 v20, s[28:31], s52 offen offset:2048 lds
    s_add_u32 m0, s71, 40960
    s_add_u32 s52, s72, 2883584
    buffer_load_dwordx4 v20, s[28:31], s52 offen lds
    s_add_u32 s52, s72, 2897920
    buffer_load_dwordx4 v20, s[28:31], s52 offen offset:2048 lds
    s_add_u32 m0, s71, 45056
    s_add_u32 s52, s72, 3670016
    buffer_load_dwordx4 v20, s[28:31], s52 offen lds
    s_add_u32 s52, s72, 3684352
    buffer_load_dwordx4 v20, s[28:31], s52 offen offset:2048 lds
    s_add_u32 m0, s71, 49152
    s_add_u32 s52, s72, 4456448
    buffer_load_dwordx4 v20, s[28:31], s52 offen lds
    s_add_u32 s52, s72, 4470784
    buffer_load_dwordx4 v20, s[28:31], s52 offen offset:2048 lds
    s_add_u32 m0, s71, 53248
    s_add_u32 s52, s72, 5242880
    buffer_load_dwordx4 v20, s[28:31], s52 offen lds
    s_add_u32 s52, s72, 5257216
    buffer_load_dwordx4 v20, s[28:31], s52 offen offset:2048 lds
    s_add_u32 m0, s71, 57344
    s_add_u32 s52, s72, 6029312
    buffer_load_dwordx4 v20, s[28:31], s52 offen lds
    s_add_u32 s52, s72, 6043648
    buffer_load_dwordx4 v20, s[28:31], s52 offen offset:2048 lds
    s_add_u32 m0, s71, 61440
    s_add_u32 s52, s72, 6815744
    buffer_load_dwordx4 v20, s[28:31], s52 offen lds
    s_add_u32 s52, s72, 6830080
    buffer_load_dwordx4 v20, s[28:31], s52 offen offset:2048 lds
    s_add_u32 m0, s71, 65536
    s_add_u32 s52, s72, 7602176
    buffer_load_dwordx4 v20, s[28:31], s52 offen lds
    s_add_u32 s52, s72, 7616512
    buffer_load_dwordx4 v20, s[28:31], s52 offen offset:2048 lds
    s_add_u32 m0, s71, 73728
    s_add_u32 s52, s72, 557056
    buffer_load_dwordx4 v20, s[28:31], s52 offen lds
    s_add_u32 s52, s72, 571392
    buffer_load_dwordx4 v20, s[28:31], s52 offen offset:2048 lds
    s_add_u32 m0, s71, 77824
    s_add_u32 s52, s72, 1343488
    buffer_load_dwordx4 v20, s[28:31], s52 offen lds
    s_add_u32 s52, s72, 1357824
    buffer_load_dwordx4 v20, s[28:31], s52 offen offset:2048 lds
    s_add_u32 m0, s71, 81920
    s_add_u32 s52, s72, 2129920
    buffer_load_dwordx4 v20, s[28:31], s52 offen lds
    s_add_u32 s52, s72, 2144256
    buffer_load_dwordx4 v20, s[28:31], s52 offen offset:2048 lds
    s_add_u32 m0, s71, 86016
    s_add_u32 s52, s72, 2916352
    buffer_load_dwordx4 v20, s[28:31], s52 offen lds
    s_add_u32 s52, s72, 2930688
    buffer_load_dwordx4 v20, s[28:31], s52 offen offset:2048 lds
    s_add_u32 m0, s71, 90112
    s_add_u32 s52, s72, 3702784
    buffer_load_dwordx4 v20, s[28:31], s52 offen lds
    s_add_u32 s52, s72, 3717120
    buffer_load_dwordx4 v20, s[28:31], s52 offen offset:2048 lds
    s_add_u32 m0, s71, 94208
    s_add_u32 s52, s72, 4489216
    buffer_load_dwordx4 v20, s[28:31], s52 offen lds
    s_add_u32 s52, s72, 4503552
    buffer_load_dwordx4 v20, s[28:31], s52 offen offset:2048 lds
    s_add_u32 m0, s71, 98304
    s_add_u32 s52, s72, 5275648
    buffer_load_dwordx4 v20, s[28:31], s52 offen lds
    s_add_u32 s52, s72, 5289984
    buffer_load_dwordx4 v20, s[28:31], s52 offen offset:2048 lds
    s_add_u32 m0, s71, 102400
    s_add_u32 s52, s72, 6062080
    buffer_load_dwordx4 v20, s[28:31], s52 offen lds
    s_add_u32 s52, s72, 6076416
    buffer_load_dwordx4 v20, s[28:31], s52 offen offset:2048 lds
    s_add_u32 m0, s71, 106496
    s_add_u32 s52, s72, 6848512
    buffer_load_dwordx4 v20, s[28:31], s52 offen lds
    s_add_u32 s52, s72, 6862848
    buffer_load_dwordx4 v20, s[28:31], s52 offen offset:2048 lds
    s_add_u32 m0, s71, 110592
    s_add_u32 s52, s72, 7634944
    buffer_load_dwordx4 v20, s[28:31], s52 offen lds
    s_add_u32 s52, s72, 7649280
    buffer_load_dwordx4 v20, s[28:31], s52 offen offset:2048 lds
    s_waitcnt vmcnt(20)
    s_barrier
    s_add_u32 m0, s71, 118784
    s_add_u32 s52, s72, 589824
    buffer_load_dwordx4 v20, s[28:31], s52 offen lds
    s_add_u32 s52, s72, 604160
    buffer_load_dwordx4 v20, s[28:31], s52 offen offset:2048 lds
    s_add_u32 m0, s71, 122880
    s_add_u32 s52, s72, 1376256
    buffer_load_dwordx4 v20, s[28:31], s52 offen lds
    s_add_u32 s52, s72, 1390592
    buffer_load_dwordx4 v20, s[28:31], s52 offen offset:2048 lds
    s_add_u32 m0, s71, 126976
    s_add_u32 s52, s72, 2162688
    buffer_load_dwordx4 v20, s[28:31], s52 offen lds
    s_add_u32 s52, s72, 2177024
    buffer_load_dwordx4 v20, s[28:31], s52 offen offset:2048 lds
    s_add_u32 m0, s71, 131072
    s_add_u32 s52, s72, 2949120
    buffer_load_dwordx4 v20, s[28:31], s52 offen lds
    s_add_u32 s52, s72, 2963456
    buffer_load_dwordx4 v20, s[28:31], s52 offen offset:2048 lds
    s_add_u32 m0, s71, 135168
    s_add_u32 s52, s72, 3735552
    buffer_load_dwordx4 v20, s[28:31], s52 offen lds
    s_add_u32 s52, s72, 3749888
    buffer_load_dwordx4 v20, s[28:31], s52 offen offset:2048 lds
    s_add_u32 m0, s71, 139264
    s_add_u32 s52, s72, 4521984
    buffer_load_dwordx4 v20, s[28:31], s52 offen lds
    s_add_u32 s52, s72, 4536320
    buffer_load_dwordx4 v20, s[28:31], s52 offen offset:2048 lds
    s_add_u32 m0, s71, 143360
    s_add_u32 s52, s72, 5308416
    buffer_load_dwordx4 v20, s[28:31], s52 offen lds
    s_add_u32 s52, s72, 5322752
    buffer_load_dwordx4 v20, s[28:31], s52 offen offset:2048 lds
    s_add_u32 m0, s71, 147456
    s_add_u32 s52, s72, 6094848
    buffer_load_dwordx4 v20, s[28:31], s52 offen lds
    s_add_u32 s52, s72, 6109184
    buffer_load_dwordx4 v20, s[28:31], s52 offen offset:2048 lds
    s_add_u32 m0, s71, 151552
    s_add_u32 s52, s72, 6881280
    buffer_load_dwordx4 v20, s[28:31], s52 offen lds
    s_add_u32 s52, s72, 6895616
    buffer_load_dwordx4 v20, s[28:31], s52 offen offset:2048 lds
    s_add_u32 m0, s71, 155648
    s_add_u32 s52, s72, 7667712
    buffer_load_dwordx4 v20, s[28:31], s52 offen lds
    s_add_u32 s52, s72, 7682048
    buffer_load_dwordx4 v20, s[28:31], s52 offen offset:2048 lds
    s_movk_i32 s53, 128
    s_add_u32 m0, s71, 14336
    s_nop 0
    buffer_load_dwordx4 v24, s[24:27], s53 offen lds
    s_add_u32 m0, s71, 16384
    s_nop 0
    buffer_load_dwordx4 v25, s[24:27], s53 offen lds
    s_add_u32 m0, s71, 18432
    s_nop 0
    buffer_load_dwordx4 v26, s[24:27], s53 offen lds
    s_add_u32 m0, s71, 20480
    s_nop 0
    buffer_load_dwordx4 v27, s[24:27], s53 offen lds
    s_add_u32 m0, s71, 22528
    s_nop 0
    buffer_load_dwordx4 v28, s[24:27], s53 offen lds
    s_add_u32 m0, s71, 24576
    s_nop 0
    buffer_load_dwordx4 v29, s[24:27], s53 offen lds
    s_add_u32 m0, s71, 26624
    s_nop 0
    buffer_load_dwordx4 v30, s[24:27], s53 offen lds
    s_cmp_eq_u32 s21, 1
    s_cbranch_scc1 L_xs_3
    s_sub_u32 s52, 0, s73
    s_max_i32 s52, s52, -9
    s_sub_u32 s53, 665, s73
    s_min_i32 s53, s53, 95
    s_sub_u32 s53, s53, s52
    s_sub_u32 s54, s73, 0
    s_mul_i32 s54, s54, 6
    s_and_b32 s55, s19, 1
    s_add_u32 s54, s54, s55
    s_lshr_b32 s55, s19, 1
    s_mul_i32 s55, s55, 4000
    s_add_u32 s54, s54, s55
    s_lshl_b32 s54, s54, 9
    v_mov_b32 v12, 0x40000000
    v_subrev_u32 v10, s52, v48
    v_cmp_ge_u32 vcc, s53, v10
    v_mul_i32_i24 v11, 3072, v48
    v_add3_u32 v11, v11, s54, v56
    v_cndmask_b32 v32, v12, v11, vcc
    v_subrev_u32 v10, s52, v49
    v_cmp_ge_u32 vcc, s53, v10
    v_mul_i32_i24 v11, 3072, v49
    v_add3_u32 v11, v11, s54, v57
    v_cndmask_b32 v33, v12, v11, vcc
    v_subrev_u32 v10, s52, v50
    v_cmp_ge_u32 vcc, s53, v10
    v_mul_i32_i24 v11, 3072, v50
    v_add3_u32 v11, v11, s54, v58
    v_cndmask_b32 v34, v12, v11, vcc
    v_subrev_u32 v10, s52, v51
    v_cmp_ge_u32 vcc, s53, v10
    v_mul_i32_i24 v11, 3072, v51
    v_add3_u32 v11, v11, s54, v59
    v_cndmask_b32 v35, v12, v11, vcc
    v_subrev_u32 v10, s52, v52
    v_cmp_ge_u32 vcc, s53, v10
    v_mul_i32_i24 v11, 3072, v52
    v_add3_u32 v11, v11, s54, v60
    v_cndmask_b32 v36, v12, v11, vcc
    v_subrev_u32 v10, s52, v53
    v_cmp_ge_u32 vcc, s53, v10
    v_mul_i32_i24 v11, 3072, v53
    v_add3_u32 v11, v11, s54, v61
    v_cndmask_b32 v37, v12, v11, vcc
    v_subrev_u32 v10, s52, v54
    v_cmp_ge_u32 vcc, s53, v10
    v_mul_i32_i24 v11, 3072, v54
    v_add3_u32 v11, v11, s54, v62
    v_cndmask_b32 v38, v12, v11, vcc
    s_sub_u32 s52, 0, s73
    s_max_i32 s52, s52, -10
    s_sub_u32 s53, 666, s73
    s_min_i32 s53, s53, 95
    s_sub_u32 s53, s53, s52
    s_sub_u32 s54, s73, 0
    s_lshl_b32 s54, s54, 9
    s_mul_i32 s55, s19, 344064
    s_add_u32 s54, s54, s55
    v_mov_b32 v12, 0x40000000
    v_subrev_u32 v10, s52, v48
    v_cmp_ge_u32 vcc, s53, v10
    v_lshlrev_b32 v11, 9, v48
    v_add3_u32 v11, v11, s54, v56
    v_cndmask_b32 v40, v12, v11, vcc
    v_subrev_u32 v10, s52, v49
    v_cmp_ge_u32 vcc, s53, v10
    v_lshlrev_b32 v11, 9, v49
    v_add3_u32 v11, v11, s54, v57
    v_cndmask_b32 v41, v12, v11, vcc
    v_subrev_u32 v10, s52, v50
    v_cmp_ge_u32 vcc, s53, v10
    v_lshlrev_b32 v11, 9, v50
    v_add3_u32 v11, v11, s54, v58
    v_cndmask_b32 v42, v12, v11, vcc
    v_subrev_u32 v10, s52, v51
    v_cmp_ge_u32 vcc, s53, v10
    v_lshlrev_b32 v11, 9, v51
    v_add3_u32 v11, v11, s54, v59
    v_cndmask_b32 v43, v12, v11, vcc
    v_subrev_u32 v10, s52, v52
    v_cmp_ge_u32 vcc, s53, v10
    v_lshlrev_b32 v11, 9, v52
    v_add3_u32 v11, v11, s54, v60
    v_cndmask_b32 v44, v12, v11, vcc
    v_subrev_u32 v10, s52, v53
    v_cmp_ge_u32 vcc, s53, v10
    v_lshlrev_b32 v11, 9, v53
    v_add3_u32 v11, v11, s54, v61
    v_cndmask_b32 v45, v12, v11, vcc
    v_subrev_u32 v10, s52, v54
    v_cmp_ge_u32 vcc, s53, v10
    v_lshlrev_b32 v11, 9, v54
    v_add3_u32 v11, v11, s54, v62
    v_cndmask_b32 v46, v12, v11, vcc
    s_branch L_xe_4
L_xs_3:
    s_cmp_eq_u32 s21, 1
    s_cselect_b32 s52, 0, -9
    s_sub_u32 s53, 95, s52
    v_mov_b32 v12, 0x40000000
    v_subrev_u32 v10, s52, v48
    v_cmp_ge_u32 vcc, s53, v10
    v_subrev_u32 v10, 0, v64
    v_and_b32 v13, 1, v72
    v_mul_i32_i24 v11, 6, v10
    v_add_u32 v11, v11, v13
    s_movk_i32 s54, 3996
    v_cmp_gt_u32 s[56:57], s54, v11
    s_and_b64 vcc, vcc, s[56:57]
    v_lshrrev_b32 v13, 1, v72
    v_mul_u32_u24 v13, 4000, v13
    v_add_u32 v11, v11, v13
    v_lshl_add_u32 v11, v11, 9, v56
    s_nop 0
    v_cndmask_b32 v32, v12, v11, vcc
    v_subrev_u32 v10, s52, v49
    v_cmp_ge_u32 vcc, s53, v10
    v_subrev_u32 v10, 0, v65
    v_and_b32 v13, 1, v73
    v_mul_i32_i24 v11, 6, v10
    v_add_u32 v11, v11, v13
    s_movk_i32 s54, 3996
    v_cmp_gt_u32 s[56:57], s54, v11
    s_and_b64 vcc, vcc, s[56:57]
    v_lshrrev_b32 v13, 1, v73
    v_mul_u32_u24 v13, 4000, v13
    v_add_u32 v11, v11, v13
    v_lshl_add_u32 v11, v11, 9, v57
    s_nop 0
    v_cndmask_b32 v33, v12, v11, vcc
    v_subrev_u32 v10, s52, v50
    v_cmp_ge_u32 vcc, s53, v10
    v_subrev_u32 v10, 0, v66
    v_and_b32 v13, 1, v74
    v_mul_i32_i24 v11, 6, v10
    v_add_u32 v11, v11, v13
    s_movk_i32 s54, 3996
    v_cmp_gt_u32 s[56:57], s54, v11
    s_and_b64 vcc, vcc, s[56:57]
    v_lshrrev_b32 v13, 1, v74
    v_mul_u32_u24 v13, 4000, v13
    v_add_u32 v11, v11, v13
    v_lshl_add_u32 v11, v11, 9, v58
    s_nop 0
    v_cndmask_b32 v34, v12, v11, vcc
    v_subrev_u32 v10, s52, v51
    v_cmp_ge_u32 vcc, s53, v10
    v_subrev_u32 v10, 0, v67
    v_and_b32 v13, 1, v75
    v_mul_i32_i24 v11, 6, v10
    v_add_u32 v11, v11, v13
    s_movk_i32 s54, 3996
    v_cmp_gt_u32 s[56:57], s54, v11
    s_and_b64 vcc, vcc, s[56:57]
    v_lshrrev_b32 v13, 1, v75
    v_mul_u32_u24 v13, 4000, v13
    v_add_u32 v11, v11, v13
    v_lshl_add_u32 v11, v11, 9, v59
    s_nop 0
    v_cndmask_b32 v35, v12, v11, vcc
    v_subrev_u32 v10, s52, v52
    v_cmp_ge_u32 vcc, s53, v10
    v_subrev_u32 v10, 0, v68
    v_and_b32 v13, 1, v76
    v_mul_i32_i24 v11, 6, v10
    v_add_u32 v11, v11, v13
    s_movk_i32 s54, 3996
    v_cmp_gt_u32 s[56:57], s54, v11
    s_and_b64 vcc, vcc, s[56:57]
    v_lshrrev_b32 v13, 1, v76
    v_mul_u32_u24 v13, 4000, v13
    v_add_u32 v11, v11, v13
    v_lshl_add_u32 v11, v11, 9, v60
    s_nop 0
    v_cndmask_b32 v36, v12, v11, vcc
    v_subrev_u32 v10, s52, v53
    v_cmp_ge_u32 vcc, s53, v10
    v_subrev_u32 v10, 0, v69
    v_and_b32 v13, 1, v77
    v_mul_i32_i24 v11, 6, v10
    v_add_u32 v11, v11, v13
    s_movk_i32 s54, 3996
    v_cmp_gt_u32 s[56:57], s54, v11
    s_and_b64 vcc, vcc, s[56:57]
    v_lshrrev_b32 v13, 1, v77
    v_mul_u32_u24 v13, 4000, v13
    v_add_u32 v11, v11, v13
    v_lshl_add_u32 v11, v11, 9, v61
    s_nop 0
    v_cndmask_b32 v37, v12, v11, vcc
    v_subrev_u32 v10, s52, v54
    v_cmp_ge_u32 vcc, s53, v10
    v_subrev_u32 v10, 0, v70
    v_and_b32 v13, 1, v78
    v_mul_i32_i24 v11, 6, v10
    v_add_u32 v11, v11, v13
    s_movk_i32 s54, 3996
    v_cmp_gt_u32 s[56:57], s54, v11
    s_and_b64 vcc, vcc, s[56:57]
    v_lshrrev_b32 v13, 1, v78
    v_mul_u32_u24 v13, 4000, v13
    v_add_u32 v11, v11, v13
    v_lshl_add_u32 v11, v11, 9, v62
    s_nop 0
    v_cndmask_b32 v38, v12, v11, vcc
    s_cmp_eq_u32 s21, 1
    s_cselect_b32 s52, 0, -10
    s_sub_u32 s53, 95, s52
    v_mov_b32 v12, 0x40000000
    v_subrev_u32 v10, s52, v48
    v_cmp_ge_u32 vcc, s53, v10
    v_subrev_u32 v10, 0, v64
    s_movk_i32 s54, 667
    v_cmp_gt_u32 s[56:57], s54, v10
    s_and_b64 vcc, vcc, s[56:57]
    s_mov_b32 s54, 344064
    v_mul_lo_u32 v11, v72, s54
    v_lshl_add_u32 v11, v10, 9, v11
    v_add_u32 v11, v11, v56
    s_nop 0
    v_cndmask_b32 v40, v12, v11, vcc
    v_subrev_u32 v10, s52, v49
    v_cmp_ge_u32 vcc, s53, v10
    v_subrev_u32 v10, 0, v65
    s_movk_i32 s54, 667
    v_cmp_gt_u32 s[56:57], s54, v10
    s_and_b64 vcc, vcc, s[56:57]
    s_mov_b32 s54, 344064
    v_mul_lo_u32 v11, v73, s54
    v_lshl_add_u32 v11, v10, 9, v11
    v_add_u32 v11, v11, v57
    s_nop 0
    v_cndmask_b32 v41, v12, v11, vcc
    v_subrev_u32 v10, s52, v50
    v_cmp_ge_u32 vcc, s53, v10
    v_subrev_u32 v10, 0, v66
    s_movk_i32 s54, 667
    v_cmp_gt_u32 s[56:57], s54, v10
    s_and_b64 vcc, vcc, s[56:57]
    s_mov_b32 s54, 344064
    v_mul_lo_u32 v11, v74, s54
    v_lshl_add_u32 v11, v10, 9, v11
    v_add_u32 v11, v11, v58
    s_nop 0
    v_cndmask_b32 v42, v12, v11, vcc
    v_subrev_u32 v10, s52, v51
    v_cmp_ge_u32 vcc, s53, v10
    v_subrev_u32 v10, 0, v67
    s_movk_i32 s54, 667
    v_cmp_gt_u32 s[56:57], s54, v10
    s_and_b64 vcc, vcc, s[56:57]
    s_mov_b32 s54, 344064
    v_mul_lo_u32 v11, v75, s54
    v_lshl_add_u32 v11, v10, 9, v11
    v_add_u32 v11, v11, v59
    s_nop 0
    v_cndmask_b32 v43, v12, v11, vcc
    v_subrev_u32 v10, s52, v52
    v_cmp_ge_u32 vcc, s53, v10
    v_subrev_u32 v10, 0, v68
    s_movk_i32 s54, 667
    v_cmp_gt_u32 s[56:57], s54, v10
    s_and_b64 vcc, vcc, s[56:57]
    s_mov_b32 s54, 344064
    v_mul_lo_u32 v11, v76, s54
    v_lshl_add_u32 v11, v10, 9, v11
    v_add_u32 v11, v11, v60
    s_nop 0
    v_cndmask_b32 v44, v12, v11, vcc
    v_subrev_u32 v10, s52, v53
    v_cmp_ge_u32 vcc, s53, v10
    v_subrev_u32 v10, 0, v69
    s_movk_i32 s54, 667
    v_cmp_gt_u32 s[56:57], s54, v10
    s_and_b64 vcc, vcc, s[56:57]
    s_mov_b32 s54, 344064
    v_mul_lo_u32 v11, v77, s54
    v_lshl_add_u32 v11, v10, 9, v11
    v_add_u32 v11, v11, v61
    s_nop 0
    v_cndmask_b32 v45, v12, v11, vcc
    v_subrev_u32 v10, s52, v54
    v_cmp_ge_u32 vcc, s53, v10
    v_subrev_u32 v10, 0, v70
    s_movk_i32 s54, 667
    v_cmp_gt_u32 s[56:57], s54, v10
    s_and_b64 vcc, vcc, s[56:57]
    s_mov_b32 s54, 344064
    v_mul_lo_u32 v11, v78, s54
    v_lshl_add_u32 v11, v10, 9, v11
    v_add_u32 v11, v11, v62
    s_nop 0
    v_cndmask_b32 v46, v12, v11, vcc
L_xe_4:
    s_setprio 0
    s_waitcnt vmcnt(27)
    s_barrier
    s_add_u32 m0, s71, 28672
    s_add_u32 s52, s72, 622592
    buffer_load_dwordx4 v20, s[28:31], s52 offen lds
    s_add_u32 s52, s72, 636928
    buffer_load_dwordx4 v20, s[28:31], s52 offen offset:2048 lds
    s_add_u32 m0, s71, 32768
    s_add_u32 s52, s72, 1409024
    buffer_load_dwordx4 v20, s[28:31], s52 offen lds
    s_add_u32 s52, s72, 1423360
    buffer_load_dwordx4 v20, s[28:31], s52 offen offset:2048 lds
    s_add_u32 m0, s71, 36864
    s_add_u32 s52, s72, 2195456
    buffer_load_dwordx4 v20, s[28:31], s52 offen lds
    s_add_u32 s52, s72, 2209792
    buffer_load_dwordx4 v20, s[28:31], s52 offen offset:2048 lds
    s_add_u32 m0, s71, 40960
    s_add_u32 s52, s72, 2981888
    buffer_load_dwordx4 v20, s[28:31], s52 offen lds
    s_add_u32 s52, s72, 2996224
    buffer_load_dwordx4 v20, s[28:31], s52 offen offset:2048 lds
    s_add_u32 m0, s71, 45056
    s_add_u32 s52, s72, 3768320
    buffer_load_dwordx4 v20, s[28:31], s52 offen lds
    s_add_u32 s52, s72, 3782656
    buffer_load_dwordx4 v20, s[28:31], s52 offen offset:2048 lds
    s_add_u32 m0, s71, 49152
    s_add_u32 s52, s72, 4554752
    buffer_load_dwordx4 v20, s[28:31], s52 offen lds
    s_add_u32 s52, s72, 4569088
    buffer_load_dwordx4 v20, s[28:31], s52 offen offset:2048 lds
    s_add_u32 m0, s71, 53248
    s_add_u32 s52, s72, 5341184
    buffer_load_dwordx4 v20, s[28:31], s52 offen lds
    s_add_u32 s52, s72, 5355520
    buffer_load_dwordx4 v20, s[28:31], s52 offen offset:2048 lds
    s_waitcnt vmcnt(14)
    s_barrier
    s_add_u32 m0, s71, 57344
    s_add_u32 s52, s72, 6127616
    buffer_load_dwordx4 v20, s[28:31], s52 offen lds
    s_add_u32 s52, s72, 6141952
    buffer_load_dwordx4 v20, s[28:31], s52 offen offset:2048 lds
    s_add_u32 m0, s71, 61440
    s_add_u32 s52, s72, 6914048
    buffer_load_dwordx4 v20, s[28:31], s52 offen lds
    s_add_u32 s52, s72, 6928384
    buffer_load_dwordx4 v20, s[28:31], s52 offen offset:2048 lds
    s_add_u32 m0, s71, 65536
    s_add_u32 s52, s72, 7700480
    buffer_load_dwordx4 v20, s[28:31], s52 offen lds
    s_add_u32 s52, s72, 7714816
    buffer_load_dwordx4 v20, s[28:31], s52 offen offset:2048 lds
    s_movk_i32 s53, 256
    s_add_u32 m0, s71, 0
    s_nop 0
    buffer_load_dwordx4 v24, s[24:27], s53 offen lds
    s_add_u32 m0, s71, 2048
    s_nop 0
    buffer_load_dwordx4 v25, s[24:27], s53 offen lds
    s_add_u32 m0, s71, 4096
    s_nop 0
    buffer_load_dwordx4 v26, s[24:27], s53 offen lds
    s_add_u32 m0, s71, 6144
    s_nop 0
    buffer_load_dwordx4 v27, s[24:27], s53 offen lds
    s_add_u32 m0, s71, 8192
    s_nop 0
    buffer_load_dwordx4 v28, s[24:27], s53 offen lds
    s_add_u32 m0, s71, 10240
    s_nop 0
    buffer_load_dwordx4 v29, s[24:27], s53 offen lds
    s_add_u32 m0, s71, 12288
    s_nop 0
    buffer_load_dwordx4 v30, s[24:27], s53 offen lds
    s_add_u32 m0, s71, 73728
    s_add_u32 s52, s72, 655360
    buffer_load_dwordx4 v20, s[28:31], s52 offen lds
    s_add_u32 s52, s72, 669696
    buffer_load_dwordx4 v20, s[28:31], s52 offen offset:2048 lds
    s_add_u32 m0, s71, 77824
    s_add_u32 s52, s72, 1441792
    buffer_load_dwordx4 v20, s[28:31], s52 offen lds
    s_add_u32 s52, s72, 1456128
    buffer_load_dwordx4 v20, s[28:31], s52 offen offset:2048 lds
    s_add_u32 m0, s71, 81920
    s_add_u32 s52, s72, 2228224
    buffer_load_dwordx4 v20, s[28:31], s52 offen lds
    s_add_u32 s52, s72, 2242560
    buffer_load_dwordx4 v20, s[28:31], s52 offen offset:2048 lds
    s_add_u32 m0, s71, 86016
    s_add_u32 s52, s72, 3014656
    buffer_load_dwordx4 v20, s[28:31], s52 offen lds
    s_add_u32 s52, s72, 3028992
    buffer_load_dwordx4 v20, s[28:31], s52 offen offset:2048 lds
    s_add_u32 m0, s71, 90112
    s_add_u32 s52, s72, 3801088
    buffer_load_dwordx4 v20, s[28:31], s52 offen lds
    s_add_u32 s52, s72, 3815424
    buffer_load_dwordx4 v20, s[28:31], s52 offen offset:2048 lds
    s_add_u32 m0, s71, 94208
    s_add_u32 s52, s72, 4587520
    buffer_load_dwordx4 v20, s[28:31], s52 offen lds
    s_add_u32 s52, s72, 4601856
    buffer_load_dwordx4 v20, s[28:31], s52 offen offset:2048 lds
    s_add_u32 m0, s71, 98304
    s_add_u32 s52, s72, 5373952
    buffer_load_dwordx4 v20, s[28:31], s52 offen lds
    s_add_u32 s52, s72, 5388288
    buffer_load_dwordx4 v20, s[28:31], s52 offen offset:2048 lds
    s_waitcnt vmcnt(21)
    s_barrier
    s_add_u32 m0, s71, 102400
    s_add_u32 s52, s72, 6160384
    buffer_load_dwordx4 v20, s[28:31], s52 offen lds
    s_add_u32 s52, s72, 6174720
    buffer_load_dwordx4 v20, s[28:31], s52 offen offset:2048 lds
    s_add_u32 m0, s71, 106496
    s_add_u32 s52, s72, 6946816
    buffer_load_dwordx4 v20, s[28:31], s52 offen lds
    s_add_u32 s52, s72, 6961152
    buffer_load_dwordx4 v20, s[28:31], s52 offen offset:2048 lds
    s_add_u32 m0, s71, 110592
    s_add_u32 s52, s72, 7733248
    buffer_load_dwordx4 v20, s[28:31], s52 offen lds
    s_add_u32 s52, s72, 7747584
    buffer_load_dwordx4 v20, s[28:31], s52 offen offset:2048 lds
    s_add_u32 m0, s71, 118784
    s_add_u32 s52, s72, 688128
    buffer_load_dwordx4 v20, s[28:31], s52 offen lds
    s_add_u32 s52, s72, 702464
    buffer_load_dwordx4 v20, s[28:31], s52 offen offset:2048 lds
    s_add_u32 m0, s71, 122880
    s_add_u32 s52, s72, 1474560
    buffer_load_dwordx4 v20, s[28:31], s52 offen lds
    s_add_u32 s52, s72, 1488896
    buffer_load_dwordx4 v20, s[28:31], s52 offen offset:2048 lds
    s_add_u32 m0, s71, 126976
    s_add_u32 s52, s72, 2260992
    buffer_load_dwordx4 v20, s[28:31], s52 offen lds
    s_add_u32 s52, s72, 2275328
    buffer_load_dwordx4 v20, s[28:31], s52 offen offset:2048 lds
    s_add_u32 m0, s71, 131072
    s_add_u32 s52, s72, 3047424
    buffer_load_dwordx4 v20, s[28:31], s52 offen lds
    s_add_u32 s52, s72, 3061760
    buffer_load_dwordx4 v20, s[28:31], s52 offen offset:2048 lds
    s_add_u32 m0, s71, 135168
    s_add_u32 s52, s72, 3833856
    buffer_load_dwordx4 v20, s[28:31], s52 offen lds
    s_add_u32 s52, s72, 3848192
    buffer_load_dwordx4 v20, s[28:31], s52 offen offset:2048 lds
    s_add_u32 m0, s71, 139264
    s_add_u32 s52, s72, 4620288
    buffer_load_dwordx4 v20, s[28:31], s52 offen lds
    s_add_u32 s52, s72, 4634624
    buffer_load_dwordx4 v20, s[28:31], s52 offen offset:2048 lds
    s_add_u32 m0, s71, 143360
    s_add_u32 s52, s72, 5406720
    buffer_load_dwordx4 v20, s[28:31], s52 offen lds
    s_add_u32 s52, s72, 5421056
    buffer_load_dwordx4 v20, s[28:31], s52 offen offset:2048 lds
    s_waitcnt vmcnt(14)
    s_barrier
    s_add_u32 m0, s71, 147456
    s_add_u32 s52, s72, 6193152
    buffer_load_dwordx4 v20, s[28:31], s52 offen lds
    s_add_u32 s52, s72, 6207488
    buffer_load_dwordx4 v20, s[28:31], s52 offen offset:2048 lds
    s_add_u32 m0, s71, 151552
    s_add_u32 s52, s72, 6979584
    buffer_load_dwordx4 v20, s[28:31], s52 offen lds
    s_add_u32 s52, s72, 6993920
    buffer_load_dwordx4 v20, s[28:31], s52 offen offset:2048 lds
    s_add_u32 m0, s71, 155648
    s_add_u32 s52, s72, 7766016
    buffer_load_dwordx4 v20, s[28:31], s52 offen lds
    s_add_u32 s52, s72, 7780352
    buffer_load_dwordx4 v20, s[28:31], s52 offen offset:2048 lds
    s_movk_i32 s53, 384
    s_add_u32 m0, s71, 14336
    s_nop 0
    buffer_load_dwordx4 v24, s[24:27], s53 offen lds
    s_add_u32 m0, s71, 16384
    s_nop 0
    buffer_load_dwordx4 v25, s[24:27], s53 offen lds
    s_add_u32 m0, s71, 18432
    s_nop 0
    buffer_load_dwordx4 v26, s[24:27], s53 offen lds
    s_add_u32 m0, s71, 20480
    s_nop 0
    buffer_load_dwordx4 v27, s[24:27], s53 offen lds
    s_add_u32 m0, s71, 22528
    s_nop 0
    buffer_load_dwordx4 v28, s[24:27], s53 offen lds
    s_add_u32 m0, s71, 24576
    s_nop 0
    buffer_load_dwordx4 v29, s[24:27], s53 offen lds
    s_add_u32 m0, s71, 26624
    s_nop 0
    buffer_load_dwordx4 v30, s[24:27], s53 offen lds
    s_add_u32 m0, s71, 28672
    s_add_u32 s52, s72, 720896
    buffer_load_dwordx4 v20, s[28:31], s52 offen lds
    s_add_u32 s52, s72, 735232
    buffer_load_dwordx4 v20, s[28:31], s52 offen offset:2048 lds
    s_add_u32 m0, s71, 32768
    s_add_u32 s52, s72, 1507328
    buffer_load_dwordx4 v20, s[28:31], s52 offen lds
    s_add_u32 s52, s72, 1521664
    buffer_load_dwordx4 v20, s[28:31], s52 offen offset:2048 lds
    s_add_u32 m0, s71, 36864
    s_add_u32 s52, s72, 2293760
    buffer_load_dwordx4 v20, s[28:31], s52 offen lds
    s_add_u32 s52, s72, 2308096
    buffer_load_dwordx4 v20, s[28:31], s52 offen offset:2048 lds
    s_add_u32 m0, s71, 40960
    s_add_u32 s52, s72, 3080192
    buffer_load_dwordx4 v20, s[28:31], s52 offen lds
    s_add_u32 s52, s72, 3094528
    buffer_load_dwordx4 v20, s[28:31], s52 offen offset:2048 lds
    s_add_u32 m0, s71, 45056
    s_add_u32 s52, s72, 3866624
    buffer_load_dwordx4 v20, s[28:31], s52 offen lds
    s_add_u32 s52, s72, 3880960
    buffer_load_dwordx4 v20, s[28:31], s52 offen offset:2048 lds
    s_add_u32 m0, s71, 49152
    s_add_u32 s52, s72, 4653056
    buffer_load_dwordx4 v20, s[28:31], s52 offen lds
    s_add_u32 s52, s72, 4667392
    buffer_load_dwordx4 v20, s[28:31], s52 offen offset:2048 lds
    s_add_u32 m0, s71, 53248
    s_add_u32 s52, s72, 5439488
    buffer_load_dwordx4 v20, s[28:31], s52 offen lds
    s_add_u32 s52, s72, 5453824
    buffer_load_dwordx4 v20, s[28:31], s52 offen offset:2048 lds
    s_waitcnt vmcnt(21)
    s_barrier
    s_add_u32 m0, s71, 57344
    s_add_u32 s52, s72, 6225920
    buffer_load_dwordx4 v20, s[28:31], s52 offen lds
    s_add_u32 s52, s72, 6240256
    buffer_load_dwordx4 v20, s[28:31], s52 offen offset:2048 lds
    s_add_u32 m0, s71, 61440
    s_add_u32 s52, s72, 7012352
    buffer_load_dwordx4 v20, s[28:31], s52 offen lds
    s_add_u32 s52, s72, 7026688
    buffer_load_dwordx4 v20, s[28:31], s52 offen offset:2048 lds
    s_add_u32 m0, s71, 65536
    s_add_u32 s52, s72, 7798784
    buffer_load_dwordx4 v20, s[28:31], s52 offen lds
    s_add_u32 s52, s72, 7813120
    buffer_load_dwordx4 v20, s[28:31], s52 offen offset:2048 lds
    s_add_u32 m0, s71, 73728
    s_add_u32 s52, s72, 753664
    buffer_load_dwordx4 v20, s[28:31], s52 offen lds
    s_add_u32 s52, s72, 768000
    buffer_load_dwordx4 v20, s[28:31], s52 offen offset:2048 lds
    s_add_u32 m0, s71, 77824
    s_add_u32 s52, s72, 1540096
    buffer_load_dwordx4 v20, s[28:31], s52 offen lds
    s_add_u32 s52, s72, 1554432
    buffer_load_dwordx4 v20, s[28:31], s52 offen offset:2048 lds
    s_add_u32 m0, s71, 81920
    s_add_u32 s52, s72, 2326528
    buffer_load_dwordx4 v20, s[28:31], s52 offen lds
    s_add_u32 s52, s72, 2340864
    buffer_load_dwordx4 v20, s[28:31], s52 offen offset:2048 lds
    s_add_u32 m0, s71, 86016
    s_add_u32 s52, s72, 3112960
    buffer_load_dwordx4 v20, s[28:31], s52 offen lds
    s_add_u32 s52, s72, 3127296
    buffer_load_dwordx4 v20, s[28:31], s52 offen offset:2048 lds
    s_add_u32 m0, s71, 90112
    s_add_u32 s52, s72, 3899392
    buffer_load_dwordx4 v20, s[28:31], s52 offen lds
    s_add_u32 s52, s72, 3913728
    buffer_load_dwordx4 v20, s[28:31], s52 offen offset:2048 lds
    s_add_u32 m0, s71, 94208
    s_add_u32 s52, s72, 4685824
    buffer_load_dwordx4 v20, s[28:31], s52 offen lds
    s_add_u32 s52, s72, 4700160
    buffer_load_dwordx4 v20, s[28:31], s52 offen offset:2048 lds
    s_add_u32 m0, s71, 98304
    s_add_u32 s52, s72, 5472256
    buffer_load_dwordx4 v20, s[28:31], s52 offen lds
    s_add_u32 s52, s72, 5486592
    buffer_load_dwordx4 v20, s[28:31], s52 offen offset:2048 lds
    s_waitcnt vmcnt(14)
    s_barrier
    s_add_u32 m0, s71, 102400
    s_add_u32 s52, s72, 6258688
    buffer_load_dwordx4 v20, s[28:31], s52 offen lds
    s_add_u32 s52, s72, 6273024
    buffer_load_dwordx4 v20, s[28:31], s52 offen offset:2048 lds
    s_add_u32 m0, s71, 106496
    s_add_u32 s52, s72, 7045120
    buffer_load_dwordx4 v20, s[28:31], s52 offen lds
    s_add_u32 s52, s72, 7059456
    buffer_load_dwordx4 v20, s[28:31], s52 offen offset:2048 lds
    s_add_u32 m0, s71, 110592
    s_add_u32 s52, s72, 7831552
    buffer_load_dwordx4 v20, s[28:31], s52 offen lds
    s_add_u32 s52, s72, 7845888
    buffer_load_dwordx4 v20, s[28:31], s52 offen offset:2048 lds
    s_movk_i32 s53, 2048
    s_add_u32 m0, s71, 0
    s_nop 0
    buffer_load_dwordx4 v32, s[24:27], s53 offen lds
    s_add_u32 m0, s71, 2048
    s_nop 0
    buffer_load_dwordx4 v33, s[24:27], s53 offen lds
    s_add_u32 m0, s71, 4096
    s_nop 0
    buffer_load_dwordx4 v34, s[24:27], s53 offen lds
    s_add_u32 m0, s71, 6144
    s_nop 0
    buffer_load_dwordx4 v35, s[24:27], s53 offen lds
    s_add_u32 m0, s71, 8192
    s_nop 0
    buffer_load_dwordx4 v36, s[24:27], s53 offen lds
    s_add_u32 m0, s71, 10240
    s_nop 0
    buffer_load_dwordx4 v37, s[24:27], s53 offen lds
    s_add_u32 m0, s71, 12288
    s_nop 0
    buffer_load_dwordx4 v38, s[24:27], s53 offen lds
    s_add_u32 m0, s71, 118784
    s_add_u32 s52, s72, 262144
    buffer_load_dwordx4 v20, s[28:31], s52 offen lds
    s_add_u32 s52, s72, 276480
    buffer_load_dwordx4 v20, s[28:31], s52 offen offset:2048 lds
    s_add_u32 m0, s71, 122880
    s_add_u32 s52, s72, 1048576
    buffer_load_dwordx4 v20, s[28:31], s52 offen lds
    s_add_u32 s52, s72, 1062912
    buffer_load_dwordx4 v20, s[28:31], s52 offen offset:2048 lds
    s_add_u32 m0, s71, 126976
    s_add_u32 s52, s72, 1835008
    buffer_load_dwordx4 v20, s[28:31], s52 offen lds
    s_add_u32 s52, s72, 1849344
    buffer_load_dwordx4 v20, s[28:31], s52 offen offset:2048 lds
    s_add_u32 m0, s71, 131072
    s_add_u32 s52, s72, 2621440
    buffer_load_dwordx4 v20, s[28:31], s52 offen lds
    s_add_u32 s52, s72, 2635776
    buffer_load_dwordx4 v20, s[28:31], s52 offen offset:2048 lds
    s_add_u32 m0, s71, 135168
    s_add_u32 s52, s72, 3407872
    buffer_load_dwordx4 v20, s[28:31], s52 offen lds
    s_add_u32 s52, s72, 3422208
    buffer_load_dwordx4 v20, s[28:31], s52 offen offset:2048 lds
    s_add_u32 m0, s71, 139264
    s_add_u32 s52, s72, 4194304
    buffer_load_dwordx4 v20, s[28:31], s52 offen lds
    s_add_u32 s52, s72, 4208640
    buffer_load_dwordx4 v20, s[28:31], s52 offen offset:2048 lds
    s_add_u32 m0, s71, 143360
    s_add_u32 s52, s72, 4980736
    buffer_load_dwordx4 v20, s[28:31], s52 offen lds
    s_add_u32 s52, s72, 4995072
    buffer_load_dwordx4 v20, s[28:31], s52 offen offset:2048 lds
    s_waitcnt vmcnt(21)
    s_barrier
    s_add_u32 m0, s71, 147456
    s_add_u32 s52, s72, 5767168
    buffer_load_dwordx4 v20, s[28:31], s52 offen lds
    s_add_u32 s52, s72, 5781504
    buffer_load_dwordx4 v20, s[28:31], s52 offen offset:2048 lds
    s_add_u32 m0, s71, 151552
    s_add_u32 s52, s72, 6553600
    buffer_load_dwordx4 v20, s[28:31], s52 offen lds
    s_add_u32 s52, s72, 6567936
    buffer_load_dwordx4 v20, s[28:31], s52 offen offset:2048 lds
    s_add_u32 m0, s71, 155648
    s_add_u32 s52, s72, 7340032
    buffer_load_dwordx4 v20, s[28:31], s52 offen lds
    s_add_u32 s52, s72, 7354368
    buffer_load_dwordx4 v20, s[28:31], s52 offen offset:2048 lds
    s_add_u32 m0, s71, 28672
    s_add_u32 s52, s72, 294912
    buffer_load_dwordx4 v20, s[28:31], s52 offen lds
    s_add_u32 s52, s72, 309248
    buffer_load_dwordx4 v20, s[28:31], s52 offen offset:2048 lds
    s_add_u32 m0, s71, 32768
    s_add_u32 s52, s72, 1081344
    buffer_load_dwordx4 v20, s[28:31], s52 offen lds
    s_add_u32 s52, s72, 1095680
    buffer_load_dwordx4 v20, s[28:31], s52 offen offset:2048 lds
    s_add_u32 m0, s71, 36864
    s_add_u32 s52, s72, 1867776
    buffer_load_dwordx4 v20, s[28:31], s52 offen lds
    s_add_u32 s52, s72, 1882112
    buffer_load_dwordx4 v20, s[28:31], s52 offen offset:2048 lds
    s_add_u32 m0, s71, 40960
    s_add_u32 s52, s72, 2654208
    buffer_load_dwordx4 v20, s[28:31], s52 offen lds
    s_add_u32 s52, s72, 2668544
    buffer_load_dwordx4 v20, s[28:31], s52 offen offset:2048 lds
    s_add_u32 m0, s71, 45056
    s_add_u32 s52, s72, 3440640
    buffer_load_dwordx4 v20, s[28:31], s52 offen lds
    s_add_u32 s52, s72, 3454976
    buffer_load_dwordx4 v20, s[28:31], s52 offen offset:2048 lds
    s_add_u32 m0, s71, 49152
    s_add_u32 s52, s72, 4227072
    buffer_load_dwordx4 v20, s[28:31], s52 offen lds
    s_add_u32 s52, s72, 4241408
    buffer_load_dwordx4 v20, s[28:31], s52 offen offset:2048 lds
    s_add_u32 m0, s71, 53248
    s_add_u32 s52, s72, 5013504
    buffer_load_dwordx4 v20, s[28:31], s52 offen lds
    s_add_u32 s52, s72, 5027840
    buffer_load_dwordx4 v20, s[28:31], s52 offen offset:2048 lds
    s_waitcnt vmcnt(14)
    s_barrier
    s_add_u32 m0, s71, 57344
    s_add_u32 s52, s72, 5799936
    buffer_load_dwordx4 v20, s[28:31], s52 offen lds
    s_add_u32 s52, s72, 5814272
    buffer_load_dwordx4 v20, s[28:31], s52 offen offset:2048 lds
    s_add_u32 m0, s71, 61440
    s_add_u32 s52, s72, 6586368
    buffer_load_dwordx4 v20, s[28:31], s52 offen lds
    s_add_u32 s52, s72, 6600704
    buffer_load_dwordx4 v20, s[28:31], s52 offen offset:2048 lds
    s_add_u32 m0, s71, 65536
    s_add_u32 s52, s72, 7372800
    buffer_load_dwordx4 v20, s[28:31], s52 offen lds
    s_add_u32 s52, s72, 7387136
    buffer_load_dwordx4 v20, s[28:31], s52 offen offset:2048 lds
    s_movk_i32 s53, 2176
    s_add_u32 m0, s71, 14336
    s_nop 0
    buffer_load_dwordx4 v32, s[24:27], s53 offen lds
    s_add_u32 m0, s71, 16384
    s_nop 0
    buffer_load_dwordx4 v33, s[24:27], s53 offen lds
    s_add_u32 m0, s71, 18432
    s_nop 0
    buffer_load_dwordx4 v34, s[24:27], s53 offen lds
    s_add_u32 m0, s71, 20480
    s_nop 0
    buffer_load_dwordx4 v35, s[24:27], s53 offen lds
    s_add_u32 m0, s71, 22528
    s_nop 0
    buffer_load_dwordx4 v36, s[24:27], s53 offen lds
    s_add_u32 m0, s71, 24576
    s_nop 0
    buffer_load_dwordx4 v37, s[24:27], s53 offen lds
    s_add_u32 m0, s71, 26624
    s_nop 0
    buffer_load_dwordx4 v38, s[24:27], s53 offen lds
    s_add_u32 m0, s71, 73728
    s_add_u32 s52, s72, 327680
    buffer_load_dwordx4 v20, s[28:31], s52 offen lds
    s_add_u32 s52, s72, 342016
    buffer_load_dwordx4 v20, s[28:31], s52 offen offset:2048 lds
    s_add_u32 m0, s71, 77824
    s_add_u32 s52, s72, 1114112
    buffer_load_dwordx4 v20, s[28:31], s52 offen lds
    s_add_u32 s52, s72, 1128448
    buffer_load_dwordx4 v20, s[28:31], s52 offen offset:2048 lds
    s_add_u32 m0, s71, 81920
    s_add_u32 s52, s72, 1900544
    buffer_load_dwordx4 v20, s[28:31], s52 offen lds
    s_add_u32 s52, s72, 1914880
    buffer_load_dwordx4 v20, s[28:31], s52 offen offset:2048 lds
    s_add_u32 m0, s71, 86016
    s_add_u32 s52, s72, 2686976
    buffer_load_dwordx4 v20, s[28:31], s52 offen lds
    s_add_u32 s52, s72, 2701312
    buffer_load_dwordx4 v20, s[28:31], s52 offen offset:2048 lds
    s_add_u32 m0, s71, 90112
    s_add_u32 s52, s72, 3473408
    buffer_load_dwordx4 v20, s[28:31], s52 offen lds
    s_add_u32 s52, s72, 3487744
    buffer_load_dwordx4 v20, s[28:31], s52 offen offset:2048 lds
    s_add_u32 m0, s71, 94208
    s_add_u32 s52, s72, 4259840
    buffer_load_dwordx4 v20, s[28:31], s52 offen lds
    s_add_u32 s52, s72, 4274176
    buffer_load_dwordx4 v20, s[28:31], s52 offen offset:2048 lds
    s_add_u32 m0, s71, 98304
    s_add_u32 s52, s72, 5046272
    buffer_load_dwordx4 v20, s[28:31], s52 offen lds
    s_add_u32 s52, s72, 5060608
    buffer_load_dwordx4 v20, s[28:31], s52 offen offset:2048 lds
    s_waitcnt vmcnt(21)
    s_barrier
    s_add_u32 m0, s71, 102400
    s_add_u32 s52, s72, 5832704
    buffer_load_dwordx4 v20, s[28:31], s52 offen lds
    s_add_u32 s52, s72, 5847040
    buffer_load_dwordx4 v20, s[28:31], s52 offen offset:2048 lds
    s_add_u32 m0, s71, 106496
    s_add_u32 s52, s72, 6619136
    buffer_load_dwordx4 v20, s[28:31], s52 offen lds
    s_add_u32 s52, s72, 6633472
    buffer_load_dwordx4 v20, s[28:31], s52 offen offset:2048 lds
    s_add_u32 m0, s71, 110592
    s_add_u32 s52, s72, 7405568
    buffer_load_dwordx4 v20, s[28:31], s52 offen lds
    s_add_u32 s52, s72, 7419904
    buffer_load_dwordx4 v20, s[28:31], s52 offen offset:2048 lds
    s_add_u32 m0, s71, 118784
    s_add_u32 s52, s72, 360448
    buffer_load_dwordx4 v20, s[28:31], s52 offen lds
    s_add_u32 s52, s72, 374784
    buffer_load_dwordx4 v20, s[28:31], s52 offen offset:2048 lds
    s_add_u32 m0, s71, 122880
    s_add_u32 s52, s72, 1146880
    buffer_load_dwordx4 v20, s[28:31], s52 offen lds
    s_add_u32 s52, s72, 1161216
    buffer_load_dwordx4 v20, s[28:31], s52 offen offset:2048 lds
    s_add_u32 m0, s71, 126976
    s_add_u32 s52, s72, 1933312
    buffer_load_dwordx4 v20, s[28:31], s52 offen lds
    s_add_u32 s52, s72, 1947648
    buffer_load_dwordx4 v20, s[28:31], s52 offen offset:2048 lds
    s_add_u32 m0, s71, 131072
    s_add_u32 s52, s72, 2719744
    buffer_load_dwordx4 v20, s[28:31], s52 offen lds
    s_add_u32 s52, s72, 2734080
    buffer_load_dwordx4 v20, s[28:31], s52 offen offset:2048 lds
    s_add_u32 m0, s71, 135168
    s_add_u32 s52, s72, 3506176
    buffer_load_dwordx4 v20, s[28:31], s52 offen lds
    s_add_u32 s52, s72, 3520512
    buffer_load_dwordx4 v20, s[28:31], s52 offen offset:2048 lds
    s_add_u32 m0, s71, 139264
    s_add_u32 s52, s72, 4292608
    buffer_load_dwordx4 v20, s[28:31], s52 offen lds
    s_add_u32 s52, s72, 4306944
    buffer_load_dwordx4 v20, s[28:31], s52 offen offset:2048 lds
    s_add_u32 m0, s71, 143360
    s_add_u32 s52, s72, 5079040
    buffer_load_dwordx4 v20, s[28:31], s52 offen lds
    s_add_u32 s52, s72, 5093376
    buffer_load_dwordx4 v20, s[28:31], s52 offen offset:2048 lds
    s_waitcnt vmcnt(14)
    s_barrier
    s_add_u32 m0, s71, 147456
    s_add_u32 s52, s72, 5865472
    buffer_load_dwordx4 v20, s[28:31], s52 offen lds
    s_add_u32 s52, s72, 5879808
    buffer_load_dwordx4 v20, s[28:31], s52 offen offset:2048 lds
    s_add_u32 m0, s71, 151552
    s_add_u32 s52, s72, 6651904
    buffer_load_dwordx4 v20, s[28:31], s52 offen lds
    s_add_u32 s52, s72, 6666240
    buffer_load_dwordx4 v20, s[28:31], s52 offen offset:2048 lds
    s_add_u32 m0, s71, 155648
    s_add_u32 s52, s72, 7438336
    buffer_load_dwordx4 v20, s[28:31], s52 offen lds
    s_add_u32 s52, s72, 7452672
    buffer_load_dwordx4 v20, s[28:31], s52 offen offset:2048 lds
    s_movk_i32 s53, 2304
    s_add_u32 m0, s71, 0
    s_nop 0
    buffer_load_dwordx4 v32, s[24:27], s53 offen lds
    s_add_u32 m0, s71, 2048
    s_nop 0
    buffer_load_dwordx4 v33, s[24:27], s53 offen lds
    s_add_u32 m0, s71, 4096
    s_nop 0
    buffer_load_dwordx4 v34, s[24:27], s53 offen lds
    s_add_u32 m0, s71, 6144
    s_nop 0
    buffer_load_dwordx4 v35, s[24:27], s53 offen lds
    s_add_u32 m0, s71, 8192
    s_nop 0
    buffer_load_dwordx4 v36, s[24:27], s53 offen lds
    s_add_u32 m0, s71, 10240
    s_nop 0
    buffer_load_dwordx4 v37, s[24:27], s53 offen lds
    s_add_u32 m0, s71, 12288
    s_nop 0
    buffer_load_dwordx4 v38, s[24:27], s53 offen lds
    s_add_u32 m0, s71, 28672
    s_add_u32 s52, s72, 393216
    buffer_load_dwordx4 v20, s[28:31], s52 offen lds
    s_add_u32 s52, s72, 407552
    buffer_load_dwordx4 v20, s[28:31], s52 offen offset:2048 lds
    s_add_u32 m0, s71, 32768
    s_add_u32 s52, s72, 1179648
    buffer_load_dwordx4 v20, s[28:31], s52 offen lds
    s_add_u32 s52, s72, 1193984
    buffer_load_dwordx4 v20, s[28:31], s52 offen offset:2048 lds
    s_add_u32 m0, s71, 36864
    s_add_u32 s52, s72, 1966080
    buffer_load_dwordx4 v20, s[28:31], s52 offen lds
    s_add_u32 s52, s72, 1980416
    buffer_load_dwordx4 v20, s[28:31], s52 offen offset:2048 lds
    s_add_u32 m0, s71, 40960
    s_add_u32 s52, s72, 2752512
    buffer_load_dwordx4 v20, s[28:31], s52 offen lds
    s_add_u32 s52, s72, 2766848
    buffer_load_dwordx4 v20, s[28:31], s52 offen offset:2048 lds
    s_add_u32 m0, s71, 45056
    s_add_u32 s52, s72, 3538944
    buffer_load_dwordx4 v20, s[28:31], s52 offen lds
    s_add_u32 s52, s72, 3553280
    buffer_load_dwordx4 v20, s[28:31], s52 offen offset:2048 lds
    s_add_u32 m0, s71, 49152
    s_add_u32 s52, s72, 4325376
    buffer_load_dwordx4 v20, s[28:31], s52 offen lds
    s_add_u32 s52, s72, 4339712
    buffer_load_dwordx4 v20, s[28:31], s52 offen offset:2048 lds
    s_add_u32 m0, s71, 53248
    s_add_u32 s52, s72, 5111808
    buffer_load_dwordx4 v20, s[28:31], s52 offen lds
    s_add_u32 s52, s72, 5126144
    buffer_load_dwordx4 v20, s[28:31], s52 offen offset:2048 lds
    s_waitcnt vmcnt(21)
    s_barrier
    s_add_u32 m0, s71, 57344
    s_add_u32 s52, s72, 5898240
    buffer_load_dwordx4 v20, s[28:31], s52 offen lds
    s_add_u32 s52, s72, 5912576
    buffer_load_dwordx4 v20, s[28:31], s52 offen offset:2048 lds
    s_add_u32 m0, s71, 61440
    s_add_u32 s52, s72, 6684672
    buffer_load_dwordx4 v20, s[28:31], s52 offen lds
    s_add_u32 s52, s72, 6699008
    buffer_load_dwordx4 v20, s[28:31], s52 offen offset:2048 lds
    s_add_u32 m0, s71, 65536
    s_add_u32 s52, s72, 7471104
    buffer_load_dwordx4 v20, s[28:31], s52 offen lds
    s_add_u32 s52, s72, 7485440
    buffer_load_dwordx4 v20, s[28:31], s52 offen offset:2048 lds
    s_add_u32 m0, s71, 73728
    s_add_u32 s52, s72, 425984
    buffer_load_dwordx4 v20, s[28:31], s52 offen lds
    s_add_u32 s52, s72, 440320
    buffer_load_dwordx4 v20, s[28:31], s52 offen offset:2048 lds
    s_add_u32 m0, s71, 77824
    s_add_u32 s52, s72, 1212416
    buffer_load_dwordx4 v20, s[28:31], s52 offen lds
    s_add_u32 s52, s72, 1226752
    buffer_load_dwordx4 v20, s[28:31], s52 offen offset:2048 lds
    s_add_u32 m0, s71, 81920
    s_add_u32 s52, s72, 1998848
    buffer_load_dwordx4 v20, s[28:31], s52 offen lds
    s_add_u32 s52, s72, 2013184
    buffer_load_dwordx4 v20, s[28:31], s52 offen offset:2048 lds
    s_add_u32 m0, s71, 86016
    s_add_u32 s52, s72, 2785280
    buffer_load_dwordx4 v20, s[28:31], s52 offen lds
    s_add_u32 s52, s72, 2799616
    buffer_load_dwordx4 v20, s[28:31], s52 offen offset:2048 lds
    s_add_u32 m0, s71, 90112
    s_add_u32 s52, s72, 3571712
    buffer_load_dwordx4 v20, s[28:31], s52 offen lds
    s_add_u32 s52, s72, 3586048
    buffer_load_dwordx4 v20, s[28:31], s52 offen offset:2048 lds
    s_add_u32 m0, s71, 94208
    s_add_u32 s52, s72, 4358144
    buffer_load_dwordx4 v20, s[28:31], s52 offen lds
    s_add_u32 s52, s72, 4372480
    buffer_load_dwordx4 v20, s[28:31], s52 offen offset:2048 lds
    s_add_u32 m0, s71, 98304
    s_add_u32 s52, s72, 5144576
    buffer_load_dwordx4 v20, s[28:31], s52 offen lds
    s_add_u32 s52, s72, 5158912
    buffer_load_dwordx4 v20, s[28:31], s52 offen offset:2048 lds
    s_waitcnt vmcnt(14)
    s_barrier
    s_add_u32 m0, s71, 102400
    s_add_u32 s52, s72, 5931008
    buffer_load_dwordx4 v20, s[28:31], s52 offen lds
    s_add_u32 s52, s72, 5945344
    buffer_load_dwordx4 v20, s[28:31], s52 offen offset:2048 lds
    s_add_u32 m0, s71, 106496
    s_add_u32 s52, s72, 6717440
    buffer_load_dwordx4 v20, s[28:31], s52 offen lds
    s_add_u32 s52, s72, 6731776
    buffer_load_dwordx4 v20, s[28:31], s52 offen offset:2048 lds
    s_add_u32 m0, s71, 110592
    s_add_u32 s52, s72, 7503872
    buffer_load_dwordx4 v20, s[28:31], s52 offen lds
    s_add_u32 s52, s72, 7518208
    buffer_load_dwordx4 v20, s[28:31], s52 offen offset:2048 lds
    s_movk_i32 s53, 2432
    s_add_u32 m0, s71, 14336
    s_nop 0
    buffer_load_dwordx4 v32, s[24:27], s53 offen lds
    s_add_u32 m0, s71, 16384
    s_nop 0
    buffer_load_dwordx4 v33, s[24:27], s53 offen lds
    s_add_u32 m0, s71, 18432
    s_nop 0
    buffer_load_dwordx4 v34, s[24:27], s53 offen lds
    s_add_u32 m0, s71, 20480
    s_nop 0
    buffer_load_dwordx4 v35, s[24:27], s53 offen lds
    s_add_u32 m0, s71, 22528
    s_nop 0
    buffer_load_dwordx4 v36, s[24:27], s53 offen lds
    s_add_u32 m0, s71, 24576
    s_nop 0
    buffer_load_dwordx4 v37, s[24:27], s53 offen lds
    s_add_u32 m0, s71, 26624
    s_nop 0
    buffer_load_dwordx4 v38, s[24:27], s53 offen lds
    s_add_u32 m0, s71, 118784
    s_add_u32 s52, s72, 458752
    buffer_load_dwordx4 v20, s[28:31], s52 offen lds
    s_add_u32 s52, s72, 473088
    buffer_load_dwordx4 v20, s[28:31], s52 offen offset:2048 lds
    s_add_u32 m0, s71, 122880
    s_add_u32 s52, s72, 1245184
    buffer_load_dwordx4 v20, s[28:31], s52 offen lds
    s_add_u32 s52, s72, 1259520
    buffer_load_dwordx4 v20, s[28:31], s52 offen offset:2048 lds
    s_add_u32 m0, s71, 126976
    s_add_u32 s52, s72, 2031616
    buffer_load_dwordx4 v20, s[28:31], s52 offen lds
    s_add_u32 s52, s72, 2045952
    buffer_load_dwordx4 v20, s[28:31], s52 offen offset:2048 lds
    s_add_u32 m0, s71, 131072
    s_add_u32 s52, s72, 2818048
    buffer_load_dwordx4 v20, s[28:31], s52 offen lds
    s_add_u32 s52, s72, 2832384
    buffer_load_dwordx4 v20, s[28:31], s52 offen offset:2048 lds
    s_add_u32 m0, s71, 135168
    s_add_u32 s52, s72, 3604480
    buffer_load_dwordx4 v20, s[28:31], s52 offen lds
    s_add_u32 s52, s72, 3618816
    buffer_load_dwordx4 v20, s[28:31], s52 offen offset:2048 lds
    s_add_u32 m0, s71, 139264
    s_add_u32 s52, s72, 4390912
    buffer_load_dwordx4 v20, s[28:31], s52 offen lds
    s_add_u32 s52, s72, 4405248
    buffer_load_dwordx4 v20, s[28:31], s52 offen offset:2048 lds
    s_add_u32 m0, s71, 143360
    s_add_u32 s52, s72, 5177344
    buffer_load_dwordx4 v20, s[28:31], s52 offen lds
    s_add_u32 s52, s72, 5191680
    buffer_load_dwordx4 v20, s[28:31], s52 offen offset:2048 lds
    s_waitcnt vmcnt(21)
    s_barrier
    s_add_u32 m0, s71, 147456
    s_add_u32 s52, s72, 5963776
    buffer_load_dwordx4 v20, s[28:31], s52 offen lds
    s_add_u32 s52, s72, 5978112
    buffer_load_dwordx4 v20, s[28:31], s52 offen offset:2048 lds
    s_add_u32 m0, s71, 151552
    s_add_u32 s52, s72, 6750208
    buffer_load_dwordx4 v20, s[28:31], s52 offen lds
    s_add_u32 s52, s72, 6764544
    buffer_load_dwordx4 v20, s[28:31], s52 offen offset:2048 lds
    s_add_u32 m0, s71, 155648
    s_add_u32 s52, s72, 7536640
    buffer_load_dwordx4 v20, s[28:31], s52 offen lds
    s_add_u32 s52, s72, 7550976
    buffer_load_dwordx4 v20, s[28:31], s52 offen offset:2048 lds
    s_add_u32 m0, s71, 28672
    s_add_u32 s52, s72, 491520
    buffer_load_dwordx4 v20, s[28:31], s52 offen lds
    s_add_u32 s52, s72, 505856
    buffer_load_dwordx4 v20, s[28:31], s52 offen offset:2048 lds
    s_add_u32 m0, s71, 32768
    s_add_u32 s52, s72, 1277952
    buffer_load_dwordx4 v20, s[28:31], s52 offen lds
    s_add_u32 s52, s72, 1292288
    buffer_load_dwordx4 v20, s[28:31], s52 offen offset:2048 lds
    s_add_u32 m0, s71, 36864
    s_add_u32 s52, s72, 2064384
    buffer_load_dwordx4 v20, s[28:31], s52 offen lds
    s_add_u32 s52, s72, 2078720
    buffer_load_dwordx4 v20, s[28:31], s52 offen offset:2048 lds
    s_add_u32 m0, s71, 40960
    s_add_u32 s52, s72, 2850816
    buffer_load_dwordx4 v20, s[28:31], s52 offen lds
    s_add_u32 s52, s72, 2865152
    buffer_load_dwordx4 v20, s[28:31], s52 offen offset:2048 lds
    s_add_u32 m0, s71, 45056
    s_add_u32 s52, s72, 3637248
    buffer_load_dwordx4 v20, s[28:31], s52 offen lds
    s_add_u32 s52, s72, 3651584
    buffer_load_dwordx4 v20, s[28:31], s52 offen offset:2048 lds
    s_add_u32 m0, s71, 49152
    s_add_u32 s52, s72, 4423680
    buffer_load_dwordx4 v20, s[28:31], s52 offen lds
    s_add_u32 s52, s72, 4438016
    buffer_load_dwordx4 v20, s[28:31], s52 offen offset:2048 lds
    s_add_u32 m0, s71, 53248
    s_add_u32 s52, s72, 5210112
    buffer_load_dwordx4 v20, s[28:31], s52 offen lds
    s_add_u32 s52, s72, 5224448
    buffer_load_dwordx4 v20, s[28:31], s52 offen offset:2048 lds
    s_waitcnt vmcnt(14)
    s_barrier
    s_add_u32 m0, s71, 57344
    s_add_u32 s52, s72, 5996544
    buffer_load_dwordx4 v20, s[28:31], s52 offen lds
    s_add_u32 s52, s72, 6010880
    buffer_load_dwordx4 v20, s[28:31], s52 offen offset:2048 lds
    s_add_u32 m0, s71, 61440
    s_add_u32 s52, s72, 6782976
    buffer_load_dwordx4 v20, s[28:31], s52 offen lds
    s_add_u32 s52, s72, 6797312
    buffer_load_dwordx4 v20, s[28:31], s52 offen offset:2048 lds
    s_add_u32 m0, s71, 65536
    s_add_u32 s52, s72, 7569408
    buffer_load_dwordx4 v20, s[28:31], s52 offen lds
    s_add_u32 s52, s72, 7583744
    buffer_load_dwordx4 v20, s[28:31], s52 offen offset:2048 lds
    s_add_u32 s36, s14, 8650752
    s_addc_u32 s37, s15, 0
    s_movk_i32 s53, 0
    s_add_u32 m0, s71, 0
    s_nop 0
    buffer_load_dwordx4 v40, s[36:39], s53 offen lds
    s_add_u32 m0, s71, 2048
    s_nop 0
    buffer_load_dwordx4 v41, s[36:39], s53 offen lds
    s_add_u32 m0, s71, 4096
    s_nop 0
    buffer_load_dwordx4 v42, s[36:39], s53 offen lds
    s_add_u32 m0, s71, 6144
    s_nop 0
    buffer_load_dwordx4 v43, s[36:39], s53 offen lds
    s_add_u32 m0, s71, 8192
    s_nop 0
    buffer_load_dwordx4 v44, s[36:39], s53 offen lds
    s_add_u32 m0, s71, 10240
    s_nop 0
    buffer_load_dwordx4 v45, s[36:39], s53 offen lds
    s_add_u32 m0, s71, 12288
    s_nop 0
    buffer_load_dwordx4 v46, s[36:39], s53 offen lds
    s_add_u32 m0, s71, 73728
    s_add_u32 s52, s74, 0
    buffer_load_dwordx4 v21, s[32:35], s52 offen lds
    buffer_load_dwordx4 v21, s[32:35], s52 offen offset:2048 lds
    s_add_u32 m0, s71, 77824
    s_add_u32 s52, s74, 32768
    buffer_load_dwordx4 v21, s[32:35], s52 offen lds
    buffer_load_dwordx4 v21, s[32:35], s52 offen offset:2048 lds
    s_add_u32 m0, s71, 81920
    s_add_u32 s52, s74, 65536
    buffer_load_dwordx4 v21, s[32:35], s52 offen lds
    buffer_load_dwordx4 v21, s[32:35], s52 offen offset:2048 lds
    s_add_u32 m0, s71, 86016
    s_add_u32 s52, s74, 98304
    buffer_load_dwordx4 v21, s[32:35], s52 offen lds
    buffer_load_dwordx4 v21, s[32:35], s52 offen offset:2048 lds
    s_add_u32 m0, s71, 90112
    s_add_u32 s52, s74, 131072
    buffer_load_dwordx4 v21, s[32:35], s52 offen lds
    buffer_load_dwordx4 v21, s[32:35], s52 offen offset:2048 lds
    s_add_u32 m0, s71, 94208
    s_add_u32 s52, s74, 163840
    buffer_load_dwordx4 v21, s[32:35], s52 offen lds
    buffer_load_dwordx4 v21, s[32:35], s52 offen offset:2048 lds
    s_add_u32 m0, s71, 98304
    s_add_u32 s52, s74, 196608
    buffer_load_dwordx4 v21, s[32:35], s52 offen lds
    buffer_load_dwordx4 v21, s[32:35], s52 offen offset:2048 lds
    s_waitcnt vmcnt(21)
    s_barrier
    s_add_u32 m0, s71, 102400
    s_add_u32 s52, s74, 229376
    buffer_load_dwordx4 v21, s[32:35], s52 offen lds
    buffer_load_dwordx4 v21, s[32:35], s52 offen offset:2048 lds
    s_add_u32 m0, s71, 106496
    s_add_u32 s52, s74, 262144
    buffer_load_dwordx4 v21, s[32:35], s52 offen lds
    buffer_load_dwordx4 v21, s[32:35], s52 offen offset:2048 lds
    s_add_u32 m0, s71, 110592
    s_add_u32 s52, s74, 294912
    buffer_load_dwordx4 v21, s[32:35], s52 offen lds
    buffer_load_dwordx4 v21, s[32:35], s52 offen offset:2048 lds
    s_add_u32 m0, s71, 114688
    s_add_u32 s52, s74, 327680
    buffer_load_dwordx4 v21, s[32:35], s52 offen lds
    buffer_load_dwordx4 v21, s[32:35], s52 offen offset:2048 lds
    s_add_u32 m0, s71, 118784
    s_add_u32 s52, s74, 4096
    buffer_load_dwordx4 v21, s[32:35], s52 offen lds
    buffer_load_dwordx4 v21, s[32:35], s52 offen offset:2048 lds
    s_add_u32 m0, s71, 122880
    s_add_u32 s52, s74, 36864
    buffer_load_dwordx4 v21, s[32:35], s52 offen lds
    buffer_load_dwordx4 v21, s[32:35], s52 offen offset:2048 lds
    s_add_u32 m0, s71, 126976
    s_add_u32 s52, s74, 69632
    buffer_load_dwordx4 v21, s[32:35], s52 offen lds
    buffer_load_dwordx4 v21, s[32:35], s52 offen offset:2048 lds
    s_add_u32 m0, s71, 131072
    s_add_u32 s52, s74, 102400
    buffer_load_dwordx4 v21, s[32:35], s52 offen lds
    buffer_load_dwordx4 v21, s[32:35], s52 offen offset:2048 lds
    s_add_u32 m0, s71, 135168
    s_add_u32 s52, s74, 135168
    buffer_load_dwordx4 v21, s[32:35], s52 offen lds
    buffer_load_dwordx4 v21, s[32:35], s52 offen offset:2048 lds
    s_add_u32 m0, s71, 139264
    s_add_u32 s52, s74, 167936
    buffer_load_dwordx4 v21, s[32:35], s52 offen lds
    buffer_load_dwordx4 v21, s[32:35], s52 offen offset:2048 lds
    s_add_u32 m0, s71, 143360
    s_add_u32 s52, s74, 200704
    buffer_load_dwordx4 v21, s[32:35], s52 offen lds
    buffer_load_dwordx4 v21, s[32:35], s52 offen offset:2048 lds
    s_waitcnt vmcnt(14)
    s_barrier
    s_add_u32 m0, s71, 147456
    s_add_u32 s52, s74, 233472
    buffer_load_dwordx4 v21, s[32:35], s52 offen lds
    buffer_load_dwordx4 v21, s[32:35], s52 offen offset:2048 lds
    s_add_u32 m0, s71, 151552
    s_add_u32 s52, s74, 266240
    buffer_load_dwordx4 v21, s[32:35], s52 offen lds
    buffer_load_dwordx4 v21, s[32:35], s52 offen offset:2048 lds
    s_add_u32 m0, s71, 155648
    s_add_u32 s52, s74, 299008
    buffer_load_dwordx4 v21, s[32:35], s52 offen lds
    buffer_load_dwordx4 v21, s[32:35], s52 offen offset:2048 lds
    s_add_u32 m0, s71, 159744
    s_add_u32 s52, s74, 331776
    buffer_load_dwordx4 v21, s[32:35], s52 offen lds
    buffer_load_dwordx4 v21, s[32:35], s52 offen offset:2048 lds
    s_movk_i32 s53, 128
    s_add_u32 m0, s71, 14336
    s_nop 0
    buffer_load_dwordx4 v40, s[36:39], s53 offen lds
    s_add_u32 m0, s71, 16384
    s_nop 0
    buffer_load_dwordx4 v41, s[36:39], s53 offen lds
    s_add_u32 m0, s71, 18432
    s_nop 0
    buffer_load_dwordx4 v42, s[36:39], s53 offen lds
    s_add_u32 m0, s71, 20480
    s_nop 0
    buffer_load_dwordx4 v43, s[36:39], s53 offen lds
    s_add_u32 m0, s71, 22528
    s_nop 0
    buffer_load_dwordx4 v44, s[36:39], s53 offen lds
    s_add_u32 m0, s71, 24576
    s_nop 0
    buffer_load_dwordx4 v45, s[36:39], s53 offen lds
    s_add_u32 m0, s71, 26624
    s_nop 0
    buffer_load_dwordx4 v46, s[36:39], s53 offen lds
    s_add_u32 m0, s71, 28672
    s_add_u32 s52, s74, 8192
    buffer_load_dwordx4 v21, s[32:35], s52 offen lds
    buffer_load_dwordx4 v21, s[32:35], s52 offen offset:2048 lds
    s_add_u32 m0, s71, 32768
    s_add_u32 s52, s74, 40960
    buffer_load_dwordx4 v21, s[32:35], s52 offen lds
    buffer_load_dwordx4 v21, s[32:35], s52 offen offset:2048 lds
    s_add_u32 m0, s71, 36864
    s_add_u32 s52, s74, 73728
    buffer_load_dwordx4 v21, s[32:35], s52 offen lds
    buffer_load_dwordx4 v21, s[32:35], s52 offen offset:2048 lds
    s_add_u32 m0, s71, 40960
    s_add_u32 s52, s74, 106496
    buffer_load_dwordx4 v21, s[32:35], s52 offen lds
    buffer_load_dwordx4 v21, s[32:35], s52 offen offset:2048 lds
    s_add_u32 m0, s71, 45056
    s_add_u32 s52, s74, 139264
    buffer_load_dwordx4 v21, s[32:35], s52 offen lds
    buffer_load_dwordx4 v21, s[32:35], s52 offen offset:2048 lds
    s_add_u32 m0, s71, 49152
    s_add_u32 s52, s74, 172032
    buffer_load_dwordx4 v21, s[32:35], s52 offen lds
    buffer_load_dwordx4 v21, s[32:35], s52 offen offset:2048 lds
    s_add_u32 m0, s71, 53248
    s_add_u32 s52, s74, 204800
    buffer_load_dwordx4 v21, s[32:35], s52 offen lds
    buffer_load_dwordx4 v21, s[32:35], s52 offen offset:2048 lds
    s_waitcnt vmcnt(21)
    s_barrier
    s_add_u32 m0, s71, 57344
    s_add_u32 s52, s74, 237568
    buffer_load_dwordx4 v21, s[32:35], s52 offen lds
    buffer_load_dwordx4 v21, s[32:35], s52 offen offset:2048 lds
    s_add_u32 m0, s71, 61440
    s_add_u32 s52, s74, 270336
    buffer_load_dwordx4 v21, s[32:35], s52 offen lds
    buffer_load_dwordx4 v21, s[32:35], s52 offen offset:2048 lds
    s_add_u32 m0, s71, 65536
    s_add_u32 s52, s74, 303104
    buffer_load_dwordx4 v21, s[32:35], s52 offen lds
    buffer_load_dwordx4 v21, s[32:35], s52 offen offset:2048 lds
    s_add_u32 m0, s71, 69632
    s_add_u32 s52, s74, 335872
    buffer_load_dwordx4 v21, s[32:35], s52 offen lds
    buffer_load_dwordx4 v21, s[32:35], s52 offen offset:2048 lds
    s_add_u32 m0, s71, 73728
    s_add_u32 s52, s74, 12288
    buffer_load_dwordx4 v21, s[32:35], s52 offen lds
    buffer_load_dwordx4 v21, s[32:35], s52 offen offset:2048 lds
    s_add_u32 m0, s71, 77824
    s_add_u32 s52, s74, 45056
    buffer_load_dwordx4 v21, s[32:35], s52 offen lds
    buffer_load_dwordx4 v21, s[32:35], s52 offen offset:2048 lds
    s_add_u32 m0, s71, 81920
    s_add_u32 s52, s74, 77824
    buffer_load_dwordx4 v21, s[32:35], s52 offen lds
    buffer_load_dwordx4 v21, s[32:35], s52 offen offset:2048 lds
    s_add_u32 m0, s71, 86016
    s_add_u32 s52, s74, 110592
    buffer_load_dwordx4 v21, s[32:35], s52 offen lds
    buffer_load_dwordx4 v21, s[32:35], s52 offen offset:2048 lds
    s_add_u32 m0, s71, 90112
    s_add_u32 s52, s74, 143360
    buffer_load_dwordx4 v21, s[32:35], s52 offen lds
    buffer_load_dwordx4 v21, s[32:35], s52 offen offset:2048 lds
    s_add_u32 m0, s71, 94208
    s_add_u32 s52, s74, 176128
    buffer_load_dwordx4 v21, s[32:35], s52 offen lds
    buffer_load_dwordx4 v21, s[32:35], s52 offen offset:2048 lds
    s_add_u32 m0, s71, 98304
    s_add_u32 s52, s74, 208896
    buffer_load_dwordx4 v21, s[32:35], s52 offen lds
    buffer_load_dwordx4 v21, s[32:35], s52 offen offset:2048 lds
    s_add_u32 m0, s71, 102400
    s_add_u32 s52, s74, 241664
    buffer_load_dwordx4 v21, s[32:35], s52 offen lds
    buffer_load_dwordx4 v21, s[32:35], s52 offen offset:2048 lds
    s_waitcnt vmcnt(16)
    s_barrier
    s_add_u32 m0, s71, 106496
    s_add_u32 s52, s74, 274432
    buffer_load_dwordx4 v21, s[32:35], s52 offen lds
    buffer_load_dwordx4 v21, s[32:35], s52 offen offset:2048 lds
    s_add_u32 m0, s71, 110592
    s_add_u32 s52, s74, 307200
    buffer_load_dwordx4 v21, s[32:35], s52 offen lds
    buffer_load_dwordx4 v21, s[32:35], s52 offen offset:2048 lds
    s_add_u32 m0, s71, 114688
    s_add_u32 s52, s74, 339968
    buffer_load_dwordx4 v21, s[32:35], s52 offen lds
    buffer_load_dwordx4 v21, s[32:35], s52 offen offset:2048 lds
    s_movk_i32 s53, 256
    s_add_u32 m0, s71, 0
    s_nop 0
    buffer_load_dwordx4 v40, s[36:39], s53 offen lds
    s_add_u32 m0, s71, 2048
    s_nop 0
    buffer_load_dwordx4 v41, s[36:39], s53 offen lds
    s_add_u32 m0, s71, 4096
    s_nop 0
    buffer_load_dwordx4 v42, s[36:39], s53 offen lds
    s_add_u32 m0, s71, 6144
    s_nop 0
    buffer_load_dwordx4 v43, s[36:39], s53 offen lds
    s_add_u32 m0, s71, 8192
    s_nop 0
    buffer_load_dwordx4 v44, s[36:39], s53 offen lds
    s_add_u32 m0, s71, 10240
    s_nop 0
    buffer_load_dwordx4 v45, s[36:39], s53 offen lds
    s_add_u32 m0, s71, 12288
    s_nop 0
    buffer_load_dwordx4 v46, s[36:39], s53 offen lds
    s_add_u32 m0, s71, 118784
    s_add_u32 s52, s74, 16384
    buffer_load_dwordx4 v21, s[32:35], s52 offen lds
    buffer_load_dwordx4 v21, s[32:35], s52 offen offset:2048 lds
    s_add_u32 m0, s71, 122880
    s_add_u32 s52, s74, 49152
    buffer_load_dwordx4 v21, s[32:35], s52 offen lds
    buffer_load_dwordx4 v21, s[32:35], s52 offen offset:2048 lds
    s_add_u32 m0, s71, 126976
    s_add_u32 s52, s74, 81920
    buffer_load_dwordx4 v21, s[32:35], s52 offen lds
    buffer_load_dwordx4 v21, s[32:35], s52 offen offset:2048 lds
    s_add_u32 m0, s71, 131072
    s_add_u32 s52, s74, 114688
    buffer_load_dwordx4 v21, s[32:35], s52 offen lds
    buffer_load_dwordx4 v21, s[32:35], s52 offen offset:2048 lds
    s_add_u32 m0, s71, 135168
    s_add_u32 s52, s74, 147456
    buffer_load_dwordx4 v21, s[32:35], s52 offen lds
    buffer_load_dwordx4 v21, s[32:35], s52 offen offset:2048 lds
    s_add_u32 m0, s71, 139264
    s_add_u32 s52, s74, 180224
    buffer_load_dwordx4 v21, s[32:35], s52 offen lds
    buffer_load_dwordx4 v21, s[32:35], s52 offen offset:2048 lds
    s_add_u32 m0, s71, 143360
    s_add_u32 s52, s74, 212992
    buffer_load_dwordx4 v21, s[32:35], s52 offen lds
    buffer_load_dwordx4 v21, s[32:35], s52 offen offset:2048 lds
    s_add_u32 m0, s71, 147456
    s_add_u32 s52, s74, 245760
    buffer_load_dwordx4 v21, s[32:35], s52 offen lds
    buffer_load_dwordx4 v21, s[32:35], s52 offen offset:2048 lds
    s_waitcnt vmcnt(23)
    s_barrier
    s_add_u32 m0, s71, 151552
    s_add_u32 s52, s74, 278528
    buffer_load_dwordx4 v21, s[32:35], s52 offen lds
    buffer_load_dwordx4 v21, s[32:35], s52 offen offset:2048 lds
    s_add_u32 m0, s71, 155648
    s_add_u32 s52, s74, 311296
    buffer_load_dwordx4 v21, s[32:35], s52 offen lds
    buffer_load_dwordx4 v21, s[32:35], s52 offen offset:2048 lds
    s_add_u32 m0, s71, 159744
    s_add_u32 s52, s74, 344064
    buffer_load_dwordx4 v21, s[32:35], s52 offen lds
    buffer_load_dwordx4 v21, s[32:35], s52 offen offset:2048 lds
    s_add_u32 m0, s71, 28672
    s_add_u32 s52, s74, 20480
    buffer_load_dwordx4 v21, s[32:35], s52 offen lds
    buffer_load_dwordx4 v21, s[32:35], s52 offen offset:2048 lds
    s_add_u32 m0, s71, 32768
    s_add_u32 s52, s74, 53248
    buffer_load_dwordx4 v21, s[32:35], s52 offen lds
    buffer_load_dwordx4 v21, s[32:35], s52 offen offset:2048 lds
    s_add_u32 m0, s71, 36864
    s_add_u32 s52, s74, 86016
    buffer_load_dwordx4 v21, s[32:35], s52 offen lds
    buffer_load_dwordx4 v21, s[32:35], s52 offen offset:2048 lds
    s_add_u32 m0, s71, 40960
    s_add_u32 s52, s74, 118784
    buffer_load_dwordx4 v21, s[32:35], s52 offen lds
    buffer_load_dwordx4 v21, s[32:35], s52 offen offset:2048 lds
    s_add_u32 m0, s71, 45056
    s_add_u32 s52, s74, 151552
    buffer_load_dwordx4 v21, s[32:35], s52 offen lds
    buffer_load_dwordx4 v21, s[32:35], s52 offen offset:2048 lds
    s_add_u32 m0, s71, 49152
    s_add_u32 s52, s74, 184320
    buffer_load_dwordx4 v21, s[32:35], s52 offen lds
    buffer_load_dwordx4 v21, s[32:35], s52 offen offset:2048 lds
    s_add_u32 m0, s71, 53248
    s_add_u32 s52, s74, 217088
    buffer_load_dwordx4 v21, s[32:35], s52 offen lds
    buffer_load_dwordx4 v21, s[32:35], s52 offen offset:2048 lds
    s_add_u32 m0, s71, 57344
    s_add_u32 s52, s74, 249856
    buffer_load_dwordx4 v21, s[32:35], s52 offen lds
    buffer_load_dwordx4 v21, s[32:35], s52 offen offset:2048 lds
    s_waitcnt vmcnt(16)
    s_barrier
    s_add_u32 m0, s71, 61440
    s_add_u32 s52, s74, 282624
    buffer_load_dwordx4 v21, s[32:35], s52 offen lds
    buffer_load_dwordx4 v21, s[32:35], s52 offen offset:2048 lds
    s_add_u32 m0, s71, 65536
    s_add_u32 s52, s74, 315392
    buffer_load_dwordx4 v21, s[32:35], s52 offen lds
    buffer_load_dwordx4 v21, s[32:35], s52 offen offset:2048 lds
    s_add_u32 m0, s71, 69632
    s_add_u32 s52, s74, 348160
    buffer_load_dwordx4 v21, s[32:35], s52 offen lds
    buffer_load_dwordx4 v21, s[32:35], s52 offen offset:2048 lds
    s_movk_i32 s53, 384
    s_add_u32 m0, s71, 14336
    s_nop 0
    buffer_load_dwordx4 v40, s[36:39], s53 offen lds
    s_add_u32 m0, s71, 16384
    s_nop 0
    buffer_load_dwordx4 v41, s[36:39], s53 offen lds
    s_add_u32 m0, s71, 18432
    s_nop 0
    buffer_load_dwordx4 v42, s[36:39], s53 offen lds
    s_add_u32 m0, s71, 20480
    s_nop 0
    buffer_load_dwordx4 v43, s[36:39], s53 offen lds
    s_add_u32 m0, s71, 22528
    s_nop 0
    buffer_load_dwordx4 v44, s[36:39], s53 offen lds
    s_add_u32 m0, s71, 24576
    s_nop 0
    buffer_load_dwordx4 v45, s[36:39], s53 offen lds
    s_add_u32 m0, s71, 26624
    s_nop 0
    buffer_load_dwordx4 v46, s[36:39], s53 offen lds
    s_add_u32 m0, s71, 73728
    s_add_u32 s52, s74, 24576
    buffer_load_dwordx4 v21, s[32:35], s52 offen lds
    buffer_load_dwordx4 v21, s[32:35], s52 offen offset:2048 lds
    s_add_u32 m0, s71, 77824
    s_add_u32 s52, s74, 57344
    buffer_load_dwordx4 v21, s[32:35], s52 offen lds
    buffer_load_dwordx4 v21, s[32:35], s52 offen offset:2048 lds
    s_add_u32 m0, s71, 81920
    s_add_u32 s52, s74, 90112
    buffer_load_dwordx4 v21, s[32:35], s52 offen lds
    buffer_load_dwordx4 v21, s[32:35], s52 offen offset:2048 lds
    s_add_u32 m0, s71, 86016
    s_add_u32 s52, s74, 122880
    buffer_load_dwordx4 v21, s[32:35], s52 offen lds
    buffer_load_dwordx4 v21, s[32:35], s52 offen offset:2048 lds
    s_add_u32 m0, s71, 90112
    s_add_u32 s52, s74, 155648
    buffer_load_dwordx4 v21, s[32:35], s52 offen lds
    buffer_load_dwordx4 v21, s[32:35], s52 offen offset:2048 lds
    s_add_u32 m0, s71, 94208
    s_add_u32 s52, s74, 188416
    buffer_load_dwordx4 v21, s[32:35], s52 offen lds
    buffer_load_dwordx4 v21, s[32:35], s52 offen offset:2048 lds
    s_add_u32 m0, s71, 98304
    s_add_u32 s52, s74, 221184
    buffer_load_dwordx4 v21, s[32:35], s52 offen lds
    buffer_load_dwordx4 v21, s[32:35], s52 offen offset:2048 lds
    s_add_u32 m0, s71, 102400
    s_add_u32 s52, s74, 253952
    buffer_load_dwordx4 v21, s[32:35], s52 offen lds
    buffer_load_dwordx4 v21, s[32:35], s52 offen offset:2048 lds
    s_waitcnt vmcnt(23)
    s_barrier
    s_add_u32 m0, s71, 106496
    s_add_u32 s52, s74, 286720
    buffer_load_dwordx4 v21, s[32:35], s52 offen lds
    buffer_load_dwordx4 v21, s[32:35], s52 offen offset:2048 lds
    s_add_u32 m0, s71, 110592
    s_add_u32 s52, s74, 319488
    buffer_load_dwordx4 v21, s[32:35], s52 offen lds
    buffer_load_dwordx4 v21, s[32:35], s52 offen offset:2048 lds
    s_add_u32 m0, s71, 114688
    s_add_u32 s52, s74, 352256
    buffer_load_dwordx4 v21, s[32:35], s52 offen lds
    buffer_load_dwordx4 v21, s[32:35], s52 offen offset:2048 lds
    s_add_u32 m0, s71, 118784
    s_add_u32 s52, s74, 28672
    buffer_load_dwordx4 v21, s[32:35], s52 offen lds
    buffer_load_dwordx4 v21, s[32:35], s52 offen offset:2048 lds
    s_add_u32 m0, s71, 122880
    s_add_u32 s52, s74, 61440
    buffer_load_dwordx4 v21, s[32:35], s52 offen lds
    buffer_load_dwordx4 v21, s[32:35], s52 offen offset:2048 lds
    s_add_u32 m0, s71, 126976
    s_add_u32 s52, s74, 94208
    buffer_load_dwordx4 v21, s[32:35], s52 offen lds
    buffer_load_dwordx4 v21, s[32:35], s52 offen offset:2048 lds
    s_add_u32 m0, s71, 131072
    s_add_u32 s52, s74, 126976
    buffer_load_dwordx4 v21, s[32:35], s52 offen lds
    buffer_load_dwordx4 v21, s[32:35], s52 offen offset:2048 lds
    s_add_u32 m0, s71, 135168
    s_add_u32 s52, s74, 159744
    buffer_load_dwordx4 v21, s[32:35], s52 offen lds
    buffer_load_dwordx4 v21, s[32:35], s52 offen offset:2048 lds
    s_add_u32 m0, s71, 139264
    s_add_u32 s52, s74, 192512
    buffer_load_dwordx4 v21, s[32:35], s52 offen lds
    buffer_load_dwordx4 v21, s[32:35], s52 offen offset:2048 lds
    s_add_u32 m0, s71, 143360
    s_add_u32 s52, s74, 225280
    buffer_load_dwordx4 v21, s[32:35], s52 offen lds
    buffer_load_dwordx4 v21, s[32:35], s52 offen offset:2048 lds
    s_add_u32 m0, s71, 147456
    s_add_u32 s52, s74, 258048
    buffer_load_dwordx4 v21, s[32:35], s52 offen lds
    buffer_load_dwordx4 v21, s[32:35], s52 offen offset:2048 lds
    s_waitcnt vmcnt(16)
    s_barrier
    s_add_u32 m0, s71, 151552
    s_add_u32 s52, s74, 290816
    buffer_load_dwordx4 v21, s[32:35], s52 offen lds
    buffer_load_dwordx4 v21, s[32:35], s52 offen offset:2048 lds
    s_add_u32 m0, s71, 155648
    s_add_u32 s52, s74, 323584
    buffer_load_dwordx4 v21, s[32:35], s52 offen lds
    buffer_load_dwordx4 v21, s[32:35], s52 offen offset:2048 lds
    s_add_u32 m0, s71, 159744
    s_add_u32 s52, s74, 356352
    buffer_load_dwordx4 v21, s[32:35], s52 offen lds
    buffer_load_dwordx4 v21, s[32:35], s52 offen offset:2048 lds
    s_add_u32 s36, s14, 10027008
    s_addc_u32 s37, s15, 0
    s_movk_i32 s53, 0
    s_add_u32 m0, s71, 0
    s_nop 0
    buffer_load_dwordx4 v40, s[36:39], s53 offen lds
    s_add_u32 m0, s71, 2048
    s_nop 0
    buffer_load_dwordx4 v41, s[36:39], s53 offen lds
    s_add_u32 m0, s71, 4096
    s_nop 0
    buffer_load_dwordx4 v42, s[36:39], s53 offen lds
    s_add_u32 m0, s71, 6144
    s_nop 0
    buffer_load_dwordx4 v43, s[36:39], s53 offen lds
    s_add_u32 m0, s71, 8192
    s_nop 0
    buffer_load_dwordx4 v44, s[36:39], s53 offen lds
    s_add_u32 m0, s71, 10240
    s_nop 0
    buffer_load_dwordx4 v45, s[36:39], s53 offen lds
    s_add_u32 m0, s71, 12288
    s_nop 0
    buffer_load_dwordx4 v46, s[36:39], s53 offen lds
    s_add_u32 m0, s71, 28672
    s_add_u32 s52, s74, 360448
    buffer_load_dwordx4 v21, s[32:35], s52 offen lds
    buffer_load_dwordx4 v21, s[32:35], s52 offen offset:2048 lds
    s_add_u32 m0, s71, 32768
    s_add_u32 s52, s74, 393216
    buffer_load_dwordx4 v21, s[32:35], s52 offen lds
    buffer_load_dwordx4 v21, s[32:35], s52 offen offset:2048 lds
    s_add_u32 m0, s71, 36864
    s_add_u32 s52, s74, 425984
    buffer_load_dwordx4 v21, s[32:35], s52 offen lds
    buffer_load_dwordx4 v21, s[32:35], s52 offen offset:2048 lds
    s_add_u32 m0, s71, 40960
    s_add_u32 s52, s74, 458752
    buffer_load_dwordx4 v21, s[32:35], s52 offen lds
    buffer_load_dwordx4 v21, s[32:35], s52 offen offset:2048 lds
    s_add_u32 m0, s71, 45056
    s_add_u32 s52, s74, 491520
    buffer_load_dwordx4 v21, s[32:35], s52 offen lds
    buffer_load_dwordx4 v21, s[32:35], s52 offen offset:2048 lds
    s_add_u32 m0, s71, 49152
    s_add_u32 s52, s74, 524288
    buffer_load_dwordx4 v21, s[32:35], s52 offen lds
    buffer_load_dwordx4 v21, s[32:35], s52 offen offset:2048 lds
    s_add_u32 m0, s71, 53248
    s_add_u32 s52, s74, 557056
    buffer_load_dwordx4 v21, s[32:35], s52 offen lds
    buffer_load_dwordx4 v21, s[32:35], s52 offen offset:2048 lds
    s_add_u32 m0, s71, 57344
    s_add_u32 s52, s74, 589824
    buffer_load_dwordx4 v21, s[32:35], s52 offen lds
    buffer_load_dwordx4 v21, s[32:35], s52 offen offset:2048 lds
    s_waitcnt vmcnt(23)
    s_barrier
    s_add_u32 m0, s71, 61440
    s_add_u32 s52, s74, 622592
    buffer_load_dwordx4 v21, s[32:35], s52 offen lds
    buffer_load_dwordx4 v21, s[32:35], s52 offen offset:2048 lds
    s_add_u32 m0, s71, 65536
    s_add_u32 s52, s74, 655360
    buffer_load_dwordx4 v21, s[32:35], s52 offen lds
    buffer_load_dwordx4 v21, s[32:35], s52 offen offset:2048 lds
    s_add_u32 m0, s71, 69632
    s_add_u32 s52, s74, 688128
    buffer_load_dwordx4 v21, s[32:35], s52 offen lds
    buffer_load_dwordx4 v21, s[32:35], s52 offen offset:2048 lds
    s_add_u32 m0, s71, 73728
    s_add_u32 s52, s74, 364544
    buffer_load_dwordx4 v21, s[32:35], s52 offen lds
    buffer_load_dwordx4 v21, s[32:35], s52 offen offset:2048 lds
    s_add_u32 m0, s71, 77824
    s_add_u32 s52, s74, 397312
    buffer_load_dwordx4 v21, s[32:35], s52 offen lds
    buffer_load_dwordx4 v21, s[32:35], s52 offen offset:2048 lds
    s_add_u32 m0, s71, 81920
    s_add_u32 s52, s74, 430080
    buffer_load_dwordx4 v21, s[32:35], s52 offen lds
    buffer_load_dwordx4 v21, s[32:35], s52 offen offset:2048 lds
    s_add_u32 m0, s71, 86016
    s_add_u32 s52, s74, 462848
    buffer_load_dwordx4 v21, s[32:35], s52 offen lds
    buffer_load_dwordx4 v21, s[32:35], s52 offen offset:2048 lds
    s_add_u32 m0, s71, 90112
    s_add_u32 s52, s74, 495616
    buffer_load_dwordx4 v21, s[32:35], s52 offen lds
    buffer_load_dwordx4 v21, s[32:35], s52 offen offset:2048 lds
    s_add_u32 m0, s71, 94208
    s_add_u32 s52, s74, 528384
    buffer_load_dwordx4 v21, s[32:35], s52 offen lds
    buffer_load_dwordx4 v21, s[32:35], s52 offen offset:2048 lds
    s_add_u32 m0, s71, 98304
    s_add_u32 s52, s74, 561152
    buffer_load_dwordx4 v21, s[32:35], s52 offen lds
    buffer_load_dwordx4 v21, s[32:35], s52 offen offset:2048 lds
    s_add_u32 m0, s71, 102400
    s_add_u32 s52, s74, 593920
    buffer_load_dwordx4 v21, s[32:35], s52 offen lds
    buffer_load_dwordx4 v21, s[32:35], s52 offen offset:2048 lds
    s_lshl_b32 s67, s17, 17
    s_sub_u32 s56, s16, 4
    s_lshl_b32 s56, s56, 15
    s_add_u32 s67, s67, s56
    s_add_u32 s67, s67, 23068672
    v_and_b32 v62, 63, v0
    v_lshlrev_b32 v62, 4, v62
    s_waitcnt vmcnt(16)
    s_barrier
    s_add_u32 m0, s71, 106496
    s_add_u32 s52, s74, 626688
    buffer_load_dwordx4 v21, s[32:35], s52 offen lds
    buffer_load_dwordx4 v21, s[32:35], s52 offen offset:2048 lds
    s_add_u32 m0, s71, 110592
    s_add_u32 s52, s74, 659456
    buffer_load_dwordx4 v21, s[32:35], s52 offen lds
    buffer_load_dwordx4 v21, s[32:35], s52 offen offset:2048 lds
    s_add_u32 m0, s71, 114688
    s_add_u32 s52, s74, 692224
    buffer_load_dwordx4 v21, s[32:35], s52 offen lds
    buffer_load_dwordx4 v21, s[32:35], s52 offen offset:2048 lds
    s_movk_i32 s53, 128
    s_add_u32 m0, s71, 14336
    s_nop 0
    buffer_load_dwordx4 v40, s[36:39], s53 offen lds
    s_add_u32 m0, s71, 16384
    s_nop 0
    buffer_load_dwordx4 v41, s[36:39], s53 offen lds
    s_add_u32 m0, s71, 18432
    s_nop 0
    buffer_load_dwordx4 v42, s[36:39], s53 offen lds
    s_add_u32 m0, s71, 20480
    s_nop 0
    buffer_load_dwordx4 v43, s[36:39], s53 offen lds
    s_add_u32 m0, s71, 22528
    s_nop 0
    buffer_load_dwordx4 v44, s[36:39], s53 offen lds
    s_add_u32 m0, s71, 24576
    s_nop 0
    buffer_load_dwordx4 v45, s[36:39], s53 offen lds
    s_add_u32 m0, s71, 26624
    s_nop 0
    buffer_load_dwordx4 v46, s[36:39], s53 offen lds
    s_add_u32 m0, s71, 118784
    s_add_u32 s52, s74, 368640
    buffer_load_dwordx4 v21, s[32:35], s52 offen lds
    buffer_load_dwordx4 v21, s[32:35], s52 offen offset:2048 lds
    s_add_u32 m0, s71, 122880
    s_add_u32 s52, s74, 401408
    buffer_load_dwordx4 v21, s[32:35], s52 offen lds
    buffer_load_dwordx4 v21, s[32:35], s52 offen offset:2048 lds
    s_add_u32 m0, s71, 126976
    s_add_u32 s52, s74, 434176
    buffer_load_dwordx4 v21, s[32:35], s52 offen lds
    buffer_load_dwordx4 v21, s[32:35], s52 offen offset:2048 lds
    s_add_u32 m0, s71, 131072
    s_add_u32 s52, s74, 466944
    buffer_load_dwordx4 v21, s[32:35], s52 offen lds
    buffer_load_dwordx4 v21, s[32:35], s52 offen offset:2048 lds
    s_add_u32 m0, s71, 135168
    s_add_u32 s52, s74, 499712
    buffer_load_dwordx4 v21, s[32:35], s52 offen lds
    buffer_load_dwordx4 v21, s[32:35], s52 offen offset:2048 lds
    s_add_u32 m0, s71, 139264
    s_add_u32 s52, s74, 532480
    buffer_load_dwordx4 v21, s[32:35], s52 offen lds
    buffer_load_dwordx4 v21, s[32:35], s52 offen offset:2048 lds
    s_add_u32 m0, s71, 143360
    s_add_u32 s52, s74, 565248
    buffer_load_dwordx4 v21, s[32:35], s52 offen lds
    buffer_load_dwordx4 v21, s[32:35], s52 offen offset:2048 lds
    s_add_u32 m0, s71, 147456
    s_add_u32 s52, s74, 598016
    buffer_load_dwordx4 v21, s[32:35], s52 offen lds
    buffer_load_dwordx4 v21, s[32:35], s52 offen offset:2048 lds
    s_add_u32 s56, s67, 0
    buffer_load_dwordx4 v[128:131], v62, s[0:3], s56 offen
    s_add_u32 s56, s67, 1024
    buffer_load_dwordx4 v[132:135], v62, s[0:3], s56 offen
    s_waitcnt vmcnt(25)
    s_barrier
    s_add_u32 m0, s71, 151552
    s_add_u32 s52, s74, 630784
    buffer_load_dwordx4 v21, s[32:35], s52 offen lds
    buffer_load_dwordx4 v21, s[32:35], s52 offen offset:2048 lds
    s_add_u32 m0, s71, 155648
    s_add_u32 s52, s74, 663552
    buffer_load_dwordx4 v21, s[32:35], s52 offen lds
    buffer_load_dwordx4 v21, s[32:35], s52 offen offset:2048 lds
    s_add_u32 m0, s71, 159744
    s_add_u32 s52, s74, 696320
    buffer_load_dwordx4 v21, s[32:35], s52 offen lds
    buffer_load_dwordx4 v21, s[32:35], s52 offen offset:2048 lds
    s_add_u32 m0, s71, 28672
    s_add_u32 s52, s74, 372736
    buffer_load_dwordx4 v21, s[32:35], s52 offen lds
    buffer_load_dwordx4 v21, s[32:35], s52 offen offset:2048 lds
    s_add_u32 m0, s71, 32768
    s_add_u32 s52, s74, 405504
    buffer_load_dwordx4 v21, s[32:35], s52 offen lds
    buffer_load_dwordx4 v21, s[32:35], s52 offen offset:2048 lds
    s_add_u32 m0, s71, 36864
    s_add_u32 s52, s74, 438272
    buffer_load_dwordx4 v21, s[32:35], s52 offen lds
    buffer_load_dwordx4 v21, s[32:35], s52 offen offset:2048 lds
    s_add_u32 m0, s71, 40960
    s_add_u32 s52, s74, 471040
    buffer_load_dwordx4 v21, s[32:35], s52 offen lds
    buffer_load_dwordx4 v21, s[32:35], s52 offen offset:2048 lds
    s_add_u32 m0, s71, 45056
    s_add_u32 s52, s74, 503808
    buffer_load_dwordx4 v21, s[32:35], s52 offen lds
    buffer_load_dwordx4 v21, s[32:35], s52 offen offset:2048 lds
    s_add_u32 m0, s71, 49152
    s_add_u32 s52, s74, 536576
    buffer_load_dwordx4 v21, s[32:35], s52 offen lds
    buffer_load_dwordx4 v21, s[32:35], s52 offen offset:2048 lds
    s_add_u32 m0, s71, 53248
    s_add_u32 s52, s74, 569344
    buffer_load_dwordx4 v21, s[32:35], s52 offen lds
    buffer_load_dwordx4 v21, s[32:35], s52 offen offset:2048 lds
    s_add_u32 m0, s71, 57344
    s_add_u32 s52, s74, 602112
    buffer_load_dwordx4 v21, s[32:35], s52 offen lds
    buffer_load_dwordx4 v21, s[32:35], s52 offen offset:2048 lds
    s_add_u32 s56, s67, 2048
    buffer_load_dwordx4 v[136:139], v62, s[0:3], s56 offen
    s_add_u32 s56, s67, 3072
    buffer_load_dwordx4 v[140:143], v62, s[0:3], s56 offen
    s_waitcnt vmcnt(18)
    s_barrier
    s_add_u32 m0, s71, 61440
    s_add_u32 s52, s74, 634880
    buffer_load_dwordx4 v21, s[32:35], s52 offen lds
    buffer_load_dwordx4 v21, s[32:35], s52 offen offset:2048 lds
    s_add_u32 m0, s71, 65536
    s_add_u32 s52, s74, 667648
    buffer_load_dwordx4 v21, s[32:35], s52 offen lds
    buffer_load_dwordx4 v21, s[32:35], s52 offen offset:2048 lds
    s_add_u32 m0, s71, 69632
    s_add_u32 s52, s74, 700416
    buffer_load_dwordx4 v21, s[32:35], s52 offen lds
    buffer_load_dwordx4 v21, s[32:35], s52 offen offset:2048 lds
    s_movk_i32 s53, 256
    s_add_u32 m0, s71, 0
    s_nop 0
    buffer_load_dwordx4 v40, s[36:39], s53 offen lds
    s_add_u32 m0, s71, 2048
    s_nop 0
    buffer_load_dwordx4 v41, s[36:39], s53 offen lds
    s_add_u32 m0, s71, 4096
    s_nop 0
    buffer_load_dwordx4 v42, s[36:39], s53 offen lds
    s_add_u32 m0, s71, 6144
    s_nop 0
    buffer_load_dwordx4 v43, s[36:39], s53 offen lds
    s_add_u32 m0, s71, 8192
    s_nop 0
    buffer_load_dwordx4 v44, s[36:39], s53 offen lds
    s_add_u32 m0, s71, 10240
    s_nop 0
    buffer_load_dwordx4 v45, s[36:39], s53 offen lds
    s_add_u32 m0, s71, 12288
    s_nop 0
    buffer_load_dwordx4 v46, s[36:39], s53 offen lds
    s_add_u32 m0, s71, 73728
    s_add_u32 s52, s74, 376832
    buffer_load_dwordx4 v21, s[32:35], s52 offen lds
    buffer_load_dwordx4 v21, s[32:35], s52 offen offset:2048 lds
    s_add_u32 m0, s71, 77824
    s_add_u32 s52, s74, 409600
    buffer_load_dwordx4 v21, s[32:35], s52 offen lds
    buffer_load_dwordx4 v21, s[32:35], s52 offen offset:2048 lds
    s_add_u32 m0, s71, 81920
    s_add_u32 s52, s74, 442368
    buffer_load_dwordx4 v21, s[32:35], s52 offen lds
    buffer_load_dwordx4 v21, s[32:35], s52 offen offset:2048 lds
    s_add_u32 m0, s71, 86016
    s_add_u32 s52, s74, 475136
    buffer_load_dwordx4 v21, s[32:35], s52 offen lds
    buffer_load_dwordx4 v21, s[32:35], s52 offen offset:2048 lds
    s_add_u32 m0, s71, 90112
    s_add_u32 s52, s74, 507904
    buffer_load_dwordx4 v21, s[32:35], s52 offen lds
    buffer_load_dwordx4 v21, s[32:35], s52 offen offset:2048 lds
    s_add_u32 m0, s71, 94208
    s_add_u32 s52, s74, 540672
    buffer_load_dwordx4 v21, s[32:35], s52 offen lds
    buffer_load_dwordx4 v21, s[32:35], s52 offen offset:2048 lds
    s_add_u32 m0, s71, 98304
    s_add_u32 s52, s74, 573440
    buffer_load_dwordx4 v21, s[32:35], s52 offen lds
    buffer_load_dwordx4 v21, s[32:35], s52 offen offset:2048 lds
    s_add_u32 m0, s71, 102400
    s_add_u32 s52, s74, 606208
    buffer_load_dwordx4 v21, s[32:35], s52 offen lds
    buffer_load_dwordx4 v21, s[32:35], s52 offen offset:2048 lds
    s_add_u32 s56, s67, 4096
    buffer_load_dwordx4 v[144:147], v62, s[0:3], s56 offen
    s_add_u32 s56, s67, 5120
    buffer_load_dwordx4 v[148:151], v62, s[0:3], s56 offen
    s_waitcnt vmcnt(25)
    s_barrier
    s_add_u32 m0, s71, 106496
    s_add_u32 s52, s74, 638976
    buffer_load_dwordx4 v21, s[32:35], s52 offen lds
    buffer_load_dwordx4 v21, s[32:35], s52 offen offset:2048 lds
    s_add_u32 m0, s71, 110592
    s_add_u32 s52, s74, 671744
    buffer_load_dwordx4 v21, s[32:35], s52 offen lds
    buffer_load_dwordx4 v21, s[32:35], s52 offen offset:2048 lds
    s_add_u32 m0, s71, 114688
    s_add_u32 s52, s74, 704512
    buffer_load_dwordx4 v21, s[32:35], s52 offen lds
    buffer_load_dwordx4 v21, s[32:35], s52 offen offset:2048 lds
    s_add_u32 m0, s71, 118784
    s_add_u32 s52, s74, 380928
    buffer_load_dwordx4 v21, s[32:35], s52 offen lds
    buffer_load_dwordx4 v21, s[32:35], s52 offen offset:2048 lds
    s_add_u32 m0, s71, 122880
    s_add_u32 s52, s74, 413696
    buffer_load_dwordx4 v21, s[32:35], s52 offen lds
    buffer_load_dwordx4 v21, s[32:35], s52 offen offset:2048 lds
    s_add_u32 m0, s71, 126976
    s_add_u32 s52, s74, 446464
    buffer_load_dwordx4 v21, s[32:35], s52 offen lds
    buffer_load_dwordx4 v21, s[32:35], s52 offen offset:2048 lds
    s_add_u32 m0, s71, 131072
    s_add_u32 s52, s74, 479232
    buffer_load_dwordx4 v21, s[32:35], s52 offen lds
    buffer_load_dwordx4 v21, s[32:35], s52 offen offset:2048 lds
    s_add_u32 m0, s71, 135168
    s_add_u32 s52, s74, 512000
    buffer_load_dwordx4 v21, s[32:35], s52 offen lds
    buffer_load_dwordx4 v21, s[32:35], s52 offen offset:2048 lds
    s_add_u32 m0, s71, 139264
    s_add_u32 s52, s74, 544768
    buffer_load_dwordx4 v21, s[32:35], s52 offen lds
    buffer_load_dwordx4 v21, s[32:35], s52 offen offset:2048 lds
    s_add_u32 m0, s71, 143360
    s_add_u32 s52, s74, 577536
    buffer_load_dwordx4 v21, s[32:35], s52 offen lds
    buffer_load_dwordx4 v21, s[32:35], s52 offen offset:2048 lds
    s_add_u32 m0, s71, 147456
    s_add_u32 s52, s74, 610304
    buffer_load_dwordx4 v21, s[32:35], s52 offen lds
    buffer_load_dwordx4 v21, s[32:35], s52 offen offset:2048 lds
    s_add_u32 s56, s67, 6144
    buffer_load_dwordx4 v[152:155], v62, s[0:3], s56 offen
    s_add_u32 s56, s67, 7168
    buffer_load_dwordx4 v[156:159], v62, s[0:3], s56 offen
    s_waitcnt vmcnt(18)
    s_barrier
    s_add_u32 m0, s71, 151552
    s_add_u32 s52, s74, 643072
    buffer_load_dwordx4 v21, s[32:35], s52 offen lds
    buffer_load_dwordx4 v21, s[32:35], s52 offen offset:2048 lds
    s_add_u32 m0, s71, 155648
    s_add_u32 s52, s74, 675840
    buffer_load_dwordx4 v21, s[32:35], s52 offen lds
    buffer_load_dwordx4 v21, s[32:35], s52 offen offset:2048 lds
    s_add_u32 m0, s71, 159744
    s_add_u32 s52, s74, 708608
    buffer_load_dwordx4 v21, s[32:35], s52 offen lds
    buffer_load_dwordx4 v21, s[32:35], s52 offen offset:2048 lds
    s_movk_i32 s53, 384
    s_add_u32 m0, s71, 14336
    s_nop 0
    buffer_load_dwordx4 v40, s[36:39], s53 offen lds
    s_add_u32 m0, s71, 16384
    s_nop 0
    buffer_load_dwordx4 v41, s[36:39], s53 offen lds
    s_add_u32 m0, s71, 18432
    s_nop 0
    buffer_load_dwordx4 v42, s[36:39], s53 offen lds
    s_add_u32 m0, s71, 20480
    s_nop 0
    buffer_load_dwordx4 v43, s[36:39], s53 offen lds
    s_add_u32 m0, s71, 22528
    s_nop 0
    buffer_load_dwordx4 v44, s[36:39], s53 offen lds
    s_add_u32 m0, s71, 24576
    s_nop 0
    buffer_load_dwordx4 v45, s[36:39], s53 offen lds
    s_add_u32 m0, s71, 26624
    s_nop 0
    buffer_load_dwordx4 v46, s[36:39], s53 offen lds
    s_add_u32 m0, s71, 28672
    s_add_u32 s52, s74, 385024
    buffer_load_dwordx4 v21, s[32:35], s52 offen lds
    buffer_load_dwordx4 v21, s[32:35], s52 offen offset:2048 lds
    s_add_u32 m0, s71, 32768
    s_add_u32 s52, s74, 417792
    buffer_load_dwordx4 v21, s[32:35], s52 offen lds
    buffer_load_dwordx4 v21, s[32:35], s52 offen offset:2048 lds
    s_add_u32 m0, s71, 36864
    s_add_u32 s52, s74, 450560
    buffer_load_dwordx4 v21, s[32:35], s52 offen lds
    buffer_load_dwordx4 v21, s[32:35], s52 offen offset:2048 lds
    s_add_u32 m0, s71, 40960
    s_add_u32 s52, s74, 483328
    buffer_load_dwordx4 v21, s[32:35], s52 offen lds
    buffer_load_dwordx4 v21, s[32:35], s52 offen offset:2048 lds
    s_add_u32 m0, s71, 45056
    s_add_u32 s52, s74, 516096
    buffer_load_dwordx4 v21, s[32:35], s52 offen lds
    buffer_load_dwordx4 v21, s[32:35], s52 offen offset:2048 lds
    s_add_u32 m0, s71, 49152
    s_add_u32 s52, s74, 548864
    buffer_load_dwordx4 v21, s[32:35], s52 offen lds
    buffer_load_dwordx4 v21, s[32:35], s52 offen offset:2048 lds
    s_add_u32 m0, s71, 53248
    s_add_u32 s52, s74, 581632
    buffer_load_dwordx4 v21, s[32:35], s52 offen lds
    buffer_load_dwordx4 v21, s[32:35], s52 offen offset:2048 lds
    s_add_u32 m0, s71, 57344
    s_add_u32 s52, s74, 614400
    buffer_load_dwordx4 v21, s[32:35], s52 offen lds
    buffer_load_dwordx4 v21, s[32:35], s52 offen offset:2048 lds
    s_add_u32 s56, s67, 8192
    buffer_load_dwordx4 v[160:163], v62, s[0:3], s56 offen
    s_add_u32 s56, s67, 9216
    buffer_load_dwordx4 v[164:167], v62, s[0:3], s56 offen
    s_waitcnt vmcnt(25)
    s_barrier
    s_add_u32 m0, s71, 61440
    s_add_u32 s52, s74, 647168
    buffer_load_dwordx4 v21, s[32:35], s52 offen lds
    buffer_load_dwordx4 v21, s[32:35], s52 offen offset:2048 lds
    s_add_u32 m0, s71, 65536
    s_add_u32 s52, s74, 679936
    buffer_load_dwordx4 v21, s[32:35], s52 offen lds
    buffer_load_dwordx4 v21, s[32:35], s52 offen offset:2048 lds
    s_add_u32 m0, s71, 69632
    s_add_u32 s52, s74, 712704
    buffer_load_dwordx4 v21, s[32:35], s52 offen lds
    buffer_load_dwordx4 v21, s[32:35], s52 offen offset:2048 lds
    s_add_u32 m0, s71, 73728
    s_add_u32 s52, s74, 389120
    buffer_load_dwordx4 v21, s[32:35], s52 offen lds
    buffer_load_dwordx4 v21, s[32:35], s52 offen offset:2048 lds
    s_add_u32 m0, s71, 77824
    s_add_u32 s52, s74, 421888
    buffer_load_dwordx4 v21, s[32:35], s52 offen lds
    buffer_load_dwordx4 v21, s[32:35], s52 offen offset:2048 lds
    s_add_u32 m0, s71, 81920
    s_add_u32 s52, s74, 454656
    buffer_load_dwordx4 v21, s[32:35], s52 offen lds
    buffer_load_dwordx4 v21, s[32:35], s52 offen offset:2048 lds
    s_add_u32 m0, s71, 86016
    s_add_u32 s52, s74, 487424
    buffer_load_dwordx4 v21, s[32:35], s52 offen lds
    buffer_load_dwordx4 v21, s[32:35], s52 offen offset:2048 lds
    s_add_u32 m0, s71, 90112
    s_add_u32 s52, s74, 520192
    buffer_load_dwordx4 v21, s[32:35], s52 offen lds
    buffer_load_dwordx4 v21, s[32:35], s52 offen offset:2048 lds
    s_add_u32 m0, s71, 94208
    s_add_u32 s52, s74, 552960
    buffer_load_dwordx4 v21, s[32:35], s52 offen lds
    buffer_load_dwordx4 v21, s[32:35], s52 offen offset:2048 lds
    s_add_u32 m0, s71, 98304
    s_add_u32 s52, s74, 585728
    buffer_load_dwordx4 v21, s[32:35], s52 offen lds
    buffer_load_dwordx4 v21, s[32:35], s52 offen offset:2048 lds
    s_add_u32 m0, s71, 102400
    s_add_u32 s52, s74, 618496
    buffer_load_dwordx4 v21, s[32:35], s52 offen lds
    buffer_load_dwordx4 v21, s[32:35], s52 offen offset:2048 lds
    s_add_u32 s56, s67, 10240
    buffer_load_dwordx4 v[168:171], v62, s[0:3], s56 offen
    s_add_u32 s56, s67, 11264
    buffer_load_dwordx4 v[172:175], v62, s[0:3], s56 offen
    s_waitcnt vmcnt(18)
    s_barrier
    s_add_u32 m0, s71, 106496
    s_add_u32 s52, s74, 651264
    buffer_load_dwordx4 v21, s[32:35], s52 offen lds
    buffer_load_dwordx4 v21, s[32:35], s52 offen offset:2048 lds
    s_add_u32 m0, s71, 110592
    s_add_u32 s52, s74, 684032
    buffer_load_dwordx4 v21, s[32:35], s52 offen lds
    buffer_load_dwordx4 v21, s[32:35], s52 offen offset:2048 lds
    s_add_u32 m0, s71, 114688
    s_add_u32 s52, s74, 716800
    buffer_load_dwordx4 v21, s[32:35], s52 offen lds
    buffer_load_dwordx4 v21, s[32:35], s52 offen offset:2048 lds
    s_add_u32 s36, s14, 11403264
    s_addc_u32 s37, s15, 0
    s_movk_i32 s53, 0
    s_add_u32 m0, s71, 0
    s_nop 0
    buffer_load_dwordx4 v40, s[36:39], s53 offen lds
    s_add_u32 m0, s71, 2048
    s_nop 0
    buffer_load_dwordx4 v41, s[36:39], s53 offen lds
    s_add_u32 m0, s71, 4096
    s_nop 0
    buffer_load_dwordx4 v42, s[36:39], s53 offen lds
    s_add_u32 m0, s71, 6144
    s_nop 0
    buffer_load_dwordx4 v43, s[36:39], s53 offen lds
    s_add_u32 m0, s71, 8192
    s_nop 0
    buffer_load_dwordx4 v44, s[36:39], s53 offen lds
    s_add_u32 m0, s71, 10240
    s_nop 0
    buffer_load_dwordx4 v45, s[36:39], s53 offen lds
    s_add_u32 m0, s71, 12288
    s_nop 0
    buffer_load_dwordx4 v46, s[36:39], s53 offen lds
    s_add_u32 m0, s71, 118784
    s_add_u32 s52, s74, 720896
    buffer_load_dwordx4 v21, s[32:35], s52 offen lds
    buffer_load_dwordx4 v21, s[32:35], s52 offen offset:2048 lds
    s_add_u32 m0, s71, 122880
    s_add_u32 s52, s74, 753664
    buffer_load_dwordx4 v21, s[32:35], s52 offen lds
    buffer_load_dwordx4 v21, s[32:35], s52 offen offset:2048 lds
    s_add_u32 m0, s71, 126976
    s_add_u32 s52, s74, 786432
    buffer_load_dwordx4 v21, s[32:35], s52 offen lds
    buffer_load_dwordx4 v21, s[32:35], s52 offen offset:2048 lds
    s_add_u32 m0, s71, 131072
    s_add_u32 s52, s74, 819200
    buffer_load_dwordx4 v21, s[32:35], s52 offen lds
    buffer_load_dwordx4 v21, s[32:35], s52 offen offset:2048 lds
    s_add_u32 m0, s71, 135168
    s_add_u32 s52, s74, 851968
    buffer_load_dwordx4 v21, s[32:35], s52 offen lds
    buffer_load_dwordx4 v21, s[32:35], s52 offen offset:2048 lds
    s_add_u32 m0, s71, 139264
    s_add_u32 s52, s74, 884736
    buffer_load_dwordx4 v21, s[32:35], s52 offen lds
    buffer_load_dwordx4 v21, s[32:35], s52 offen offset:2048 lds
    s_add_u32 m0, s71, 143360
    s_add_u32 s52, s74, 917504
    buffer_load_dwordx4 v21, s[32:35], s52 offen lds
    buffer_load_dwordx4 v21, s[32:35], s52 offen offset:2048 lds
    s_add_u32 m0, s71, 147456
    s_add_u32 s52, s74, 950272
    buffer_load_dwordx4 v21, s[32:35], s52 offen lds
    buffer_load_dwordx4 v21, s[32:35], s52 offen offset:2048 lds
    s_add_u32 s56, s67, 12288
    buffer_load_dwordx4 v[176:179], v62, s[0:3], s56 offen
    s_add_u32 s56, s67, 13312
    buffer_load_dwordx4 v[180:183], v62, s[0:3], s56 offen
    s_waitcnt vmcnt(25)
    s_barrier
    s_add_u32 m0, s71, 151552
    s_add_u32 s52, s74, 983040
    buffer_load_dwordx4 v21, s[32:35], s52 offen lds
    buffer_load_dwordx4 v21, s[32:35], s52 offen offset:2048 lds
    s_add_u32 m0, s71, 155648
    s_add_u32 s52, s74, 1015808
    buffer_load_dwordx4 v21, s[32:35], s52 offen lds
    buffer_load_dwordx4 v21, s[32:35], s52 offen offset:2048 lds
    s_add_u32 m0, s71, 159744
    s_add_u32 s52, s74, 1048576
    buffer_load_dwordx4 v21, s[32:35], s52 offen lds
    buffer_load_dwordx4 v21, s[32:35], s52 offen offset:2048 lds
    s_add_u32 m0, s71, 28672
    s_add_u32 s52, s74, 724992
    buffer_load_dwordx4 v21, s[32:35], s52 offen lds
    buffer_load_dwordx4 v21, s[32:35], s52 offen offset:2048 lds
    s_add_u32 m0, s71, 32768
    s_add_u32 s52, s74, 757760
    buffer_load_dwordx4 v21, s[32:35], s52 offen lds
    buffer_load_dwordx4 v21, s[32:35], s52 offen offset:2048 lds
    s_add_u32 m0, s71, 36864
    s_add_u32 s52, s74, 790528
    buffer_load_dwordx4 v21, s[32:35], s52 offen lds
    buffer_load_dwordx4 v21, s[32:35], s52 offen offset:2048 lds
    s_add_u32 m0, s71, 40960
    s_add_u32 s52, s74, 823296
    buffer_load_dwordx4 v21, s[32:35], s52 offen lds
    buffer_load_dwordx4 v21, s[32:35], s52 offen offset:2048 lds
    s_add_u32 m0, s71, 45056
    s_add_u32 s52, s74, 856064
    buffer_load_dwordx4 v21, s[32:35], s52 offen lds
    buffer_load_dwordx4 v21, s[32:35], s52 offen offset:2048 lds
    s_add_u32 m0, s71, 49152
    s_add_u32 s52, s74, 888832
    buffer_load_dwordx4 v21, s[32:35], s52 offen lds
    buffer_load_dwordx4 v21, s[32:35], s52 offen offset:2048 lds
    s_add_u32 m0, s71, 53248
    s_add_u32 s52, s74, 921600
    buffer_load_dwordx4 v21, s[32:35], s52 offen lds
    buffer_load_dwordx4 v21, s[32:35], s52 offen offset:2048 lds
    s_add_u32 m0, s71, 57344
    s_add_u32 s52, s74, 954368
    buffer_load_dwordx4 v21, s[32:35], s52 offen lds
    buffer_load_dwordx4 v21, s[32:35], s52 offen offset:2048 lds
    s_add_u32 s56, s67, 14336
    buffer_load_dwordx4 v[184:187], v62, s[0:3], s56 offen
    s_add_u32 s56, s67, 15360
    buffer_load_dwordx4 v[188:191], v62, s[0:3], s56 offen
    s_waitcnt vmcnt(18)
    s_barrier
    s_add_u32 m0, s71, 61440
    s_add_u32 s52, s74, 987136
    buffer_load_dwordx4 v21, s[32:35], s52 offen lds
    buffer_load_dwordx4 v21, s[32:35], s52 offen offset:2048 lds
    s_add_u32 m0, s71, 65536
    s_add_u32 s52, s74, 1019904
    buffer_load_dwordx4 v21, s[32:35], s52 offen lds
    buffer_load_dwordx4 v21, s[32:35], s52 offen offset:2048 lds
    s_add_u32 m0, s71, 69632
    s_add_u32 s52, s74, 1052672
    buffer_load_dwordx4 v21, s[32:35], s52 offen lds
    buffer_load_dwordx4 v21, s[32:35], s52 offen offset:2048 lds
    s_movk_i32 s53, 128
    s_add_u32 m0, s71, 14336
    s_nop 0
    buffer_load_dwordx4 v40, s[36:39], s53 offen lds
    s_add_u32 m0, s71, 16384
    s_nop 0
    buffer_load_dwordx4 v41, s[36:39], s53 offen lds
    s_add_u32 m0, s71, 18432
    s_nop 0
    buffer_load_dwordx4 v42, s[36:39], s53 offen lds
    s_add_u32 m0, s71, 20480
    s_nop 0
    buffer_load_dwordx4 v43, s[36:39], s53 offen lds
    s_add_u32 m0, s71, 22528
    s_nop 0
    buffer_load_dwordx4 v44, s[36:39], s53 offen lds
    s_add_u32 m0, s71, 24576
    s_nop 0
    buffer_load_dwordx4 v45, s[36:39], s53 offen lds
    s_add_u32 m0, s71, 26624
    s_nop 0
    buffer_load_dwordx4 v46, s[36:39], s53 offen lds
    s_add_u32 m0, s71, 73728
    s_add_u32 s52, s74, 729088
    buffer_load_dwordx4 v21, s[32:35], s52 offen lds
    buffer_load_dwordx4 v21, s[32:35], s52 offen offset:2048 lds
    s_add_u32 m0, s71, 77824
    s_add_u32 s52, s74, 761856
    buffer_load_dwordx4 v21, s[32:35], s52 offen lds
    buffer_load_dwordx4 v21, s[32:35], s52 offen offset:2048 lds
    s_add_u32 m0, s71, 81920
    s_add_u32 s52, s74, 794624
    buffer_load_dwordx4 v21, s[32:35], s52 offen lds
    buffer_load_dwordx4 v21, s[32:35], s52 offen offset:2048 lds
    s_add_u32 m0, s71, 86016
    s_add_u32 s52, s74, 827392
    buffer_load_dwordx4 v21, s[32:35], s52 offen lds
    buffer_load_dwordx4 v21, s[32:35], s52 offen offset:2048 lds
    s_add_u32 m0, s71, 90112
    s_add_u32 s52, s74, 860160
    buffer_load_dwordx4 v21, s[32:35], s52 offen lds
    buffer_load_dwordx4 v21, s[32:35], s52 offen offset:2048 lds
    s_add_u32 m0, s71, 94208
    s_add_u32 s52, s74, 892928
    buffer_load_dwordx4 v21, s[32:35], s52 offen lds
    buffer_load_dwordx4 v21, s[32:35], s52 offen offset:2048 lds
    s_add_u32 m0, s71, 98304
    s_add_u32 s52, s74, 925696
    buffer_load_dwordx4 v21, s[32:35], s52 offen lds
    buffer_load_dwordx4 v21, s[32:35], s52 offen offset:2048 lds
    s_add_u32 m0, s71, 102400
    s_add_u32 s52, s74, 958464
    buffer_load_dwordx4 v21, s[32:35], s52 offen lds
    buffer_load_dwordx4 v21, s[32:35], s52 offen offset:2048 lds
    s_add_u32 s56, s67, 16384
    buffer_load_dwordx4 v[192:195], v62, s[0:3], s56 offen
    s_add_u32 s56, s67, 17408
    buffer_load_dwordx4 v[196:199], v62, s[0:3], s56 offen
    s_waitcnt vmcnt(25)
    s_barrier
    s_add_u32 m0, s71, 106496
    s_add_u32 s52, s74, 991232
    buffer_load_dwordx4 v21, s[32:35], s52 offen lds
    buffer_load_dwordx4 v21, s[32:35], s52 offen offset:2048 lds
    s_add_u32 m0, s71, 110592
    s_add_u32 s52, s74, 1024000
    buffer_load_dwordx4 v21, s[32:35], s52 offen lds
    buffer_load_dwordx4 v21, s[32:35], s52 offen offset:2048 lds
    s_add_u32 m0, s71, 114688
    s_add_u32 s52, s74, 1056768
    buffer_load_dwordx4 v21, s[32:35], s52 offen lds
    buffer_load_dwordx4 v21, s[32:35], s52 offen offset:2048 lds
    s_add_u32 m0, s71, 118784
    s_add_u32 s52, s74, 733184
    buffer_load_dwordx4 v21, s[32:35], s52 offen lds
    buffer_load_dwordx4 v21, s[32:35], s52 offen offset:2048 lds
    s_add_u32 m0, s71, 122880
    s_add_u32 s52, s74, 765952
    buffer_load_dwordx4 v21, s[32:35], s52 offen lds
    buffer_load_dwordx4 v21, s[32:35], s52 offen offset:2048 lds
    s_add_u32 m0, s71, 126976
    s_add_u32 s52, s74, 798720
    buffer_load_dwordx4 v21, s[32:35], s52 offen lds
    buffer_load_dwordx4 v21, s[32:35], s52 offen offset:2048 lds
    s_add_u32 m0, s71, 131072
    s_add_u32 s52, s74, 831488
    buffer_load_dwordx4 v21, s[32:35], s52 offen lds
    buffer_load_dwordx4 v21, s[32:35], s52 offen offset:2048 lds
    s_add_u32 m0, s71, 135168
    s_add_u32 s52, s74, 864256
    buffer_load_dwordx4 v21, s[32:35], s52 offen lds
    buffer_load_dwordx4 v21, s[32:35], s52 offen offset:2048 lds
    s_add_u32 m0, s71, 139264
    s_add_u32 s52, s74, 897024
    buffer_load_dwordx4 v21, s[32:35], s52 offen lds
    buffer_load_dwordx4 v21, s[32:35], s52 offen offset:2048 lds
    s_add_u32 m0, s71, 143360
    s_add_u32 s52, s74, 929792
    buffer_load_dwordx4 v21, s[32:35], s52 offen lds
    buffer_load_dwordx4 v21, s[32:35], s52 offen offset:2048 lds
    s_add_u32 m0, s71, 147456
    s_add_u32 s52, s74, 962560
    buffer_load_dwordx4 v21, s[32:35], s52 offen lds
    buffer_load_dwordx4 v21, s[32:35], s52 offen offset:2048 lds
    s_add_u32 s56, s67, 18432
    buffer_load_dwordx4 v[200:203], v62, s[0:3], s56 offen
    s_add_u32 s56, s67, 19456
    buffer_load_dwordx4 v[204:207], v62, s[0:3], s56 offen
    s_waitcnt vmcnt(18)
    s_barrier
    s_add_u32 m0, s71, 151552
    s_add_u32 s52, s74, 995328
    buffer_load_dwordx4 v21, s[32:35], s52 offen lds
    buffer_load_dwordx4 v21, s[32:35], s52 offen offset:2048 lds
    s_add_u32 m0, s71, 155648
    s_add_u32 s52, s74, 1028096
    buffer_load_dwordx4 v21, s[32:35], s52 offen lds
    buffer_load_dwordx4 v21, s[32:35], s52 offen offset:2048 lds
    s_add_u32 m0, s71, 159744
    s_add_u32 s52, s74, 1060864
    buffer_load_dwordx4 v21, s[32:35], s52 offen lds
    buffer_load_dwordx4 v21, s[32:35], s52 offen offset:2048 lds
    s_movk_i32 s53, 256
    s_add_u32 m0, s71, 0
    s_nop 0
    buffer_load_dwordx4 v40, s[36:39], s53 offen lds
    s_add_u32 m0, s71, 2048
    s_nop 0
    buffer_load_dwordx4 v41, s[36:39], s53 offen lds
    s_add_u32 m0, s71, 4096
    s_nop 0
    buffer_load_dwordx4 v42, s[36:39], s53 offen lds
    s_add_u32 m0, s71, 6144
    s_nop 0
    buffer_load_dwordx4 v43, s[36:39], s53 offen lds
    s_add_u32 m0, s71, 8192
    s_nop 0
    buffer_load_dwordx4 v44, s[36:39], s53 offen lds
    s_add_u32 m0, s71, 10240
    s_nop 0
    buffer_load_dwordx4 v45, s[36:39], s53 offen lds
    s_add_u32 m0, s71, 12288
    s_nop 0
    buffer_load_dwordx4 v46, s[36:39], s53 offen lds
    s_add_u32 m0, s71, 28672
    s_add_u32 s52, s74, 737280
    buffer_load_dwordx4 v21, s[32:35], s52 offen lds
    buffer_load_dwordx4 v21, s[32:35], s52 offen offset:2048 lds
    s_add_u32 m0, s71, 32768
    s_add_u32 s52, s74, 770048
    buffer_load_dwordx4 v21, s[32:35], s52 offen lds
    buffer_load_dwordx4 v21, s[32:35], s52 offen offset:2048 lds
    s_add_u32 m0, s71, 36864
    s_add_u32 s52, s74, 802816
    buffer_load_dwordx4 v21, s[32:35], s52 offen lds
    buffer_load_dwordx4 v21, s[32:35], s52 offen offset:2048 lds
    s_add_u32 m0, s71, 40960
    s_add_u32 s52, s74, 835584
    buffer_load_dwordx4 v21, s[32:35], s52 offen lds
    buffer_load_dwordx4 v21, s[32:35], s52 offen offset:2048 lds
    s_add_u32 m0, s71, 45056
    s_add_u32 s52, s74, 868352
    buffer_load_dwordx4 v21, s[32:35], s52 offen lds
    buffer_load_dwordx4 v21, s[32:35], s52 offen offset:2048 lds
    s_add_u32 m0, s71, 49152
    s_add_u32 s52, s74, 901120
    buffer_load_dwordx4 v21, s[32:35], s52 offen lds
    buffer_load_dwordx4 v21, s[32:35], s52 offen offset:2048 lds
    s_add_u32 m0, s71, 53248
    s_add_u32 s52, s74, 933888
    buffer_load_dwordx4 v21, s[32:35], s52 offen lds
    buffer_load_dwordx4 v21, s[32:35], s52 offen offset:2048 lds
    s_add_u32 m0, s71, 57344
    s_add_u32 s52, s74, 966656
    buffer_load_dwordx4 v21, s[32:35], s52 offen lds
    buffer_load_dwordx4 v21, s[32:35], s52 offen offset:2048 lds
    s_add_u32 s56, s67, 20480
    buffer_load_dwordx4 v[208:211], v62, s[0:3], s56 offen
    s_add_u32 s56, s67, 21504
    buffer_load_dwordx4 v[212:215], v62, s[0:3], s56 offen
    s_waitcnt vmcnt(25)
    s_barrier
    s_add_u32 m0, s71, 61440
    s_add_u32 s52, s74, 999424
    buffer_load_dwordx4 v21, s[32:35], s52 offen lds
    buffer_load_dwordx4 v21, s[32:35], s52 offen offset:2048 lds
    s_add_u32 m0, s71, 65536
    s_add_u32 s52, s74, 1032192
    buffer_load_dwordx4 v21, s[32:35], s52 offen lds
    buffer_load_dwordx4 v21, s[32:35], s52 offen offset:2048 lds
    s_add_u32 m0, s71, 69632
    s_add_u32 s52, s74, 1064960
    buffer_load_dwordx4 v21, s[32:35], s52 offen lds
    buffer_load_dwordx4 v21, s[32:35], s52 offen offset:2048 lds
    s_add_u32 m0, s71, 73728
    s_add_u32 s52, s74, 741376
    buffer_load_dwordx4 v21, s[32:35], s52 offen lds
    buffer_load_dwordx4 v21, s[32:35], s52 offen offset:2048 lds
    s_add_u32 m0, s71, 77824
    s_add_u32 s52, s74, 774144
    buffer_load_dwordx4 v21, s[32:35], s52 offen lds
    buffer_load_dwordx4 v21, s[32:35], s52 offen offset:2048 lds
    s_add_u32 m0, s71, 81920
    s_add_u32 s52, s74, 806912
    buffer_load_dwordx4 v21, s[32:35], s52 offen lds
    buffer_load_dwordx4 v21, s[32:35], s52 offen offset:2048 lds
    s_add_u32 m0, s71, 86016
    s_add_u32 s52, s74, 839680
    buffer_load_dwordx4 v21, s[32:35], s52 offen lds
    buffer_load_dwordx4 v21, s[32:35], s52 offen offset:2048 lds
    s_add_u32 m0, s71, 90112
    s_add_u32 s52, s74, 872448
    buffer_load_dwordx4 v21, s[32:35], s52 offen lds
    buffer_load_dwordx4 v21, s[32:35], s52 offen offset:2048 lds
    s_add_u32 m0, s71, 94208
    s_add_u32 s52, s74, 905216
    buffer_load_dwordx4 v21, s[32:35], s52 offen lds
    buffer_load_dwordx4 v21, s[32:35], s52 offen offset:2048 lds
    s_add_u32 m0, s71, 98304
    s_add_u32 s52, s74, 937984
    buffer_load_dwordx4 v21, s[32:35], s52 offen lds
    buffer_load_dwordx4 v21, s[32:35], s52 offen offset:2048 lds
    s_add_u32 m0, s71, 102400
    s_add_u32 s52, s74, 970752
    buffer_load_dwordx4 v21, s[32:35], s52 offen lds
    buffer_load_dwordx4 v21, s[32:35], s52 offen offset:2048 lds
    s_add_u32 s56, s67, 22528
    buffer_load_dwordx4 v[216:219], v62, s[0:3], s56 offen
    s_add_u32 s56, s67, 23552
    buffer_load_dwordx4 v[220:223], v62, s[0:3], s56 offen
    s_waitcnt vmcnt(18)
    s_barrier
    s_add_u32 m0, s71, 106496
    s_add_u32 s52, s74, 1003520
    buffer_load_dwordx4 v21, s[32:35], s52 offen lds
    buffer_load_dwordx4 v21, s[32:35], s52 offen offset:2048 lds
    s_add_u32 m0, s71, 110592
    s_add_u32 s52, s74, 1036288
    buffer_load_dwordx4 v21, s[32:35], s52 offen lds
    buffer_load_dwordx4 v21, s[32:35], s52 offen offset:2048 lds
    s_add_u32 m0, s71, 114688
    s_add_u32 s52, s74, 1069056
    buffer_load_dwordx4 v21, s[32:35], s52 offen lds
    buffer_load_dwordx4 v21, s[32:35], s52 offen offset:2048 lds
    s_movk_i32 s53, 384
    s_add_u32 m0, s71, 14336
    s_nop 0
    buffer_load_dwordx4 v40, s[36:39], s53 offen lds
    s_add_u32 m0, s71, 16384
    s_nop 0
    buffer_load_dwordx4 v41, s[36:39], s53 offen lds
    s_add_u32 m0, s71, 18432
    s_nop 0
    buffer_load_dwordx4 v42, s[36:39], s53 offen lds
    s_add_u32 m0, s71, 20480
    s_nop 0
    buffer_load_dwordx4 v43, s[36:39], s53 offen lds
    s_add_u32 m0, s71, 22528
    s_nop 0
    buffer_load_dwordx4 v44, s[36:39], s53 offen lds
    s_add_u32 m0, s71, 24576
    s_nop 0
    buffer_load_dwordx4 v45, s[36:39], s53 offen lds
    s_add_u32 m0, s71, 26624
    s_nop 0
    buffer_load_dwordx4 v46, s[36:39], s53 offen lds
    s_add_u32 m0, s71, 118784
    s_add_u32 s52, s74, 745472
    buffer_load_dwordx4 v21, s[32:35], s52 offen lds
    buffer_load_dwordx4 v21, s[32:35], s52 offen offset:2048 lds
    s_add_u32 m0, s71, 122880
    s_add_u32 s52, s74, 778240
    buffer_load_dwordx4 v21, s[32:35], s52 offen lds
    buffer_load_dwordx4 v21, s[32:35], s52 offen offset:2048 lds
    s_add_u32 m0, s71, 126976
    s_add_u32 s52, s74, 811008
    buffer_load_dwordx4 v21, s[32:35], s52 offen lds
    buffer_load_dwordx4 v21, s[32:35], s52 offen offset:2048 lds
    s_add_u32 m0, s71, 131072
    s_add_u32 s52, s74, 843776
    buffer_load_dwordx4 v21, s[32:35], s52 offen lds
    buffer_load_dwordx4 v21, s[32:35], s52 offen offset:2048 lds
    s_add_u32 m0, s71, 135168
    s_add_u32 s52, s74, 876544
    buffer_load_dwordx4 v21, s[32:35], s52 offen lds
    buffer_load_dwordx4 v21, s[32:35], s52 offen offset:2048 lds
    s_add_u32 m0, s71, 139264
    s_add_u32 s52, s74, 909312
    buffer_load_dwordx4 v21, s[32:35], s52 offen lds
    buffer_load_dwordx4 v21, s[32:35], s52 offen offset:2048 lds
    s_add_u32 m0, s71, 143360
    s_add_u32 s52, s74, 942080
    buffer_load_dwordx4 v21, s[32:35], s52 offen lds
    buffer_load_dwordx4 v21, s[32:35], s52 offen offset:2048 lds
    s_add_u32 m0, s71, 147456
    s_add_u32 s52, s74, 974848
    buffer_load_dwordx4 v21, s[32:35], s52 offen lds
    buffer_load_dwordx4 v21, s[32:35], s52 offen offset:2048 lds
    s_add_u32 s56, s67, 24576
    buffer_load_dwordx4 v[224:227], v62, s[0:3], s56 offen
    s_add_u32 s56, s67, 25600
    buffer_load_dwordx4 v[228:231], v62, s[0:3], s56 offen
    s_waitcnt vmcnt(25)
    s_barrier
    s_add_u32 m0, s71, 151552
    s_add_u32 s52, s74, 1007616
    buffer_load_dwordx4 v21, s[32:35], s52 offen lds
    buffer_load_dwordx4 v21, s[32:35], s52 offen offset:2048 lds
    s_add_u32 m0, s71, 155648
    s_add_u32 s52, s74, 1040384
    buffer_load_dwordx4 v21, s[32:35], s52 offen lds
    buffer_load_dwordx4 v21, s[32:35], s52 offen offset:2048 lds
    s_add_u32 m0, s71, 159744
    s_add_u32 s52, s74, 1073152
    buffer_load_dwordx4 v21, s[32:35], s52 offen lds
    buffer_load_dwordx4 v21, s[32:35], s52 offen offset:2048 lds
    s_add_u32 m0, s71, 28672
    s_add_u32 s52, s74, 749568
    buffer_load_dwordx4 v21, s[32:35], s52 offen lds
    buffer_load_dwordx4 v21, s[32:35], s52 offen offset:2048 lds
    s_add_u32 m0, s71, 32768
    s_add_u32 s52, s74, 782336
    buffer_load_dwordx4 v21, s[32:35], s52 offen lds
    buffer_load_dwordx4 v21, s[32:35], s52 offen offset:2048 lds
    s_add_u32 m0, s71, 36864
    s_add_u32 s52, s74, 815104
    buffer_load_dwordx4 v21, s[32:35], s52 offen lds
    buffer_load_dwordx4 v21, s[32:35], s52 offen offset:2048 lds
    s_add_u32 m0, s71, 40960
    s_add_u32 s52, s74, 847872
    buffer_load_dwordx4 v21, s[32:35], s52 offen lds
    buffer_load_dwordx4 v21, s[32:35], s52 offen offset:2048 lds
    s_add_u32 m0, s71, 45056
    s_add_u32 s52, s74, 880640
    buffer_load_dwordx4 v21, s[32:35], s52 offen lds
    buffer_load_dwordx4 v21, s[32:35], s52 offen offset:2048 lds
    s_add_u32 m0, s71, 49152
    s_add_u32 s52, s74, 913408
    buffer_load_dwordx4 v21, s[32:35], s52 offen lds
    buffer_load_dwordx4 v21, s[32:35], s52 offen offset:2048 lds
    s_add_u32 m0, s71, 53248
    s_add_u32 s52, s74, 946176
    buffer_load_dwordx4 v21, s[32:35], s52 offen lds
    buffer_load_dwordx4 v21, s[32:35], s52 offen offset:2048 lds
    s_add_u32 m0, s71, 57344
    s_add_u32 s52, s74, 978944
    buffer_load_dwordx4 v21, s[32:35], s52 offen lds
    buffer_load_dwordx4 v21, s[32:35], s52 offen offset:2048 lds
    s_add_u32 s56, s67, 26624
    buffer_load_dwordx4 v[232:235], v62, s[0:3], s56 offen
    s_add_u32 s56, s67, 27648
    buffer_load_dwordx4 v[236:239], v62, s[0:3], s56 offen
    s_waitcnt vmcnt(18)
    s_barrier
    s_add_u32 m0, s71, 61440
    s_add_u32 s52, s74, 1011712
    buffer_load_dwordx4 v21, s[32:35], s52 offen lds
    buffer_load_dwordx4 v21, s[32:35], s52 offen offset:2048 lds
    s_add_u32 m0, s71, 65536
    s_add_u32 s52, s74, 1044480
    buffer_load_dwordx4 v21, s[32:35], s52 offen lds
    buffer_load_dwordx4 v21, s[32:35], s52 offen offset:2048 lds
    s_add_u32 m0, s71, 69632
    s_add_u32 s52, s74, 1077248
    buffer_load_dwordx4 v21, s[32:35], s52 offen lds
    buffer_load_dwordx4 v21, s[32:35], s52 offen offset:2048 lds
    s_add_u32 s56, s67, 28672
    buffer_load_dwordx4 v[240:243], v62, s[0:3], s56 offen
    s_add_u32 s56, s67, 29696
    buffer_load_dwordx4 v[244:247], v62, s[0:3], s56 offen
    s_waitcnt vmcnt(2)
    s_barrier
    s_add_u32 s56, s67, 30720
    buffer_load_dwordx4 v[248:251], v62, s[0:3], s56 offen
    s_add_u32 s56, s67, 31744
    buffer_load_dwordx4 v[252:255], v62, s[0:3], s56 offen
    s_waitcnt vmcnt(0)
    s_barrier
    s_barrier
    s_branch L_join
L_helper:
    s_sub_u32 s23, s16, 6
    v_and_b32 v1, 63, v0
    s_lshl_b32 s52, s23, 6
    v_add_u32 v2, s52, v1
    s_mov_b32 s62, 2.0
    s_mov_b32 s63, 2.0
    v_lshrrev_b32 v11, 3, v2
    v_and_b32 v12, 7, v2
    v_lshlrev_b32 v12, 4, v12
    s_mul_i32 s52, s18, 98
    v_add_u32 v10, s74, v12
    v_add_u32 v12, s72, v12
    v_mov_b32 v9, 0x40000000
    s_mov_b32 s54, 786432
    s_movk_i32 s55, 2816
    v_add_u32 v13, 0, v11
    v_add_u32 v14, s52, v13
    v_cmp_gt_u32 vcc, s55, v14
    v_lshrrev_b32 v15, 8, v14
    v_and_b32 v14, 255, v14
    v_lshl_add_u32 v8, v14, 7, v10
    v_lshl_add_u32 v14, v14, 10, v12
    v_mul_lo_u32 v7, v15, s54
    v_add_u32 v21, v7, v14
    v_lshl_add_u32 v76, v15, 15, v8
    v_cndmask_b32 v21, v9, v21, vcc
    v_cndmask_b32 v76, v9, v76, vcc
    v_subrev_u32 v20, 0x40000, v21
    v_cmp_eq_u32 vcc, 0, v15
    s_nop 1
    v_cndmask_b32 v20, v20, v9, vcc
    v_add_u32 v13, 16, v11
    v_add_u32 v14, s52, v13
    v_cmp_gt_u32 vcc, s55, v14
    v_lshrrev_b32 v15, 8, v14
    v_and_b32 v14, 255, v14
    v_lshl_add_u32 v8, v14, 7, v10
    v_lshl_add_u32 v14, v14, 10, v12
    v_mul_lo_u32 v7, v15, s54
    v_add_u32 v23, v7, v14
    v_lshl_add_u32 v77, v15, 15, v8
    v_cndmask_b32 v23, v9, v23, vcc
    v_cndmask_b32 v77, v9, v77, vcc
    v_subrev_u32 v22, 0x40000, v23
    v_cmp_eq_u32 vcc, 0, v15
    s_nop 1
    v_cndmask_b32 v22, v22, v9, vcc
    v_add_u32 v13, 32, v11
    v_add_u32 v14, s52, v13
    v_cmp_gt_u32 vcc, s55, v14
    v_lshrrev_b32 v15, 8, v14
    v_and_b32 v14, 255, v14
    v_lshl_add_u32 v8, v14, 7, v10
    v_lshl_add_u32 v14, v14, 10, v12
    v_mul_lo_u32 v7, v15, s54
    v_add_u32 v25, v7, v14
    v_lshl_add_u32 v78, v15, 15, v8
    v_cndmask_b32 v25, v9, v25, vcc
    v_cndmask_b32 v78, v9, v78, vcc
    v_subrev_u32 v24, 0x40000, v25
    v_cmp_eq_u32 vcc, 0, v15
    s_nop 1
    v_cndmask_b32 v24, v24, v9, vcc
    v_add_u32 v13, 48, v11
    v_add_u32 v14, s52, v13
    v_cmp_gt_u32 vcc, s55, v14
    v_lshrrev_b32 v15, 8, v14
    v_and_b32 v14, 255, v14
    v_lshl_add_u32 v8, v14, 7, v10
    v_lshl_add_u32 v14, v14, 10, v12
    v_mul_lo_u32 v7, v15, s54
    v_add_u32 v27, v7, v14
    v_lshl_add_u32 v79, v15, 15, v8
    v_cndmask_b32 v27, v9, v27, vcc
    v_cndmask_b32 v79, v9, v79, vcc
    v_subrev_u32 v26, 0x40000, v27
    v_cmp_eq_u32 vcc, 0, v15
    s_nop 1
    v_cndmask_b32 v26, v26, v9, vcc
    v_add_u32 v13, 64, v11
    v_add_u32 v14, s52, v13
    v_cmp_gt_u32 vcc, s55, v14
    v_lshrrev_b32 v15, 8, v14
    v_and_b32 v14, 255, v14
    v_lshl_add_u32 v8, v14, 7, v10
    v_lshl_add_u32 v14, v14, 10, v12
    v_mul_lo_u32 v7, v15, s54
    v_add_u32 v29, v7, v14
    v_lshl_add_u32 v80, v15, 15, v8
    v_cndmask_b32 v29, v9, v29, vcc
    v_cndmask_b32 v80, v9, v80, vcc
    v_subrev_u32 v28, 0x40000, v29
    v_cmp_eq_u32 vcc, 0, v15
    s_nop 1
    v_cndmask_b32 v28, v28, v9, vcc
    v_add_u32 v13, 80, v11
    v_add_u32 v14, s52, v13
    v_cmp_gt_u32 vcc, s55, v14
    v_lshrrev_b32 v15, 8, v14
    v_and_b32 v14, 255, v14
    v_lshl_add_u32 v8, v14, 7, v10
    v_lshl_add_u32 v14, v14, 10, v12
    v_mul_lo_u32 v7, v15, s54
    v_add_u32 v31, v7, v14
    v_lshl_add_u32 v81, v15, 15, v8
    v_cndmask_b32 v31, v9, v31, vcc
    v_cndmask_b32 v81, v9, v81, vcc
    v_subrev_u32 v30, 0x40000, v31
    v_cmp_eq_u32 vcc, 0, v15
    s_nop 1
    v_cndmask_b32 v30, v30, v9, vcc
    v_add_u32 v13, 96, v11
    v_add_u32 v14, s52, v13
    v_cmp_gt_u32 vcc, s55, v14
    v_cmp_gt_u32 s[56:57], 2, v11
    s_and_b64 vcc, vcc, s[56:57]
    v_lshrrev_b32 v15, 8, v14
    v_and_b32 v14, 255, v14
    v_lshl_add_u32 v8, v14, 7, v10
    v_lshl_add_u32 v14, v14, 10, v12
    v_mul_lo_u32 v7, v15, s54
    v_add_u32 v33, v7, v14
    v_lshl_add_u32 v82, v15, 15, v8
    v_cndmask_b32 v33, v9, v33, vcc
    v_cndmask_b32 v82, v9, v82, vcc
    v_subrev_u32 v32, 0x40000, v33
    v_cmp_eq_u32 vcc, 0, v15
    s_nop 1
    v_cndmask_b32 v32, v32, v9, vcc
    s_mul_i32 s52, s66, 368
    s_mov_b32 s53, 6439232
    v_add_u32 v13, 0, v2
    v_add_u32 v14, s52, v13
    v_lshrrev_b32 v15, 5, v14
    v_and_b32 v14, 31, v14
    v_lshlrev_b32 v14, 4, v14
    v_mul_hi_u32 v6, v15, s53
    v_mul_u32_u24 v7, 667, v6
    v_sub_u32 v15, v15, v7
    v_mul_u32_u24 v7, 6, v15
    v_and_b32 v5, 1, v6
    v_add_u32 v7, v7, v5
    v_lshrrev_b32 v5, 1, v6
    v_mul_u32_u24 v5, 4000, v5
    v_add_u32 v5, v5, v7
    v_lshl_add_u32 v5, v5, 9, v14
    s_mov_b32 s54, 344064
    v_mul_lo_u32 v8, v6, s54
    v_lshl_add_u32 v8, v15, 9, v8
    v_add_u32 v8, v8, v14
    s_movk_i32 s54, 368
    v_cmp_gt_u32 vcc, s54, v13
    s_nop 1
    v_cndmask_b32 v34, v9, v5, vcc
    v_cndmask_b32 v83, v9, v8, vcc
    s_movk_i32 s54, 3996
    v_cmp_gt_u32 s[56:57], s54, v7
    s_and_b64 vcc, vcc, s[56:57]
    s_nop 1
    v_cndmask_b32 v37, v9, v5, vcc
    v_add_u32 v13, 128, v2
    v_add_u32 v14, s52, v13
    v_lshrrev_b32 v15, 5, v14
    v_and_b32 v14, 31, v14
    v_lshlrev_b32 v14, 4, v14
    v_mul_hi_u32 v6, v15, s53
    v_mul_u32_u24 v7, 667, v6
    v_sub_u32 v15, v15, v7
    v_mul_u32_u24 v7, 6, v15
    v_and_b32 v5, 1, v6
    v_add_u32 v7, v7, v5
    v_lshrrev_b32 v5, 1, v6
    v_mul_u32_u24 v5, 4000, v5
    v_add_u32 v5, v5, v7
    v_lshl_add_u32 v5, v5, 9, v14
    s_mov_b32 s54, 344064
    v_mul_lo_u32 v8, v6, s54
    v_lshl_add_u32 v8, v15, 9, v8
    v_add_u32 v8, v8, v14
    s_movk_i32 s54, 368
    v_cmp_gt_u32 vcc, s54, v13
    s_nop 1
    v_cndmask_b32 v35, v9, v5, vcc
    v_cndmask_b32 v84, v9, v8, vcc
    s_movk_i32 s54, 3996
    v_cmp_gt_u32 s[56:57], s54, v7
    s_and_b64 vcc, vcc, s[56:57]
    s_nop 1
    v_cndmask_b32 v38, v9, v5, vcc
    v_add_u32 v13, 256, v2
    v_add_u32 v14, s52, v13
    v_lshrrev_b32 v15, 5, v14
    v_and_b32 v14, 31, v14
    v_lshlrev_b32 v14, 4, v14
    v_mul_hi_u32 v6, v15, s53
    v_mul_u32_u24 v7, 667, v6
    v_sub_u32 v15, v15, v7
    v_mul_u32_u24 v7, 6, v15
    v_and_b32 v5, 1, v6
    v_add_u32 v7, v7, v5
    v_lshrrev_b32 v5, 1, v6
    v_mul_u32_u24 v5, 4000, v5
    v_add_u32 v5, v5, v7
    v_lshl_add_u32 v5, v5, 9, v14
    s_mov_b32 s54, 344064
    v_mul_lo_u32 v8, v6, s54
    v_lshl_add_u32 v8, v15, 9, v8
    v_add_u32 v8, v8, v14
    s_movk_i32 s54, 368
    v_cmp_gt_u32 vcc, s54, v13
    s_nop 1
    v_cndmask_b32 v36, v9, v5, vcc
    v_cndmask_b32 v85, v9, v8, vcc
    s_movk_i32 s54, 3996
    v_cmp_gt_u32 s[56:57], s54, v7
    s_and_b64 vcc, vcc, s[56:57]
    s_nop 1
    v_cndmask_b32 v39, v9, v5, vcc
    s_waitcnt lgkmcnt(0)
    s_or_b32 s75, s64, 1
    s_mov_b32 s0, s14
    s_mov_b32 s1, s15
    s_mov_b32 s2, 25198592
    s_mov_b32 s3, 0x20000
    s_mov_b32 s24, s4
    s_mov_b32 s25, s5
    s_mov_b32 s26, 4096000
    s_mov_b32 s27, 0x20000
    s_mov_b32 s28, s6
    s_mov_b32 s29, s7
    s_mov_b32 s30, 8126464
    s_mov_b32 s31, 0x20000
    s_mov_b32 s32, s14
    s_mov_b32 s33, s15
    s_mov_b32 s34, 12779520
    s_mov_b32 s35, 0x20000
    s_mov_b32 s36, s14
    s_mov_b32 s37, s15
    s_mov_b32 s38, 1376256
    s_mov_b32 s39, 0x20000
    s_add_u32 s40, s14, 13631488
    s_addc_u32 s41, s15, 0
    s_mov_b32 s42, 8552448
    s_mov_b32 s43, 0x20000
    s_mov_b32 s44, s8
    s_mov_b32 s45, s9
    s_mov_b32 s46, 131072
    s_mov_b32 s47, 0x20000
    s_mov_b32 s48, s10
    s_mov_b32 s49, s11
    s_mov_b32 s50, 4096000
    s_mov_b32 s51, 0x20000
    s_mov_b32 s52, 25165824
    v_lshl_add_u32 v97, v1, 2, s52
    v_lshl_add_u32 v11, v1, 3, s17
    s_sub_u32 s53, s73, 11
    s_max_i32 s53, s53, 0
    s_mul_i32 s54, s19, 667
    s_add_u32 s53, s53, s54
    s_mul_i32 s53, s53, 2
    s_mul_hi_u32 s53, s53, 186737709
    s_sub_u32 s53, s53, 32
    v_add_u32 v12, s53, v1
    v_min_u32 v12, 231, v12
    v_cmp_le_u32 vcc, 32, v1
    s_nop 1
    v_cndmask_b32 v11, v11, v12, vcc
    v_lshl_add_u32 v98, v11, 2, s52
    s_barrier
    buffer_load_dwordx4 v[212:215], v34, s[24:27], 0 offen
    buffer_load_dwordx4 v[216:219], v34, s[24:27], 0 offen offset:1024
    buffer_load_dwordx4 v[220:223], v37, s[24:27], 0 offen offset:2048
    buffer_load_dwordx4 v[224:227], v35, s[24:27], 0 offen
    buffer_load_dwordx4 v[228:231], v35, s[24:27], 0 offen offset:1024
    buffer_load_dwordx4 v[232:235], v38, s[24:27], 0 offen offset:2048
    buffer_load_dwordx4 v[236:239], v36, s[24:27], 0 offen
    buffer_load_dwordx4 v[240:243], v36, s[24:27], 0 offen offset:1024
    buffer_load_dwordx4 v[244:247], v39, s[24:27], 0 offen offset:2048
    s_barrier
    s_mov_b32 s55, 0x40000
    buffer_load_dwordx4 v[128:131], v20, s[28:31], 0 offen
    buffer_load_dwordx4 v[132:135], v21, s[28:31], 0 offen
    buffer_load_dwordx4 v[136:139], v21, s[28:31], s55 offen
    s_mov_b32 s55, 0x40000
    buffer_load_dwordx4 v[140:143], v22, s[28:31], 0 offen
    buffer_load_dwordx4 v[144:147], v23, s[28:31], 0 offen
    buffer_load_dwordx4 v[148:151], v23, s[28:31], s55 offen
    s_mov_b32 s55, 0x40000
    buffer_load_dwordx4 v[152:155], v24, s[28:31], 0 offen
    buffer_load_dwordx4 v[156:159], v25, s[28:31], 0 offen
    buffer_load_dwordx4 v[160:163], v25, s[28:31], s55 offen
    s_mov_b32 s55, 0x40000
    buffer_load_dwordx4 v[164:167], v26, s[28:31], 0 offen
    buffer_load_dwordx4 v[168:171], v27, s[28:31], 0 offen
    buffer_load_dwordx4 v[172:175], v27, s[28:31], s55 offen
    s_barrier
    s_waitcnt vmcnt(18)
    v_lshlrev_b32 v64, 16, v212
    v_and_b32 v65, 0xffff0000, v212
    v_lshlrev_b32 v66, 16, v216
    v_and_b32 v67, 0xffff0000, v216
    v_lshlrev_b32 v68, 16, v220
    v_and_b32 v69, 0xffff0000, v220
    v_add_f32 v70, v64, v68
    v_add_f32 v71, v65, v69
    v_fma_f32 v74, 2.0, v68, v66
    v_fma_f32 v75, 2.0, v69, v67
    v_add_f32 v72, v70, v66
    v_add_f32 v73, v71, v67
    v_fma_f32 v74, 2.0, v74, v64
    v_fma_f32 v75, 2.0, v75, v65
    v_cvt_pk_bf16_f32 v212, v72, v73
    v_sub_f32 v72, v70, v66
    v_sub_f32 v73, v71, v67
    v_cvt_pk_bf16_f32 v220, v74, v75
    v_cvt_pk_bf16_f32 v216, v72, v73
    v_lshlrev_b32 v64, 16, v213
    v_and_b32 v65, 0xffff0000, v213
    v_lshlrev_b32 v66, 16, v217
    v_and_b32 v67, 0xffff0000, v217
    v_lshlrev_b32 v68, 16, v221
    v_and_b32 v69, 0xffff0000, v221
    v_add_f32 v70, v64, v68
    v_add_f32 v71, v65, v69
    v_fma_f32 v74, 2.0, v68, v66
    v_fma_f32 v75, 2.0, v69, v67
    v_add_f32 v72, v70, v66
    v_add_f32 v73, v71, v67
    v_fma_f32 v74, 2.0, v74, v64
    v_fma_f32 v75, 2.0, v75, v65
    v_cvt_pk_bf16_f32 v213, v72, v73
    v_sub_f32 v72, v70, v66
    v_sub_f32 v73, v71, v67
    v_cvt_pk_bf16_f32 v221, v74, v75
    v_cvt_pk_bf16_f32 v217, v72, v73
    v_lshlrev_b32 v64, 16, v214
    v_and_b32 v65, 0xffff0000, v214
    v_lshlrev_b32 v66, 16, v218
    v_and_b32 v67, 0xffff0000, v218
    v_lshlrev_b32 v68, 16, v222
    v_and_b32 v69, 0xffff0000, v222
    v_add_f32 v70, v64, v68
    v_add_f32 v71, v65, v69
    v_fma_f32 v74, 2.0, v68, v66
    v_fma_f32 v75, 2.0, v69, v67
    v_add_f32 v72, v70, v66
    v_add_f32 v73, v71, v67
    v_fma_f32 v74, 2.0, v74, v64
    v_fma_f32 v75, 2.0, v75, v65
    v_cvt_pk_bf16_f32 v214, v72, v73
    v_sub_f32 v72, v70, v66
    v_sub_f32 v73, v71, v67
    v_cvt_pk_bf16_f32 v222, v74, v75
    v_cvt_pk_bf16_f32 v218, v72, v73
    v_lshlrev_b32 v64, 16, v215
    v_and_b32 v65, 0xffff0000, v215
    v_lshlrev_b32 v66, 16, v219
    v_and_b32 v67, 0xffff0000, v219
    v_lshlrev_b32 v68, 16, v223
    v_and_b32 v69, 0xffff0000, v223
    v_add_f32 v70, v64, v68
    v_add_f32 v71, v65, v69
    v_fma_f32 v74, 2.0, v68, v66
    v_fma_f32 v75, 2.0, v69, v67
    v_add_f32 v72, v70, v66
    v_add_f32 v73, v71, v67
    v_fma_f32 v74, 2.0, v74, v64
    v_fma_f32 v75, 2.0, v75, v65
    v_cvt_pk_bf16_f32 v215, v72, v73
    v_sub_f32 v72, v70, v66
    v_sub_f32 v73, v71, v67
    v_cvt_pk_bf16_f32 v223, v74, v75
    v_cvt_pk_bf16_f32 v219, v72, v73
    s_mov_b32 s60, 8650752
    buffer_store_dwordx4 v[212:215], v83, s[32:35], s60 offen sc1
    s_mov_b32 s55, 0x40000
    buffer_load_dwordx4 v[176:179], v28, s[28:31], 0 offen
    buffer_load_dwordx4 v[180:183], v29, s[28:31], 0 offen
    buffer_load_dwordx4 v[184:187], v29, s[28:31], s55 offen
    s_mov_b32 s55, 0x40000
    buffer_load_dwordx4 v[188:191], v30, s[28:31], 0 offen
    buffer_load_dwordx4 v[192:195], v31, s[28:31], 0 offen
    buffer_load_dwordx4 v[196:199], v31, s[28:31], s55 offen
    s_mov_b32 s55, 0x40000
    buffer_load_dwordx4 v[200:203], v32, s[28:31], 0 offen
    buffer_load_dwordx4 v[204:207], v33, s[28:31], 0 offen
    buffer_load_dwordx4 v[208:211], v33, s[28:31], s55 offen
    s_waitcnt vmcnt(25)
    v_lshlrev_b32 v64, 16, v224
    v_and_b32 v65, 0xffff0000, v224
    v_lshlrev_b32 v66, 16, v228
    v_and_b32 v67, 0xffff0000, v228
    v_lshlrev_b32 v68, 16, v232
    v_and_b32 v69, 0xffff0000, v232
    v_add_f32 v70, v64, v68
    v_add_f32 v71, v65, v69
    v_fma_f32 v74, 2.0, v68, v66
    v_fma_f32 v75, 2.0, v69, v67
    v_add_f32 v72, v70, v66
    v_add_f32 v73, v71, v67
    v_fma_f32 v74, 2.0, v74, v64
    v_fma_f32 v75, 2.0, v75, v65
    v_cvt_pk_bf16_f32 v224, v72, v73
    v_sub_f32 v72, v70, v66
    v_sub_f32 v73, v71, v67
    v_cvt_pk_bf16_f32 v232, v74, v75
    v_cvt_pk_bf16_f32 v228, v72, v73
    v_lshlrev_b32 v64, 16, v225
    v_and_b32 v65, 0xffff0000, v225
    v_lshlrev_b32 v66, 16, v229
    v_and_b32 v67, 0xffff0000, v229
    v_lshlrev_b32 v68, 16, v233
    v_and_b32 v69, 0xffff0000, v233
    v_add_f32 v70, v64, v68
    v_add_f32 v71, v65, v69
    v_fma_f32 v74, 2.0, v68, v66
    v_fma_f32 v75, 2.0, v69, v67
    v_add_f32 v72, v70, v66
    v_add_f32 v73, v71, v67
    v_fma_f32 v74, 2.0, v74, v64
    v_fma_f32 v75, 2.0, v75, v65
    v_cvt_pk_bf16_f32 v225, v72, v73
    v_sub_f32 v72, v70, v66
    v_sub_f32 v73, v71, v67
    v_cvt_pk_bf16_f32 v233, v74, v75
    v_cvt_pk_bf16_f32 v229, v72, v73
    v_lshlrev_b32 v64, 16, v226
    v_and_b32 v65, 0xffff0000, v226
    v_lshlrev_b32 v66, 16, v230
    v_and_b32 v67, 0xffff0000, v230
    v_lshlrev_b32 v68, 16, v234
    v_and_b32 v69, 0xffff0000, v234
    v_add_f32 v70, v64, v68
    v_add_f32 v71, v65, v69
    v_fma_f32 v74, 2.0, v68, v66
    v_fma_f32 v75, 2.0, v69, v67
    v_add_f32 v72, v70, v66
    v_add_f32 v73, v71, v67
    v_fma_f32 v74, 2.0, v74, v64
    v_fma_f32 v75, 2.0, v75, v65
    v_cvt_pk_bf16_f32 v226, v72, v73
    v_sub_f32 v72, v70, v66
    v_sub_f32 v73, v71, v67
    v_cvt_pk_bf16_f32 v234, v74, v75
    v_cvt_pk_bf16_f32 v230, v72, v73
    v_lshlrev_b32 v64, 16, v227
    v_and_b32 v65, 0xffff0000, v227
    v_lshlrev_b32 v66, 16, v231
    v_and_b32 v67, 0xffff0000, v231
    v_lshlrev_b32 v68, 16, v235
    v_and_b32 v69, 0xffff0000, v235
    v_add_f32 v70, v64, v68
    v_add_f32 v71, v65, v69
    v_fma_f32 v74, 2.0, v68, v66
    v_fma_f32 v75, 2.0, v69, v67
    v_add_f32 v72, v70, v66
    v_add_f32 v73, v71, v67
    v_fma_f32 v74, 2.0, v74, v64
    v_fma_f32 v75, 2.0, v75, v65
    v_cvt_pk_bf16_f32 v227, v72, v73
    v_sub_f32 v72, v70, v66
    v_sub_f32 v73, v71, v67
    v_cvt_pk_bf16_f32 v235, v74, v75
    v_cvt_pk_bf16_f32 v231, v72, v73
    s_mov_b32 s60, 8650752
    buffer_store_dwordx4 v[224:227], v84, s[32:35], s60 offen sc1
    s_barrier
    s_waitcnt vmcnt(23)
    v_lshlrev_b32 v64, 16, v236
    v_and_b32 v65, 0xffff0000, v236
    v_lshlrev_b32 v66, 16, v240
    v_and_b32 v67, 0xffff0000, v240
    v_lshlrev_b32 v68, 16, v244
    v_and_b32 v69, 0xffff0000, v244
    v_add_f32 v70, v64, v68
    v_add_f32 v71, v65, v69
    v_fma_f32 v74, 2.0, v68, v66
    v_fma_f32 v75, 2.0, v69, v67
    v_add_f32 v72, v70, v66
    v_add_f32 v73, v71, v67
    v_fma_f32 v74, 2.0, v74, v64
    v_fma_f32 v75, 2.0, v75, v65
    v_cvt_pk_bf16_f32 v236, v72, v73
    v_sub_f32 v72, v70, v66
    v_sub_f32 v73, v71, v67
    v_cvt_pk_bf16_f32 v244, v74, v75
    v_cvt_pk_bf16_f32 v240, v72, v73
    v_lshlrev_b32 v64, 16, v237
    v_and_b32 v65, 0xffff0000, v237
    v_lshlrev_b32 v66, 16, v241
    v_and_b32 v67, 0xffff0000, v241
    v_lshlrev_b32 v68, 16, v245
    v_and_b32 v69, 0xffff0000, v245
    v_add_f32 v70, v64, v68
    v_add_f32 v71, v65, v69
    v_fma_f32 v74, 2.0, v68, v66
    v_fma_f32 v75, 2.0, v69, v67
    v_add_f32 v72, v70, v66
    v_add_f32 v73, v71, v67
    v_fma_f32 v74, 2.0, v74, v64
    v_fma_f32 v75, 2.0, v75, v65
    v_cvt_pk_bf16_f32 v237, v72, v73
    v_sub_f32 v72, v70, v66
    v_sub_f32 v73, v71, v67
    v_cvt_pk_bf16_f32 v245, v74, v75
    v_cvt_pk_bf16_f32 v241, v72, v73
    v_lshlrev_b32 v64, 16, v238
    v_and_b32 v65, 0xffff0000, v238
    v_lshlrev_b32 v66, 16, v242
    v_and_b32 v67, 0xffff0000, v242
    v_lshlrev_b32 v68, 16, v246
    v_and_b32 v69, 0xffff0000, v246
    v_add_f32 v70, v64, v68
    v_add_f32 v71, v65, v69
    v_fma_f32 v74, 2.0, v68, v66
    v_fma_f32 v75, 2.0, v69, v67
    v_add_f32 v72, v70, v66
    v_add_f32 v73, v71, v67
    v_fma_f32 v74, 2.0, v74, v64
    v_fma_f32 v75, 2.0, v75, v65
    v_cvt_pk_bf16_f32 v238, v72, v73
    v_sub_f32 v72, v70, v66
    v_sub_f32 v73, v71, v67
    v_cvt_pk_bf16_f32 v246, v74, v75
    v_cvt_pk_bf16_f32 v242, v72, v73
    v_lshlrev_b32 v64, 16, v239
    v_and_b32 v65, 0xffff0000, v239
    v_lshlrev_b32 v66, 16, v243
    v_and_b32 v67, 0xffff0000, v243
    v_lshlrev_b32 v68, 16, v247
    v_and_b32 v69, 0xffff0000, v247
    v_add_f32 v70, v64, v68
    v_add_f32 v71, v65, v69
    v_fma_f32 v74, 2.0, v68, v66
    v_fma_f32 v75, 2.0, v69, v67
    v_add_f32 v72, v70, v66
    v_add_f32 v73, v71, v67
    v_fma_f32 v74, 2.0, v74, v64
    v_fma_f32 v75, 2.0, v75, v65
    v_cvt_pk_bf16_f32 v239, v72, v73
    v_sub_f32 v72, v70, v66
    v_sub_f32 v73, v71, v67
    v_cvt_pk_bf16_f32 v247, v74, v75
    v_cvt_pk_bf16_f32 v243, v72, v73
    s_mov_b32 s60, 8650752
    buffer_store_dwordx4 v[236:239], v85, s[32:35], s60 offen sc1
    s_waitcnt vmcnt(21)
    v_lshlrev_b32 v64, 16, v128
    v_and_b32 v65, 0xffff0000, v128
    v_lshlrev_b32 v66, 16, v132
    v_and_b32 v67, 0xffff0000, v132
    v_lshlrev_b32 v68, 16, v136
    v_and_b32 v69, 0xffff0000, v136
    v_add_f32 v70, v64, v68
    v_add_f32 v71, v65, v69
    v_fma_f32 v74, 2.0, v68, v66
    v_fma_f32 v75, 2.0, v69, v67
    v_add_f32 v72, v70, v66
    v_add_f32 v73, v71, v67
    v_fma_f32 v74, 2.0, v74, v64
    v_fma_f32 v75, 2.0, v75, v65
    v_cvt_pk_bf16_f32 v128, v72, v73
    v_sub_f32 v72, v70, v66
    v_sub_f32 v73, v71, v67
    v_cvt_pk_bf16_f32 v136, v74, v75
    v_cvt_pk_bf16_f32 v132, v72, v73
    v_lshlrev_b32 v64, 16, v129
    v_and_b32 v65, 0xffff0000, v129
    v_lshlrev_b32 v66, 16, v133
    v_and_b32 v67, 0xffff0000, v133
    v_lshlrev_b32 v68, 16, v137
    v_and_b32 v69, 0xffff0000, v137
    v_add_f32 v70, v64, v68
    v_add_f32 v71, v65, v69
    v_fma_f32 v74, 2.0, v68, v66
    v_fma_f32 v75, 2.0, v69, v67
    v_add_f32 v72, v70, v66
    v_add_f32 v73, v71, v67
    v_fma_f32 v74, 2.0, v74, v64
    v_fma_f32 v75, 2.0, v75, v65
    v_cvt_pk_bf16_f32 v129, v72, v73
    v_sub_f32 v72, v70, v66
    v_sub_f32 v73, v71, v67
    v_cvt_pk_bf16_f32 v137, v74, v75
    v_cvt_pk_bf16_f32 v133, v72, v73
    v_lshlrev_b32 v64, 16, v130
    v_and_b32 v65, 0xffff0000, v130
    v_lshlrev_b32 v66, 16, v134
    v_and_b32 v67, 0xffff0000, v134
    v_lshlrev_b32 v68, 16, v138
    v_and_b32 v69, 0xffff0000, v138
    v_add_f32 v70, v64, v68
    v_add_f32 v71, v65, v69
    v_fma_f32 v74, 2.0, v68, v66
    v_fma_f32 v75, 2.0, v69, v67
    v_add_f32 v72, v70, v66
    v_add_f32 v73, v71, v67
    v_fma_f32 v74, 2.0, v74, v64
    v_fma_f32 v75, 2.0, v75, v65
    v_cvt_pk_bf16_f32 v130, v72, v73
    v_sub_f32 v72, v70, v66
    v_sub_f32 v73, v71, v67
    v_cvt_pk_bf16_f32 v138, v74, v75
    v_cvt_pk_bf16_f32 v134, v72, v73
    v_lshlrev_b32 v64, 16, v131
    v_and_b32 v65, 0xffff0000, v131
    v_lshlrev_b32 v66, 16, v135
    v_and_b32 v67, 0xffff0000, v135
    v_lshlrev_b32 v68, 16, v139
    v_and_b32 v69, 0xffff0000, v139
    v_add_f32 v70, v64, v68
    v_add_f32 v71, v65, v69
    v_fma_f32 v74, 2.0, v68, v66
    v_fma_f32 v75, 2.0, v69, v67
    v_add_f32 v72, v70, v66
    v_add_f32 v73, v71, v67
    v_fma_f32 v74, 2.0, v74, v64
    v_fma_f32 v75, 2.0, v75, v65
    v_cvt_pk_bf16_f32 v131, v72, v73
    v_sub_f32 v72, v70, v66
    v_sub_f32 v73, v71, v67
    v_cvt_pk_bf16_f32 v139, v74, v75
    v_cvt_pk_bf16_f32 v135, v72, v73
    s_mov_b32 s60, 0
    buffer_store_dwordx4 v[128:131], v76, s[32:35], s60 offen sc1
    s_barrier
    s_waitcnt vmcnt(19)
    v_lshlrev_b32 v64, 16, v140
    v_and_b32 v65, 0xffff0000, v140
    v_lshlrev_b32 v66, 16, v144
    v_and_b32 v67, 0xffff0000, v144
    v_lshlrev_b32 v68, 16, v148
    v_and_b32 v69, 0xffff0000, v148
    v_add_f32 v70, v64, v68
    v_add_f32 v71, v65, v69
    v_fma_f32 v74, 2.0, v68, v66
    v_fma_f32 v75, 2.0, v69, v67
    v_add_f32 v72, v70, v66
    v_add_f32 v73, v71, v67
    v_fma_f32 v74, 2.0, v74, v64
    v_fma_f32 v75, 2.0, v75, v65
    v_cvt_pk_bf16_f32 v140, v72, v73
    v_sub_f32 v72, v70, v66
    v_sub_f32 v73, v71, v67
    v_cvt_pk_bf16_f32 v148, v74, v75
    v_cvt_pk_bf16_f32 v144, v72, v73
    v_lshlrev_b32 v64, 16, v141
    v_and_b32 v65, 0xffff0000, v141
    v_lshlrev_b32 v66, 16, v145
    v_and_b32 v67, 0xffff0000, v145
    v_lshlrev_b32 v68, 16, v149
    v_and_b32 v69, 0xffff0000, v149
    v_add_f32 v70, v64, v68
    v_add_f32 v71, v65, v69
    v_fma_f32 v74, 2.0, v68, v66
    v_fma_f32 v75, 2.0, v69, v67
    v_add_f32 v72, v70, v66
    v_add_f32 v73, v71, v67
    v_fma_f32 v74, 2.0, v74, v64
    v_fma_f32 v75, 2.0, v75, v65
    v_cvt_pk_bf16_f32 v141, v72, v73
    v_sub_f32 v72, v70, v66
    v_sub_f32 v73, v71, v67
    v_cvt_pk_bf16_f32 v149, v74, v75
    v_cvt_pk_bf16_f32 v145, v72, v73
    v_lshlrev_b32 v64, 16, v142
    v_and_b32 v65, 0xffff0000, v142
    v_lshlrev_b32 v66, 16, v146
    v_and_b32 v67, 0xffff0000, v146
    v_lshlrev_b32 v68, 16, v150
    v_and_b32 v69, 0xffff0000, v150
    v_add_f32 v70, v64, v68
    v_add_f32 v71, v65, v69
    v_fma_f32 v74, 2.0, v68, v66
    v_fma_f32 v75, 2.0, v69, v67
    v_add_f32 v72, v70, v66
    v_add_f32 v73, v71, v67
    v_fma_f32 v74, 2.0, v74, v64
    v_fma_f32 v75, 2.0, v75, v65
    v_cvt_pk_bf16_f32 v142, v72, v73
    v_sub_f32 v72, v70, v66
    v_sub_f32 v73, v71, v67
    v_cvt_pk_bf16_f32 v150, v74, v75
    v_cvt_pk_bf16_f32 v146, v72, v73
    v_lshlrev_b32 v64, 16, v143
    v_and_b32 v65, 0xffff0000, v143
    v_lshlrev_b32 v66, 16, v147
    v_and_b32 v67, 0xffff0000, v147
    v_lshlrev_b32 v68, 16, v151
    v_and_b32 v69, 0xffff0000, v151
    v_add_f32 v70, v64, v68
    v_add_f32 v71, v65, v69
    v_fma_f32 v74, 2.0, v68, v66
    v_fma_f32 v75, 2.0, v69, v67
    v_add_f32 v72, v70, v66
    v_add_f32 v73, v71, v67
    v_fma_f32 v74, 2.0, v74, v64
    v_fma_f32 v75, 2.0, v75, v65
    v_cvt_pk_bf16_f32 v143, v72, v73
    v_sub_f32 v72, v70, v66
    v_sub_f32 v73, v71, v67
    v_cvt_pk_bf16_f32 v151, v74, v75
    v_cvt_pk_bf16_f32 v147, v72, v73
    s_mov_b32 s60, 0
    buffer_store_dwordx4 v[140:143], v77, s[32:35], s60 offen sc1
    s_cmp_lg_u32 s16, 6
    s_cbranch_scc1 L_w_5
    v_mov_b32 v101, 0
    global_load_dword v99, v101, s[12:13] sc1
L_w_5:
    s_waitcnt vmcnt(17)
    v_lshlrev_b32 v64, 16, v152
    v_and_b32 v65, 0xffff0000, v152
    v_lshlrev_b32 v66, 16, v156
    v_and_b32 v67, 0xffff0000, v156
    v_lshlrev_b32 v68, 16, v160
    v_and_b32 v69, 0xffff0000, v160
    v_add_f32 v70, v64, v68
    v_add_f32 v71, v65, v69
    v_fma_f32 v74, 2.0, v68, v66
    v_fma_f32 v75, 2.0, v69, v67
    v_add_f32 v72, v70, v66
    v_add_f32 v73, v71, v67
    v_fma_f32 v74, 2.0, v74, v64
    v_fma_f32 v75, 2.0, v75, v65
    v_cvt_pk_bf16_f32 v152, v72, v73
    v_sub_f32 v72, v70, v66
    v_sub_f32 v73, v71, v67
    v_cvt_pk_bf16_f32 v160, v74, v75
    v_cvt_pk_bf16_f32 v156, v72, v73
    v_lshlrev_b32 v64, 16, v153
    v_and_b32 v65, 0xffff0000, v153
    v_lshlrev_b32 v66, 16, v157
    v_and_b32 v67, 0xffff0000, v157
    v_lshlrev_b32 v68, 16, v161
    v_and_b32 v69, 0xffff0000, v161
    v_add_f32 v70, v64, v68
    v_add_f32 v71, v65, v69
    v_fma_f32 v74, 2.0, v68, v66
    v_fma_f32 v75, 2.0, v69, v67
    v_add_f32 v72, v70, v66
    v_add_f32 v73, v71, v67
    v_fma_f32 v74, 2.0, v74, v64
    v_fma_f32 v75, 2.0, v75, v65
    v_cvt_pk_bf16_f32 v153, v72, v73
    v_sub_f32 v72, v70, v66
    v_sub_f32 v73, v71, v67
    v_cvt_pk_bf16_f32 v161, v74, v75
    v_cvt_pk_bf16_f32 v157, v72, v73
    v_lshlrev_b32 v64, 16, v154
    v_and_b32 v65, 0xffff0000, v154
    v_lshlrev_b32 v66, 16, v158
    v_and_b32 v67, 0xffff0000, v158
    v_lshlrev_b32 v68, 16, v162
    v_and_b32 v69, 0xffff0000, v162
    v_add_f32 v70, v64, v68
    v_add_f32 v71, v65, v69
    v_fma_f32 v74, 2.0, v68, v66
    v_fma_f32 v75, 2.0, v69, v67
    v_add_f32 v72, v70, v66
    v_add_f32 v73, v71, v67
    v_fma_f32 v74, 2.0, v74, v64
    v_fma_f32 v75, 2.0, v75, v65
    v_cvt_pk_bf16_f32 v154, v72, v73
    v_sub_f32 v72, v70, v66
    v_sub_f32 v73, v71, v67
    v_cvt_pk_bf16_f32 v162, v74, v75
    v_cvt_pk_bf16_f32 v158, v72, v73
    v_lshlrev_b32 v64, 16, v155
    v_and_b32 v65, 0xffff0000, v155
    v_lshlrev_b32 v66, 16, v159
    v_and_b32 v67, 0xffff0000, v159
    v_lshlrev_b32 v68, 16, v163
    v_and_b32 v69, 0xffff0000, v163
    v_add_f32 v70, v64, v68
    v_add_f32 v71, v65, v69
    v_fma_f32 v74, 2.0, v68, v66
    v_fma_f32 v75, 2.0, v69, v67
    v_add_f32 v72, v70, v66
    v_add_f32 v73, v71, v67
    v_fma_f32 v74, 2.0, v74, v64
    v_fma_f32 v75, 2.0, v75, v65
    v_cvt_pk_bf16_f32 v155, v72, v73
    v_sub_f32 v72, v70, v66
    v_sub_f32 v73, v71, v67
    v_cvt_pk_bf16_f32 v163, v74, v75
    v_cvt_pk_bf16_f32 v159, v72, v73
    s_mov_b32 s60, 0
    buffer_store_dwordx4 v[152:155], v78, s[32:35], s60 offen sc1
    s_barrier
    s_waitcnt vmcnt(15)
    v_lshlrev_b32 v64, 16, v164
    v_and_b32 v65, 0xffff0000, v164
    v_lshlrev_b32 v66, 16, v168
    v_and_b32 v67, 0xffff0000, v168
    v_lshlrev_b32 v68, 16, v172
    v_and_b32 v69, 0xffff0000, v172
    v_add_f32 v70, v64, v68
    v_add_f32 v71, v65, v69
    v_fma_f32 v74, 2.0, v68, v66
    v_fma_f32 v75, 2.0, v69, v67
    v_add_f32 v72, v70, v66
    v_add_f32 v73, v71, v67
    v_fma_f32 v74, 2.0, v74, v64
    v_fma_f32 v75, 2.0, v75, v65
    v_cvt_pk_bf16_f32 v164, v72, v73
    v_sub_f32 v72, v70, v66
    v_sub_f32 v73, v71, v67
    v_cvt_pk_bf16_f32 v172, v74, v75
    v_cvt_pk_bf16_f32 v168, v72, v73
    v_lshlrev_b32 v64, 16, v165
    v_and_b32 v65, 0xffff0000, v165
    v_lshlrev_b32 v66, 16, v169
    v_and_b32 v67, 0xffff0000, v169
    v_lshlrev_b32 v68, 16, v173
    v_and_b32 v69, 0xffff0000, v173
    v_add_f32 v70, v64, v68
    v_add_f32 v71, v65, v69
    v_fma_f32 v74, 2.0, v68, v66
    v_fma_f32 v75, 2.0, v69, v67
    v_add_f32 v72, v70, v66
    v_add_f32 v73, v71, v67
    v_fma_f32 v74, 2.0, v74, v64
    v_fma_f32 v75, 2.0, v75, v65
    v_cvt_pk_bf16_f32 v165, v72, v73
    v_sub_f32 v72, v70, v66
    v_sub_f32 v73, v71, v67
    v_cvt_pk_bf16_f32 v173, v74, v75
    v_cvt_pk_bf16_f32 v169, v72, v73
    v_lshlrev_b32 v64, 16, v166
    v_and_b32 v65, 0xffff0000, v166
    v_lshlrev_b32 v66, 16, v170
    v_and_b32 v67, 0xffff0000, v170
    v_lshlrev_b32 v68, 16, v174
    v_and_b32 v69, 0xffff0000, v174
    v_add_f32 v70, v64, v68
    v_add_f32 v71, v65, v69
    v_fma_f32 v74, 2.0, v68, v66
    v_fma_f32 v75, 2.0, v69, v67
    v_add_f32 v72, v70, v66
    v_add_f32 v73, v71, v67
    v_fma_f32 v74, 2.0, v74, v64
    v_fma_f32 v75, 2.0, v75, v65
    v_cvt_pk_bf16_f32 v166, v72, v73
    v_sub_f32 v72, v70, v66
    v_sub_f32 v73, v71, v67
    v_cvt_pk_bf16_f32 v174, v74, v75
    v_cvt_pk_bf16_f32 v170, v72, v73
    v_lshlrev_b32 v64, 16, v167
    v_and_b32 v65, 0xffff0000, v167
    v_lshlrev_b32 v66, 16, v171
    v_and_b32 v67, 0xffff0000, v171
    v_lshlrev_b32 v68, 16, v175
    v_and_b32 v69, 0xffff0000, v175
    v_add_f32 v70, v64, v68
    v_add_f32 v71, v65, v69
    v_fma_f32 v74, 2.0, v68, v66
    v_fma_f32 v75, 2.0, v69, v67
    v_add_f32 v72, v70, v66
    v_add_f32 v73, v71, v67
    v_fma_f32 v74, 2.0, v74, v64
    v_fma_f32 v75, 2.0, v75, v65
    v_cvt_pk_bf16_f32 v167, v72, v73
    v_sub_f32 v72, v70, v66
    v_sub_f32 v73, v71, v67
    v_cvt_pk_bf16_f32 v175, v74, v75
    v_cvt_pk_bf16_f32 v171, v72, v73
    s_mov_b32 s60, 0
    buffer_store_dwordx4 v[164:167], v79, s[32:35], s60 offen sc1
    s_waitcnt vmcnt(12)
    v_lshlrev_b32 v64, 16, v176
    v_and_b32 v65, 0xffff0000, v176
    v_lshlrev_b32 v66, 16, v180
    v_and_b32 v67, 0xffff0000, v180
    v_lshlrev_b32 v68, 16, v184
    v_and_b32 v69, 0xffff0000, v184
    v_add_f32 v70, v64, v68
    v_add_f32 v71, v65, v69
    v_fma_f32 v74, 2.0, v68, v66
    v_fma_f32 v75, 2.0, v69, v67
    v_add_f32 v72, v70, v66
    v_add_f32 v73, v71, v67
    v_fma_f32 v74, 2.0, v74, v64
    v_fma_f32 v75, 2.0, v75, v65
    v_cvt_pk_bf16_f32 v176, v72, v73
    v_sub_f32 v72, v70, v66
    v_sub_f32 v73, v71, v67
    v_cvt_pk_bf16_f32 v184, v74, v75
    v_cvt_pk_bf16_f32 v180, v72, v73
    v_lshlrev_b32 v64, 16, v177
    v_and_b32 v65, 0xffff0000, v177
    v_lshlrev_b32 v66, 16, v181
    v_and_b32 v67, 0xffff0000, v181
    v_lshlrev_b32 v68, 16, v185
    v_and_b32 v69, 0xffff0000, v185
    v_add_f32 v70, v64, v68
    v_add_f32 v71, v65, v69
    v_fma_f32 v74, 2.0, v68, v66
    v_fma_f32 v75, 2.0, v69, v67
    v_add_f32 v72, v70, v66
    v_add_f32 v73, v71, v67
    v_fma_f32 v74, 2.0, v74, v64
    v_fma_f32 v75, 2.0, v75, v65
    v_cvt_pk_bf16_f32 v177, v72, v73
    v_sub_f32 v72, v70, v66
    v_sub_f32 v73, v71, v67
    v_cvt_pk_bf16_f32 v185, v74, v75
    v_cvt_pk_bf16_f32 v181, v72, v73
    v_lshlrev_b32 v64, 16, v178
    v_and_b32 v65, 0xffff0000, v178
    v_lshlrev_b32 v66, 16, v182
    v_and_b32 v67, 0xffff0000, v182
    v_lshlrev_b32 v68, 16, v186
    v_and_b32 v69, 0xffff0000, v186
    v_add_f32 v70, v64, v68
    v_add_f32 v71, v65, v69
    v_fma_f32 v74, 2.0, v68, v66
    v_fma_f32 v75, 2.0, v69, v67
    v_add_f32 v72, v70, v66
    v_add_f32 v73, v71, v67
    v_fma_f32 v74, 2.0, v74, v64
    v_fma_f32 v75, 2.0, v75, v65
    v_cvt_pk_bf16_f32 v178, v72, v73
    v_sub_f32 v72, v70, v66
    v_sub_f32 v73, v71, v67
    v_cvt_pk_bf16_f32 v186, v74, v75
    v_cvt_pk_bf16_f32 v182, v72, v73
    v_lshlrev_b32 v64, 16, v179
    v_and_b32 v65, 0xffff0000, v179
    v_lshlrev_b32 v66, 16, v183
    v_and_b32 v67, 0xffff0000, v183
    v_lshlrev_b32 v68, 16, v187
    v_and_b32 v69, 0xffff0000, v187
    v_add_f32 v70, v64, v68
    v_add_f32 v71, v65, v69
    v_fma_f32 v74, 2.0, v68, v66
    v_fma_f32 v75, 2.0, v69, v67
    v_add_f32 v72, v70, v66
    v_add_f32 v73, v71, v67
    v_fma_f32 v74, 2.0, v74, v64
    v_fma_f32 v75, 2.0, v75, v65
    v_cvt_pk_bf16_f32 v179, v72, v73
    v_sub_f32 v72, v70, v66
    v_sub_f32 v73, v71, v67
    v_cvt_pk_bf16_f32 v187, v74, v75
    v_cvt_pk_bf16_f32 v183, v72, v73
    s_mov_b32 s60, 0
    buffer_store_dwordx4 v[176:179], v80, s[32:35], s60 offen sc1
    s_barrier
    s_waitcnt vmcnt(10)
    v_lshlrev_b32 v64, 16, v188
    v_and_b32 v65, 0xffff0000, v188
    v_lshlrev_b32 v66, 16, v192
    v_and_b32 v67, 0xffff0000, v192
    v_lshlrev_b32 v68, 16, v196
    v_and_b32 v69, 0xffff0000, v196
    v_add_f32 v70, v64, v68
    v_add_f32 v71, v65, v69
    v_fma_f32 v74, 2.0, v68, v66
    v_fma_f32 v75, 2.0, v69, v67
    v_add_f32 v72, v70, v66
    v_add_f32 v73, v71, v67
    v_fma_f32 v74, 2.0, v74, v64
    v_fma_f32 v75, 2.0, v75, v65
    v_cvt_pk_bf16_f32 v188, v72, v73
    v_sub_f32 v72, v70, v66
    v_sub_f32 v73, v71, v67
    v_cvt_pk_bf16_f32 v196, v74, v75
    v_cvt_pk_bf16_f32 v192, v72, v73
    v_lshlrev_b32 v64, 16, v189
    v_and_b32 v65, 0xffff0000, v189
    v_lshlrev_b32 v66, 16, v193
    v_and_b32 v67, 0xffff0000, v193
    v_lshlrev_b32 v68, 16, v197
    v_and_b32 v69, 0xffff0000, v197
    v_add_f32 v70, v64, v68
    v_add_f32 v71, v65, v69
    v_fma_f32 v74, 2.0, v68, v66
    v_fma_f32 v75, 2.0, v69, v67
    v_add_f32 v72, v70, v66
    v_add_f32 v73, v71, v67
    v_fma_f32 v74, 2.0, v74, v64
    v_fma_f32 v75, 2.0, v75, v65
    v_cvt_pk_bf16_f32 v189, v72, v73
    v_sub_f32 v72, v70, v66
    v_sub_f32 v73, v71, v67
    v_cvt_pk_bf16_f32 v197, v74, v75
    v_cvt_pk_bf16_f32 v193, v72, v73
    v_lshlrev_b32 v64, 16, v190
    v_and_b32 v65, 0xffff0000, v190
    v_lshlrev_b32 v66, 16, v194
    v_and_b32 v67, 0xffff0000, v194
    v_lshlrev_b32 v68, 16, v198
    v_and_b32 v69, 0xffff0000, v198
    v_add_f32 v70, v64, v68
    v_add_f32 v71, v65, v69
    v_fma_f32 v74, 2.0, v68, v66
    v_fma_f32 v75, 2.0, v69, v67
    v_add_f32 v72, v70, v66
    v_add_f32 v73, v71, v67
    v_fma_f32 v74, 2.0, v74, v64
    v_fma_f32 v75, 2.0, v75, v65
    v_cvt_pk_bf16_f32 v190, v72, v73
    v_sub_f32 v72, v70, v66
    v_sub_f32 v73, v71, v67
    v_cvt_pk_bf16_f32 v198, v74, v75
    v_cvt_pk_bf16_f32 v194, v72, v73
    v_lshlrev_b32 v64, 16, v191
    v_and_b32 v65, 0xffff0000, v191
    v_lshlrev_b32 v66, 16, v195
    v_and_b32 v67, 0xffff0000, v195
    v_lshlrev_b32 v68, 16, v199
    v_and_b32 v69, 0xffff0000, v199
    v_add_f32 v70, v64, v68
    v_add_f32 v71, v65, v69
    v_fma_f32 v74, 2.0, v68, v66
    v_fma_f32 v75, 2.0, v69, v67
    v_add_f32 v72, v70, v66
    v_add_f32 v73, v71, v67
    v_fma_f32 v74, 2.0, v74, v64
    v_fma_f32 v75, 2.0, v75, v65
    v_cvt_pk_bf16_f32 v191, v72, v73
    v_sub_f32 v72, v70, v66
    v_sub_f32 v73, v71, v67
    v_cvt_pk_bf16_f32 v199, v74, v75
    v_cvt_pk_bf16_f32 v195, v72, v73
    s_mov_b32 s60, 0
    buffer_store_dwordx4 v[188:191], v81, s[32:35], s60 offen sc1
    s_waitcnt vmcnt(8)
    v_lshlrev_b32 v64, 16, v200
    v_and_b32 v65, 0xffff0000, v200
    v_lshlrev_b32 v66, 16, v204
    v_and_b32 v67, 0xffff0000, v204
    v_lshlrev_b32 v68, 16, v208
    v_and_b32 v69, 0xffff0000, v208
    v_add_f32 v70, v64, v68
    v_add_f32 v71, v65, v69
    v_fma_f32 v74, 2.0, v68, v66
    v_fma_f32 v75, 2.0, v69, v67
    v_add_f32 v72, v70, v66
    v_add_f32 v73, v71, v67
    v_fma_f32 v74, 2.0, v74, v64
    v_fma_f32 v75, 2.0, v75, v65
    v_cvt_pk_bf16_f32 v200, v72, v73
    v_sub_f32 v72, v70, v66
    v_sub_f32 v73, v71, v67
    v_cvt_pk_bf16_f32 v208, v74, v75
    v_cvt_pk_bf16_f32 v204, v72, v73
    v_lshlrev_b32 v64, 16, v201
    v_and_b32 v65, 0xffff0000, v201
    v_lshlrev_b32 v66, 16, v205
    v_and_b32 v67, 0xffff0000, v205
    v_lshlrev_b32 v68, 16, v209
    v_and_b32 v69, 0xffff0000, v209
    v_add_f32 v70, v64, v68
    v_add_f32 v71, v65, v69
    v_fma_f32 v74, 2.0, v68, v66
    v_fma_f32 v75, 2.0, v69, v67
    v_add_f32 v72, v70, v66
    v_add_f32 v73, v71, v67
    v_fma_f32 v74, 2.0, v74, v64
    v_fma_f32 v75, 2.0, v75, v65
    v_cvt_pk_bf16_f32 v201, v72, v73
    v_sub_f32 v72, v70, v66
    v_sub_f32 v73, v71, v67
    v_cvt_pk_bf16_f32 v209, v74, v75
    v_cvt_pk_bf16_f32 v205, v72, v73
    v_lshlrev_b32 v64, 16, v202
    v_and_b32 v65, 0xffff0000, v202
    v_lshlrev_b32 v66, 16, v206
    v_and_b32 v67, 0xffff0000, v206
    v_lshlrev_b32 v68, 16, v210
    v_and_b32 v69, 0xffff0000, v210
    v_add_f32 v70, v64, v68
    v_add_f32 v71, v65, v69
    v_fma_f32 v74, 2.0, v68, v66
    v_fma_f32 v75, 2.0, v69, v67
    v_add_f32 v72, v70, v66
    v_add_f32 v73, v71, v67
    v_fma_f32 v74, 2.0, v74, v64
    v_fma_f32 v75, 2.0, v75, v65
    v_cvt_pk_bf16_f32 v202, v72, v73
    v_sub_f32 v72, v70, v66
    v_sub_f32 v73, v71, v67
    v_cvt_pk_bf16_f32 v210, v74, v75
    v_cvt_pk_bf16_f32 v206, v72, v73
    v_lshlrev_b32 v64, 16, v203
    v_and_b32 v65, 0xffff0000, v203
    v_lshlrev_b32 v66, 16, v207
    v_and_b32 v67, 0xffff0000, v207
    v_lshlrev_b32 v68, 16, v211
    v_and_b32 v69, 0xffff0000, v211
    v_add_f32 v70, v64, v68
    v_add_f32 v71, v65, v69
    v_fma_f32 v74, 2.0, v68, v66
    v_fma_f32 v75, 2.0, v69, v67
    v_add_f32 v72, v70, v66
    v_add_f32 v73, v71, v67
    v_fma_f32 v74, 2.0, v74, v64
    v_fma_f32 v75, 2.0, v75, v65
    v_cvt_pk_bf16_f32 v203, v72, v73
    v_sub_f32 v72, v70, v66
    v_sub_f32 v73, v71, v67
    v_cvt_pk_bf16_f32 v211, v74, v75
    v_cvt_pk_bf16_f32 v207, v72, v73
    s_mov_b32 s60, 0
    buffer_store_dwordx4 v[200:203], v82, s[32:35], s60 offen sc1
    s_barrier
    s_mov_b32 s60, 10027008
    buffer_store_dwordx4 v[216:219], v83, s[32:35], s60 offen sc1
    s_mov_b32 s60, 11403264
    buffer_store_dwordx4 v[220:223], v83, s[32:35], s60 offen sc1
    s_mov_b32 s60, 10027008
    buffer_store_dwordx4 v[228:231], v84, s[32:35], s60 offen sc1
    s_mov_b32 s60, 11403264
    buffer_store_dwordx4 v[232:235], v84, s[32:35], s60 offen sc1
    s_barrier
    s_mov_b32 s60, 10027008
    buffer_store_dwordx4 v[240:243], v85, s[32:35], s60 offen sc1
    s_mov_b32 s60, 11403264
    buffer_store_dwordx4 v[244:247], v85, s[32:35], s60 offen sc1
    s_mov_b32 s60, 360448
    buffer_store_dwordx4 v[132:135], v76, s[32:35], s60 offen sc1
    s_mov_b32 s60, 720896
    buffer_store_dwordx4 v[136:139], v76, s[32:35], s60 offen sc1
    s_waitcnt vmcnt(8)
    s_barrier
    s_cmp_lg_u32 s16, 6
    s_cbranch_scc1 L_w_6
    s_mov_b32 s58, 100000
    v_mov_b32 v101, 0
L_tg_7:
    v_readfirstlane_b32 s75, v99
    s_nop 3
    s_cmp_lg_u32 s75, 0
    s_cbranch_scc1 L_tgk_8
    global_load_dword v99, v101, s[12:13] sc1
    s_waitcnt vmcnt(0)
    s_sub_u32 s58, s58, 1
    s_cmp_lg_u32 s58, 0
    s_cbranch_scc1 L_tg_7
L_tgk_8:
    s_lshl_b32 s52, s66, 2
    s_add_u32 s52, s52, 25165824
    s_mov_b64 s[54:55], exec
    s_mov_b64 exec, 1
    v_mov_b32 v92, s75
    v_mov_b32 v93, s52
    buffer_store_dword v92, v93, s[0:3], 0 offen sc1
    s_mov_b64 exec, s[54:55]
    s_nop 3
L_w_6:
    s_mov_b32 s60, 360448
    buffer_store_dwordx4 v[144:147], v77, s[32:35], s60 offen sc1
    s_mov_b32 s60, 720896
    buffer_store_dwordx4 v[148:151], v77, s[32:35], s60 offen sc1
    s_mov_b32 s60, 360448
    buffer_store_dwordx4 v[156:159], v78, s[32:35], s60 offen sc1
    s_mov_b32 s60, 720896
    buffer_store_dwordx4 v[160:163], v78, s[32:35], s60 offen sc1
    s_barrier
    s_mov_b32 s60, 360448
    buffer_store_dwordx4 v[168:171], v79, s[32:35], s60 offen sc1
    s_mov_b32 s60, 720896
    buffer_store_dwordx4 v[172:175], v79, s[32:35], s60 offen sc1
    s_mov_b32 s60, 360448
    buffer_store_dwordx4 v[180:183], v80, s[32:35], s60 offen sc1
    s_mov_b32 s60, 720896
    buffer_store_dwordx4 v[184:187], v80, s[32:35], s60 offen sc1
    s_barrier
    s_mov_b32 s60, 360448
    buffer_store_dwordx4 v[192:195], v81, s[32:35], s60 offen sc1
    s_mov_b32 s60, 720896
    buffer_store_dwordx4 v[196:199], v81, s[32:35], s60 offen sc1
    s_mov_b32 s60, 360448
    buffer_store_dwordx4 v[204:207], v82, s[32:35], s60 offen sc1
    s_mov_b32 s60, 720896
    buffer_store_dwordx4 v[208:211], v82, s[32:35], s60 offen sc1
    s_barrier
    s_barrier
    s_cmp_lg_u32 s16, 6
    s_cbranch_scc1 L_w_9
    s_movk_i32 s59, 0
    s_cmp_eq_u32 s21, 1
    s_cbranch_scc1 L_ps_10
    buffer_load_dword v92, v98, s[0:3], s59 offen sc1
    s_branch L_pe_11
L_ps_10:
    buffer_load_dword v92, v97, s[0:3], s59 offen offset:0 sc1
    buffer_load_dword v93, v97, s[0:3], s59 offen offset:256 sc1
    buffer_load_dword v94, v97, s[0:3], s59 offen offset:512 sc1
    buffer_load_dword v95, v97, s[0:3], s59 offen offset:768 sc1
L_pe_11:
L_w_9:
    s_waitcnt vmcnt(0)
    s_cmp_lg_u32 s16, 6
    s_cbranch_scc1 L_w_12
    s_mov_b32 s58, 100000
    s_branch L_fcc_15
L_fc_13:
    s_movk_i32 s59, 0
    s_cmp_eq_u32 s21, 1
    s_cbranch_scc1 L_ps_18
    buffer_load_dword v92, v98, s[0:3], s59 offen sc1
    s_branch L_pe_19
L_ps_18:
    buffer_load_dword v92, v97, s[0:3], s59 offen offset:0 sc1
    buffer_load_dword v93, v97, s[0:3], s59 offen offset:256 sc1
    buffer_load_dword v94, v97, s[0:3], s59 offen offset:512 sc1
    buffer_load_dword v95, v97, s[0:3], s59 offen offset:768 sc1
L_pe_19:
L_fcc_15:
    s_waitcnt vmcnt(0)
    s_cmp_eq_u32 s21, 1
    s_cbranch_scc1 L_fcs_16
    v_cmp_ne_u32 vcc, s75, v92
    s_nop 3
    s_and_b32 vcc_hi, vcc_hi, 0xffff
    s_branch L_fct_17
L_fcs_16:
    v_xor_b32 v92, s75, v92
    v_xor_b32 v93, s75, v93
    v_xor_b32 v94, s75, v94
    v_xor_b32 v95, s75, v95
    v_or3_b32 v92, v92, v93, v94
    v_or_b32 v92, v92, v95
    v_cmp_ne_u32 vcc, 0, v92
    s_nop 3
L_fct_17:
    s_cmp_eq_u64 vcc, 0
    s_cbranch_scc1 L_fcd_14
    s_sleep 4
    s_sub_u32 s58, s58, 1
    s_cmp_lg_u32 s58, 0
    s_cbranch_scc1 L_fc_13
L_fcd_14:
L_w_12:
    s_barrier
    s_cmp_lg_u32 s16, 6
    s_cbranch_scc1 L_w_20
    s_lshl_b32 s52, s66, 2
    s_add_u32 s52, s52, 25166848
    s_mov_b64 s[54:55], exec
    s_mov_b64 exec, 1
    v_mov_b32 v92, s75
    v_mov_b32 v93, s52
    buffer_store_dword v92, v93, s[0:3], 0 offen sc1
    s_mov_b64 exec, s[54:55]
    s_nop 3
L_w_20:
    s_barrier
    s_barrier
    s_barrier
    s_barrier
    s_barrier
    s_barrier
    s_barrier
    s_cmp_lg_u32 s16, 6
    s_cbranch_scc1 L_w_21
    s_movk_i32 s59, 1024
    s_cmp_eq_u32 s21, 1
    s_cbranch_scc1 L_ps_22
    buffer_load_dword v92, v98, s[0:3], s59 offen sc1
    s_branch L_pe_23
L_ps_22:
    buffer_load_dword v92, v97, s[0:3], s59 offen offset:0 sc1
    buffer_load_dword v93, v97, s[0:3], s59 offen offset:256 sc1
    buffer_load_dword v94, v97, s[0:3], s59 offen offset:512 sc1
    buffer_load_dword v95, v97, s[0:3], s59 offen offset:768 sc1
L_pe_23:
L_w_21:
    s_cmp_lg_u32 s16, 6
    s_cbranch_scc1 L_w_24
    s_mov_b32 s58, 100000
    s_branch L_fcc_27
L_fc_25:
    s_movk_i32 s59, 1024
    s_cmp_eq_u32 s21, 1
    s_cbranch_scc1 L_ps_30
    buffer_load_dword v92, v98, s[0:3], s59 offen sc1
    s_branch L_pe_31
L_ps_30:
    buffer_load_dword v92, v97, s[0:3], s59 offen offset:0 sc1
    buffer_load_dword v93, v97, s[0:3], s59 offen offset:256 sc1
    buffer_load_dword v94, v97, s[0:3], s59 offen offset:512 sc1
    buffer_load_dword v95, v97, s[0:3], s59 offen offset:768 sc1
L_pe_31:
L_fcc_27:
    s_waitcnt vmcnt(0)
    s_cmp_eq_u32 s21, 1
    s_cbranch_scc1 L_fcs_28
    v_cmp_ne_u32 vcc, s75, v92
    s_nop 3
    s_and_b32 vcc_hi, vcc_hi, 0xffff
    s_branch L_fct_29
L_fcs_28:
    v_xor_b32 v92, s75, v92
    v_xor_b32 v93, s75, v93
    v_xor_b32 v94, s75, v94
    v_xor_b32 v95, s75, v95
    v_or3_b32 v92, v92, v93, v94
    v_or_b32 v92, v92, v95
    v_cmp_ne_u32 vcc, 0, v92
    s_nop 3
L_fct_29:
    s_cmp_eq_u64 vcc, 0
    s_cbranch_scc1 L_fcd_26
    s_sleep 4
    s_sub_u32 s58, s58, 1
    s_cmp_lg_u32 s58, 0
    s_cbranch_scc1 L_fc_25
L_fcd_26:
L_w_24:
    s_barrier
    s_barrier
    s_lshl_b32 s67, s17, 17
    s_sub_u32 s56, s16, 4
    s_lshl_b32 s56, s56, 15
    s_add_u32 s67, s67, s56
    s_add_u32 s67, s67, 23068672
    v_and_b32 v62, 63, v0
    v_lshlrev_b32 v62, 4, v62
    s_barrier
    s_add_u32 s56, s67, 0
    buffer_load_dwordx4 v[128:131], v62, s[0:3], s56 offen
    s_add_u32 s56, s67, 1024
    buffer_load_dwordx4 v[132:135], v62, s[0:3], s56 offen
    s_barrier
    s_add_u32 s56, s67, 2048
    buffer_load_dwordx4 v[136:139], v62, s[0:3], s56 offen
    s_add_u32 s56, s67, 3072
    buffer_load_dwordx4 v[140:143], v62, s[0:3], s56 offen
    s_barrier
    s_add_u32 s56, s67, 4096
    buffer_load_dwordx4 v[144:147], v62, s[0:3], s56 offen
    s_add_u32 s56, s67, 5120
    buffer_load_dwordx4 v[148:151], v62, s[0:3], s56 offen
    s_barrier
    s_add_u32 s56, s67, 6144
    buffer_load_dwordx4 v[152:155], v62, s[0:3], s56 offen
    s_add_u32 s56, s67, 7168
    buffer_load_dwordx4 v[156:159], v62, s[0:3], s56 offen
    s_barrier
    s_add_u32 s56, s67, 8192
    buffer_load_dwordx4 v[160:163], v62, s[0:3], s56 offen
    s_add_u32 s56, s67, 9216
    buffer_load_dwordx4 v[164:167], v62, s[0:3], s56 offen
    s_barrier
    s_add_u32 s56, s67, 10240
    buffer_load_dwordx4 v[168:171], v62, s[0:3], s56 offen
    s_add_u32 s56, s67, 11264
    buffer_load_dwordx4 v[172:175], v62, s[0:3], s56 offen
    s_barrier
    s_add_u32 s56, s67, 12288
    buffer_load_dwordx4 v[176:179], v62, s[0:3], s56 offen
    s_add_u32 s56, s67, 13312
    buffer_load_dwordx4 v[180:183], v62, s[0:3], s56 offen
    s_barrier
    s_add_u32 s56, s67, 14336
    buffer_load_dwordx4 v[184:187], v62, s[0:3], s56 offen
    s_add_u32 s56, s67, 15360
    buffer_load_dwordx4 v[188:191], v62, s[0:3], s56 offen
    s_barrier
    s_add_u32 s56, s67, 16384
    buffer_load_dwordx4 v[192:195], v62, s[0:3], s56 offen
    s_add_u32 s56, s67, 17408
    buffer_load_dwordx4 v[196:199], v62, s[0:3], s56 offen
    s_barrier
    s_add_u32 s56, s67, 18432
    buffer_load_dwordx4 v[200:203], v62, s[0:3], s56 offen
    s_add_u32 s56, s67, 19456
    buffer_load_dwordx4 v[204:207], v62, s[0:3], s56 offen
    s_barrier
    s_add_u32 s56, s67, 20480
    buffer_load_dwordx4 v[208:211], v62, s[0:3], s56 offen
    s_add_u32 s56, s67, 21504
    buffer_load_dwordx4 v[212:215], v62, s[0:3], s56 offen
    s_barrier
    s_add_u32 s56, s67, 22528
    buffer_load_dwordx4 v[216:219], v62, s[0:3], s56 offen
    s_add_u32 s56, s67, 23552
    buffer_load_dwordx4 v[220:223], v62, s[0:3], s56 offen
    s_cmp_lg_u32 s16, 6
    s_cbranch_scc1 L_w_32
    s_movk_i32 s59, 2976
    buffer_load_dword v96, v97, s[0:3], s59 offen sc1
L_w_32:
    s_barrier
    s_add_u32 s56, s67, 24576
    buffer_load_dwordx4 v[224:227], v62, s[0:3], s56 offen
    s_add_u32 s56, s67, 25600
    buffer_load_dwordx4 v[228:231], v62, s[0:3], s56 offen
    s_barrier
    s_add_u32 s56, s67, 26624
    buffer_load_dwordx4 v[232:235], v62, s[0:3], s56 offen
    s_add_u32 s56, s67, 27648
    buffer_load_dwordx4 v[236:239], v62, s[0:3], s56 offen
    s_barrier
    s_add_u32 s56, s67, 28672
    buffer_load_dwordx4 v[240:243], v62, s[0:3], s56 offen
    s_add_u32 s56, s67, 29696
    buffer_load_dwordx4 v[244:247], v62, s[0:3], s56 offen
    s_cmp_lg_u32 s16, 6
    s_cbranch_scc1 L_w_36
    s_waitcnt vmcnt(6)
    s_movk_i32 s59, 2976
    s_mov_b32 s58, 100000
    s_mov_b64 s[54:55], exec
    s_mov_b32 exec_lo, 0xffffff
    s_mov_b32 exec_hi, 0
    v_mov_b32 v92, v96
    s_branch L_svc_39
L_sv_37:
    buffer_load_dword v92, v97, s[0:3], s59 offen sc1
    s_waitcnt vmcnt(0)
L_svc_39:
    v_cmp_ne_u32 vcc, s75, v92
    s_nop 3
    s_cmp_eq_u64 vcc, 0
    s_cbranch_scc1 L_svd_38
    s_sleep 4
    s_sub_u32 s58, s58, 1
    s_cmp_lg_u32 s58, 0
    s_cbranch_scc1 L_sv_37
L_svd_38:
    s_mov_b64 exec, s[54:55]
    s_nop 3
L_w_36:
    s_barrier
    s_add_u32 s56, s67, 30720
    buffer_load_dwordx4 v[248:251], v62, s[0:3], s56 offen
    s_add_u32 s56, s67, 31744
    buffer_load_dwordx4 v[252:255], v62, s[0:3], s56 offen
    s_barrier
    s_barrier
    s_branch L_join
L_compute:
    v_and_b32 v1, 63, v0
    s_cmp_lg_u32 s16, 0
    s_cbranch_scc1 L_cpf_40
    s_getpc_b64 s[52:53]
L_pcref:
    s_sub_u32 s52, s52, L_pcref-standalone__autoregressive_conv_wavenet__speech_kernel
    s_subb_u32 s53, s53, 0
    s_mul_i32 s54, s18, 17
    v_min_u32 v2, 16, v1
    v_add_u32 v2, s54, v2
    v_lshlrev_b32 v2, 7, v2
    s_mov_b32 s54, L_end-standalone__autoregressive_conv_wavenet__speech_kernel
    v_min_u32 v2, s54, v2
    global_load_dword v127, v2, s[52:53]
L_cpf_40:
    v_mov_b64 v[128:129], 0
    v_mov_b64 v[130:131], 0
    v_mov_b64 v[132:133], 0
    v_mov_b64 v[134:135], 0
    v_mov_b64 v[136:137], 0
    v_mov_b64 v[138:139], 0
    v_mov_b64 v[140:141], 0
    v_mov_b64 v[142:143], 0
    v_mov_b64 v[144:145], 0
    v_mov_b64 v[146:147], 0
    v_mov_b64 v[148:149], 0
    v_mov_b64 v[150:151], 0
    v_mov_b64 v[152:153], 0
    v_mov_b64 v[154:155], 0
    v_mov_b64 v[156:157], 0
    v_mov_b64 v[158:159], 0
    v_mov_b64 v[160:161], 0
    v_mov_b64 v[162:163], 0
    v_mov_b64 v[164:165], 0
    v_mov_b64 v[166:167], 0
    v_mov_b64 v[168:169], 0
    v_mov_b64 v[170:171], 0
    v_mov_b64 v[172:173], 0
    v_mov_b64 v[174:175], 0
    v_mov_b64 v[176:177], 0
    v_mov_b64 v[178:179], 0
    v_mov_b64 v[180:181], 0
    v_mov_b64 v[182:183], 0
    v_mov_b64 v[184:185], 0
    v_mov_b64 v[186:187], 0
    v_mov_b64 v[188:189], 0
    v_mov_b64 v[190:191], 0
    v_mov_b64 v[192:193], 0
    v_mov_b64 v[194:195], 0
    v_mov_b64 v[196:197], 0
    v_mov_b64 v[198:199], 0
    v_mov_b64 v[200:201], 0
    v_mov_b64 v[202:203], 0
    v_mov_b64 v[204:205], 0
    v_mov_b64 v[206:207], 0
    v_mov_b64 v[208:209], 0
    v_mov_b64 v[210:211], 0
    v_mov_b64 v[212:213], 0
    v_mov_b64 v[214:215], 0
    v_mov_b64 v[216:217], 0
    v_mov_b64 v[218:219], 0
    v_mov_b64 v[220:221], 0
    v_mov_b64 v[222:223], 0
    v_mov_b64 v[224:225], 0
    v_mov_b64 v[226:227], 0
    v_mov_b64 v[228:229], 0
    v_mov_b64 v[230:231], 0
    v_mov_b64 v[232:233], 0
    v_mov_b64 v[234:235], 0
    v_mov_b64 v[236:237], 0
    v_mov_b64 v[238:239], 0
    v_mov_b64 v[240:241], 0
    v_mov_b64 v[242:243], 0
    v_mov_b64 v[244:245], 0
    v_mov_b64 v[246:247], 0
    v_and_b32 v1, 63, v0
    v_and_b32 v11, 15, v1
    v_lshrrev_b32 v12, 4, v1
    v_add_u32 v13, 4, v11
    v_cmp_gt_u32 vcc, 4, v11
    s_nop 1
    v_cndmask_b32 v13, v13, v11, vcc
    v_subrev_u32 v14, 8, v11
    v_cmp_lt_u32 vcc, 11, v11
    s_nop 1
    v_cndmask_b32 v13, v13, v14, vcc
    v_add_u32 v14, 2, v13
    v_and_b32 v15, 6, v14
    v_add_u32 v2, 0, v12
    v_xor_b32 v2, v2, v15
    v_lshlrev_b32 v2, 4, v2
    v_lshl_add_u32 v2, v14, 7, v2
    v_add_u32 v5, 4, v12
    v_xor_b32 v5, v5, v15
    v_lshlrev_b32 v5, 4, v5
    v_lshl_add_u32 v5, v14, 7, v5
    v_add_u32 v5, 14336, v5
    v_add_u32 v14, 1, v13
    v_and_b32 v15, 6, v14
    v_add_u32 v3, 0, v12
    v_xor_b32 v3, v3, v15
    v_lshlrev_b32 v3, 4, v3
    v_lshl_add_u32 v3, v14, 7, v3
    v_add_u32 v6, 4, v12
    v_xor_b32 v6, v6, v15
    v_lshlrev_b32 v6, 4, v6
    v_lshl_add_u32 v6, v14, 7, v6
    v_add_u32 v6, 14336, v6
    v_add_u32 v14, 0, v13
    v_and_b32 v15, 6, v14
    v_add_u32 v4, 0, v12
    v_xor_b32 v4, v4, v15
    v_lshlrev_b32 v4, 4, v4
    v_lshl_add_u32 v4, v14, 7, v4
    v_add_u32 v7, 4, v12
    v_xor_b32 v7, v7, v15
    v_lshlrev_b32 v7, 4, v7
    v_lshl_add_u32 v7, v14, 7, v7
    v_add_u32 v7, 14336, v7
    v_lshrrev_b32 v14, 2, v11
    v_lshl_add_u32 v14, v12, 3, v14
    v_lshrrev_b32 v15, 1, v11
    v_and_b32 v15, 1, v15
    s_lshl_b32 s52, s16, 1
    v_add_u32 v15, s52, v15
    v_lshrrev_b32 v8, 3, v11
    v_and_b32 v9, 1, v12
    v_lshl_or_b32 v8, v9, 1, v8
    v_lshlrev_b32 v8, 1, v8
    v_xor_b32 v15, v15, v8
    v_lshlrev_b32 v15, 4, v15
    v_lshl_add_u32 v15, v14, 7, v15
    v_and_b32 v14, 1, v11
    v_lshl_add_u32 v8, v14, 3, v15
    v_add_u32 v9, 28672, v8
    s_mov_b32 s69, 73728
    s_mov_b32 s68, 4294952960
    v_and_b32 v11, 15, v1
    v_lshrrev_b32 v12, 4, v1
    v_add_u32 v13, 4, v11
    v_cmp_gt_u32 vcc, 4, v11
    s_nop 1
    v_cndmask_b32 v13, v13, v11, vcc
    v_subrev_u32 v14, 8, v11
    v_cmp_lt_u32 vcc, 11, v11
    s_nop 1
    v_cndmask_b32 v13, v13, v14, vcc
    v_subrev_u32 v14, 1, v13
    v_max_i32 v14, 0, v14
    v_subrev_u32 v15, 4, v14
    v_add_u32 v16, 8, v14
    v_cmp_gt_u32 vcc, 8, v14
    s_nop 1
    v_cndmask_b32 v15, v15, v16, vcc
    v_cmp_gt_u32 vcc, 4, v14
    s_nop 1
    v_cndmask_b32 v15, v15, v14, vcc
    v_lshl_add_u32 v15, v12, 4, v15
    v_lshlrev_b32 v112, 2, v15
    v_lshrrev_b32 v16, 1, v12
    s_lshl_b32 s52, s16, 1
    v_add_u32 v16, s52, v16
    v_and_b32 v17, 7, v13
    v_xor_b32 v16, v16, v17
    v_lshlrev_b32 v16, 4, v16
    v_and_b32 v17, 1, v12
    v_lshl_add_u32 v16, v17, 3, v16
    v_mul_u32_u24 v17, 2304, v13
    v_add_u32 v16, v16, v17
    v_add_u32 v16, 640, v16
    v_mov_b32 v17, 0x40000000
    v_mov_b32 v114, v16
    v_cmp_lt_u32 vcc, 0, v13
    s_nop 1
    v_cndmask_b32 v113, v17, v16, vcc
    s_waitcnt lgkmcnt(0)
    s_or_b32 s75, s64, 1
    s_mov_b32 s0, s14
    s_mov_b32 s1, s15
    s_mov_b32 s2, 25198592
    s_mov_b32 s3, 0x20000
    s_mov_b32 s24, s4
    s_mov_b32 s25, s5
    s_mov_b32 s26, 4096000
    s_mov_b32 s27, 0x20000
    s_mov_b32 s28, s6
    s_mov_b32 s29, s7
    s_mov_b32 s30, 8126464
    s_mov_b32 s31, 0x20000
    s_mov_b32 s32, s14
    s_mov_b32 s33, s15
    s_mov_b32 s34, 12779520
    s_mov_b32 s35, 0x20000
    s_mov_b32 s36, s14
    s_mov_b32 s37, s15
    s_mov_b32 s38, 1376256
    s_mov_b32 s39, 0x20000
    s_add_u32 s40, s14, 13631488
    s_addc_u32 s41, s15, 0
    s_mov_b32 s42, 8552448
    s_mov_b32 s43, 0x20000
    s_mov_b32 s44, s8
    s_mov_b32 s45, s9
    s_mov_b32 s46, 131072
    s_mov_b32 s47, 0x20000
    s_mov_b32 s48, s10
    s_mov_b32 s49, s11
    s_mov_b32 s50, 4096000
    s_mov_b32 s51, 0x20000
    s_barrier
    ds_read_b128 v[36:39], v2 offset:11520
    ds_read_b128 v[32:35], v2 offset:9216
    ds_read_b128 v[28:31], v2 offset:6912
    ds_read_b64_tr_b16 v[88:89], v9 offset:0
    ds_read_b64_tr_b16 v[90:91], v9 offset:512
    ds_read_b128 v[24:27], v2 offset:4608
    ds_read_b128 v[20:23], v2 offset:2304
    ds_read_b128 v[16:19], v2 offset:0
    ds_read_b64_tr_b16 v[92:93], v9 offset:4096
    ds_read_b64_tr_b16 v[94:95], v9 offset:4608
    ds_read_b128 v[48:51], v3 offset:11520
    ds_read_b128 v[44:47], v3 offset:9216
    s_mov_b32 s70, 0
L_sf0:
    s_waitcnt lgkmcnt(7)
    v_mfma_f32_16x16x32_bf16 v[148:151], v[88:91], v[36:39], v[148:151]
    ds_read_b64_tr_b16 v[96:97], v9 offset:8192
    v_mfma_f32_16x16x32_bf16 v[144:147], v[88:91], v[32:35], v[144:147]
    ds_read_b64_tr_b16 v[98:99], v9 offset:8704
    v_mfma_f32_16x16x32_bf16 v[140:143], v[88:91], v[28:31], v[140:143]
    ds_read_b128 v[40:43], v3 offset:6912
    s_waitcnt lgkmcnt(9)
    v_mfma_f32_16x16x32_bf16 v[136:139], v[88:91], v[24:27], v[136:139]
    s_waitcnt lgkmcnt(8)
    v_mfma_f32_16x16x32_bf16 v[132:135], v[88:91], v[20:23], v[132:135]
    s_waitcnt lgkmcnt(7)
    v_mfma_f32_16x16x32_bf16 v[128:131], v[88:91], v[16:19], v[128:131]
    s_waitcnt lgkmcnt(5)
    v_mfma_f32_16x16x32_bf16 v[148:151], v[92:95], v[32:35], v[148:151]
    ds_read_b64_tr_b16 v[88:89], v9 offset:12288
    v_mfma_f32_16x16x32_bf16 v[144:147], v[92:95], v[28:31], v[144:147]
    ds_read_b64_tr_b16 v[90:91], v9 offset:12800
    v_mfma_f32_16x16x32_bf16 v[140:143], v[92:95], v[24:27], v[140:143]
    ds_read_b128 v[36:39], v3 offset:4608
    v_mfma_f32_16x16x32_bf16 v[136:139], v[92:95], v[20:23], v[136:139]
    v_mfma_f32_16x16x32_bf16 v[132:135], v[92:95], v[16:19], v[132:135]
    s_waitcnt lgkmcnt(7)
    v_mfma_f32_16x16x32_bf16 v[128:131], v[92:95], v[48:51], v[128:131]
    s_waitcnt lgkmcnt(4)
    v_mfma_f32_16x16x32_bf16 v[148:151], v[96:99], v[28:31], v[148:151]
    ds_read_b64_tr_b16 v[92:93], v9 offset:16384
    v_mfma_f32_16x16x32_bf16 v[144:147], v[96:99], v[24:27], v[144:147]
    ds_read_b64_tr_b16 v[94:95], v9 offset:16896
    v_mfma_f32_16x16x32_bf16 v[140:143], v[96:99], v[20:23], v[140:143]
    ds_read_b128 v[32:35], v3 offset:2304
    v_mfma_f32_16x16x32_bf16 v[136:139], v[96:99], v[16:19], v[136:139]
    v_mfma_f32_16x16x32_bf16 v[132:135], v[96:99], v[48:51], v[132:135]
    v_mfma_f32_16x16x32_bf16 v[128:131], v[96:99], v[44:47], v[128:131]
    s_waitcnt lgkmcnt(4)
    v_mfma_f32_16x16x32_bf16 v[148:151], v[88:91], v[24:27], v[148:151]
    ds_read_b64_tr_b16 v[96:97], v9 offset:20480
    v_mfma_f32_16x16x32_bf16 v[144:147], v[88:91], v[20:23], v[144:147]
    ds_read_b64_tr_b16 v[98:99], v9 offset:20992
    v_mfma_f32_16x16x32_bf16 v[140:143], v[88:91], v[16:19], v[140:143]
    ds_read_b128 v[28:31], v3 offset:0
    v_mfma_f32_16x16x32_bf16 v[136:139], v[88:91], v[48:51], v[136:139]
    v_mfma_f32_16x16x32_bf16 v[132:135], v[88:91], v[44:47], v[132:135]
    v_mfma_f32_16x16x32_bf16 v[128:131], v[88:91], v[40:43], v[128:131]
    s_waitcnt lgkmcnt(4)
    v_mfma_f32_16x16x32_bf16 v[148:151], v[92:95], v[20:23], v[148:151]
    ds_read_b64_tr_b16 v[88:89], v9 offset:24576
    v_mfma_f32_16x16x32_bf16 v[144:147], v[92:95], v[16:19], v[144:147]
    ds_read_b64_tr_b16 v[90:91], v9 offset:25088
    v_mfma_f32_16x16x32_bf16 v[140:143], v[92:95], v[48:51], v[140:143]
    ds_read_b128 v[24:27], v4 offset:11520
    v_mfma_f32_16x16x32_bf16 v[136:139], v[92:95], v[44:47], v[136:139]
    v_mfma_f32_16x16x32_bf16 v[132:135], v[92:95], v[40:43], v[132:135]
    v_mfma_f32_16x16x32_bf16 v[128:131], v[92:95], v[36:39], v[128:131]
    s_waitcnt lgkmcnt(4)
    v_mfma_f32_16x16x32_bf16 v[148:151], v[96:99], v[16:19], v[148:151]
    ds_read_b64_tr_b16 v[92:93], v9 offset:28672
    v_mfma_f32_16x16x32_bf16 v[144:147], v[96:99], v[48:51], v[144:147]
    ds_read_b64_tr_b16 v[94:95], v9 offset:29184
    v_mfma_f32_16x16x32_bf16 v[140:143], v[96:99], v[44:47], v[140:143]
    ds_read_b128 v[20:23], v4 offset:9216
    v_mfma_f32_16x16x32_bf16 v[136:139], v[96:99], v[40:43], v[136:139]
    v_mfma_f32_16x16x32_bf16 v[132:135], v[96:99], v[36:39], v[132:135]
    v_mfma_f32_16x16x32_bf16 v[128:131], v[96:99], v[32:35], v[128:131]
    s_waitcnt lgkmcnt(4)
    v_mfma_f32_16x16x32_bf16 v[148:151], v[88:91], v[48:51], v[148:151]
    ds_read_b64_tr_b16 v[96:97], v9 offset:32768
    v_mfma_f32_16x16x32_bf16 v[144:147], v[88:91], v[44:47], v[144:147]
    ds_read_b64_tr_b16 v[98:99], v9 offset:33280
    v_mfma_f32_16x16x32_bf16 v[140:143], v[88:91], v[40:43], v[140:143]
    v_add_u32 v5, s68, v5
    ds_read_b128 v[16:19], v4 offset:6912
    v_mfma_f32_16x16x32_bf16 v[136:139], v[88:91], v[36:39], v[136:139]
    v_add_u32 v6, s68, v6
    v_mfma_f32_16x16x32_bf16 v[132:135], v[88:91], v[32:35], v[132:135]
    v_add_u32 v7, s68, v7
    v_mfma_f32_16x16x32_bf16 v[128:131], v[88:91], v[28:31], v[128:131]
    v_add_u32 v10, s69, v8
    s_add_u32 s69, s69, 45056
    s_cmp_eq_u32 s69, 163840
    s_cselect_b32 s69, 28672, s69
    s_waitcnt lgkmcnt(0)
    s_barrier
    v_mfma_f32_16x16x32_bf16 v[148:151], v[92:95], v[44:47], v[148:151]
    ds_read_b64_tr_b16 v[88:89], v9 offset:36864
    v_mfma_f32_16x16x32_bf16 v[144:147], v[92:95], v[40:43], v[144:147]
    ds_read_b64_tr_b16 v[90:91], v9 offset:37376
    v_mfma_f32_16x16x32_bf16 v[140:143], v[92:95], v[36:39], v[140:143]
    ds_read_b128 v[72:75], v5 offset:11520
    v_mfma_f32_16x16x32_bf16 v[136:139], v[92:95], v[32:35], v[136:139]
    ds_read_b128 v[68:71], v5 offset:9216
    v_mfma_f32_16x16x32_bf16 v[132:135], v[92:95], v[28:31], v[132:135]
    ds_read_b128 v[64:67], v5 offset:6912
    v_mfma_f32_16x16x32_bf16 v[128:131], v[92:95], v[24:27], v[128:131]
    v_mfma_f32_16x16x32_bf16 v[148:151], v[96:99], v[40:43], v[148:151]
    ds_read_b64_tr_b16 v[100:101], v10 offset:0
    v_mfma_f32_16x16x32_bf16 v[144:147], v[96:99], v[36:39], v[144:147]
    ds_read_b64_tr_b16 v[102:103], v10 offset:512
    v_mfma_f32_16x16x32_bf16 v[140:143], v[96:99], v[32:35], v[140:143]
    ds_read_b128 v[60:63], v5 offset:4608
    v_mfma_f32_16x16x32_bf16 v[136:139], v[96:99], v[28:31], v[136:139]
    ds_read_b128 v[56:59], v5 offset:2304
    v_mfma_f32_16x16x32_bf16 v[132:135], v[96:99], v[24:27], v[132:135]
    ds_read_b128 v[52:55], v5 offset:0
    v_mfma_f32_16x16x32_bf16 v[128:131], v[96:99], v[20:23], v[128:131]
    s_waitcnt lgkmcnt(8)
    v_mfma_f32_16x16x32_bf16 v[148:151], v[88:91], v[36:39], v[148:151]
    ds_read_b64_tr_b16 v[104:105], v10 offset:4096
    v_mfma_f32_16x16x32_bf16 v[144:147], v[88:91], v[32:35], v[144:147]
    ds_read_b64_tr_b16 v[106:107], v10 offset:4608
    v_mfma_f32_16x16x32_bf16 v[140:143], v[88:91], v[28:31], v[140:143]
    ds_read_b128 v[84:87], v6 offset:11520
    v_mfma_f32_16x16x32_bf16 v[136:139], v[88:91], v[24:27], v[136:139]
    ds_read_b128 v[80:83], v6 offset:9216
    v_mfma_f32_16x16x32_bf16 v[132:135], v[88:91], v[20:23], v[132:135]
    v_mfma_f32_16x16x32_bf16 v[128:131], v[88:91], v[16:19], v[128:131]
    s_waitcnt lgkmcnt(7)
    v_mfma_f32_16x16x32_bf16 v[148:151], v[100:103], v[72:75], v[148:151]
    ds_read_b64_tr_b16 v[108:109], v10 offset:8192
    v_mfma_f32_16x16x32_bf16 v[144:147], v[100:103], v[68:71], v[144:147]
    ds_read_b64_tr_b16 v[110:111], v10 offset:8704
    v_mfma_f32_16x16x32_bf16 v[140:143], v[100:103], v[64:67], v[140:143]
    ds_read_b128 v[76:79], v6 offset:6912
    s_waitcnt lgkmcnt(9)
    v_mfma_f32_16x16x32_bf16 v[136:139], v[100:103], v[60:63], v[136:139]
    s_waitcnt lgkmcnt(8)
    v_mfma_f32_16x16x32_bf16 v[132:135], v[100:103], v[56:59], v[132:135]
    s_waitcnt lgkmcnt(7)
    v_mfma_f32_16x16x32_bf16 v[128:131], v[100:103], v[52:55], v[128:131]
    s_waitcnt lgkmcnt(5)
    v_mfma_f32_16x16x32_bf16 v[148:151], v[104:107], v[68:71], v[148:151]
    ds_read_b64_tr_b16 v[100:101], v10 offset:12288
    v_mfma_f32_16x16x32_bf16 v[144:147], v[104:107], v[64:67], v[144:147]
    ds_read_b64_tr_b16 v[102:103], v10 offset:12800
    v_mfma_f32_16x16x32_bf16 v[140:143], v[104:107], v[60:63], v[140:143]
    ds_read_b128 v[72:75], v6 offset:4608
    v_mfma_f32_16x16x32_bf16 v[136:139], v[104:107], v[56:59], v[136:139]
    v_mfma_f32_16x16x32_bf16 v[132:135], v[104:107], v[52:55], v[132:135]
    s_waitcnt lgkmcnt(7)
    v_mfma_f32_16x16x32_bf16 v[128:131], v[104:107], v[84:87], v[128:131]
    s_waitcnt lgkmcnt(4)
    v_mfma_f32_16x16x32_bf16 v[148:151], v[108:111], v[64:67], v[148:151]
    ds_read_b64_tr_b16 v[104:105], v10 offset:16384
    v_mfma_f32_16x16x32_bf16 v[144:147], v[108:111], v[60:63], v[144:147]
    ds_read_b64_tr_b16 v[106:107], v10 offset:16896
    v_mfma_f32_16x16x32_bf16 v[140:143], v[108:111], v[56:59], v[140:143]
    ds_read_b128 v[68:71], v6 offset:2304
    v_mfma_f32_16x16x32_bf16 v[136:139], v[108:111], v[52:55], v[136:139]
    v_mfma_f32_16x16x32_bf16 v[132:135], v[108:111], v[84:87], v[132:135]
    v_mfma_f32_16x16x32_bf16 v[128:131], v[108:111], v[80:83], v[128:131]
    s_waitcnt lgkmcnt(4)
    v_mfma_f32_16x16x32_bf16 v[148:151], v[100:103], v[60:63], v[148:151]
    ds_read_b64_tr_b16 v[108:109], v10 offset:20480
    v_mfma_f32_16x16x32_bf16 v[144:147], v[100:103], v[56:59], v[144:147]
    ds_read_b64_tr_b16 v[110:111], v10 offset:20992
    v_mfma_f32_16x16x32_bf16 v[140:143], v[100:103], v[52:55], v[140:143]
    ds_read_b128 v[64:67], v6 offset:0
    v_mfma_f32_16x16x32_bf16 v[136:139], v[100:103], v[84:87], v[136:139]
    v_mfma_f32_16x16x32_bf16 v[132:135], v[100:103], v[80:83], v[132:135]
    v_mfma_f32_16x16x32_bf16 v[128:131], v[100:103], v[76:79], v[128:131]
    s_waitcnt lgkmcnt(4)
    v_mfma_f32_16x16x32_bf16 v[148:151], v[104:107], v[56:59], v[148:151]
    ds_read_b64_tr_b16 v[100:101], v10 offset:24576
    v_mfma_f32_16x16x32_bf16 v[144:147], v[104:107], v[52:55], v[144:147]
    ds_read_b64_tr_b16 v[102:103], v10 offset:25088
    v_mfma_f32_16x16x32_bf16 v[140:143], v[104:107], v[84:87], v[140:143]
    ds_read_b128 v[60:63], v7 offset:11520
    v_mfma_f32_16x16x32_bf16 v[136:139], v[104:107], v[80:83], v[136:139]
    v_mfma_f32_16x16x32_bf16 v[132:135], v[104:107], v[76:79], v[132:135]
    v_mfma_f32_16x16x32_bf16 v[128:131], v[104:107], v[72:75], v[128:131]
    s_waitcnt lgkmcnt(4)
    v_mfma_f32_16x16x32_bf16 v[148:151], v[108:111], v[52:55], v[148:151]
    ds_read_b64_tr_b16 v[104:105], v10 offset:28672
    v_mfma_f32_16x16x32_bf16 v[144:147], v[108:111], v[84:87], v[144:147]
    ds_read_b64_tr_b16 v[106:107], v10 offset:29184
    v_mfma_f32_16x16x32_bf16 v[140:143], v[108:111], v[80:83], v[140:143]
    ds_read_b128 v[56:59], v7 offset:9216
    v_mfma_f32_16x16x32_bf16 v[136:139], v[108:111], v[76:79], v[136:139]
    v_mfma_f32_16x16x32_bf16 v[132:135], v[108:111], v[72:75], v[132:135]
    v_mfma_f32_16x16x32_bf16 v[128:131], v[108:111], v[68:71], v[128:131]
    s_waitcnt lgkmcnt(4)
    v_mfma_f32_16x16x32_bf16 v[148:151], v[100:103], v[84:87], v[148:151]
    ds_read_b64_tr_b16 v[108:109], v10 offset:32768
    v_mfma_f32_16x16x32_bf16 v[144:147], v[100:103], v[80:83], v[144:147]
    ds_read_b64_tr_b16 v[110:111], v10 offset:33280
    v_mfma_f32_16x16x32_bf16 v[140:143], v[100:103], v[76:79], v[140:143]
    s_sub_u32 s68, 0, s68
    v_add_u32 v2, s68, v2
    ds_read_b128 v[52:55], v7 offset:6912
    v_mfma_f32_16x16x32_bf16 v[136:139], v[100:103], v[72:75], v[136:139]
    v_add_u32 v3, s68, v3
    v_mfma_f32_16x16x32_bf16 v[132:135], v[100:103], v[68:71], v[132:135]
    v_add_u32 v4, s68, v4
    v_mfma_f32_16x16x32_bf16 v[128:131], v[100:103], v[64:67], v[128:131]
    v_add_u32 v9, s69, v8
    s_add_u32 s69, s69, 45056
    s_cmp_eq_u32 s69, 163840
    s_cselect_b32 s69, 28672, s69
    s_waitcnt lgkmcnt(0)
    s_barrier
    v_mfma_f32_16x16x32_bf16 v[148:151], v[104:107], v[80:83], v[148:151]
    ds_read_b64_tr_b16 v[100:101], v10 offset:36864
    v_mfma_f32_16x16x32_bf16 v[144:147], v[104:107], v[76:79], v[144:147]
    ds_read_b64_tr_b16 v[102:103], v10 offset:37376
    v_mfma_f32_16x16x32_bf16 v[140:143], v[104:107], v[72:75], v[140:143]
    ds_read_b128 v[36:39], v2 offset:11520
    v_mfma_f32_16x16x32_bf16 v[136:139], v[104:107], v[68:71], v[136:139]
    ds_read_b128 v[32:35], v2 offset:9216
    v_mfma_f32_16x16x32_bf16 v[132:135], v[104:107], v[64:67], v[132:135]
    ds_read_b128 v[28:31], v2 offset:6912
    v_mfma_f32_16x16x32_bf16 v[128:131], v[104:107], v[60:63], v[128:131]
    v_mfma_f32_16x16x32_bf16 v[148:151], v[108:111], v[76:79], v[148:151]
    ds_read_b64_tr_b16 v[88:89], v9 offset:0
    v_mfma_f32_16x16x32_bf16 v[144:147], v[108:111], v[72:75], v[144:147]
    ds_read_b64_tr_b16 v[90:91], v9 offset:512
    v_mfma_f32_16x16x32_bf16 v[140:143], v[108:111], v[68:71], v[140:143]
    ds_read_b128 v[24:27], v2 offset:4608
    v_mfma_f32_16x16x32_bf16 v[136:139], v[108:111], v[64:67], v[136:139]
    ds_read_b128 v[20:23], v2 offset:2304
    v_mfma_f32_16x16x32_bf16 v[132:135], v[108:111], v[60:63], v[132:135]
    ds_read_b128 v[16:19], v2 offset:0
    v_mfma_f32_16x16x32_bf16 v[128:131], v[108:111], v[56:59], v[128:131]
    s_waitcnt lgkmcnt(8)
    v_mfma_f32_16x16x32_bf16 v[148:151], v[100:103], v[72:75], v[148:151]
    ds_read_b64_tr_b16 v[92:93], v9 offset:4096
    v_mfma_f32_16x16x32_bf16 v[144:147], v[100:103], v[68:71], v[144:147]
    ds_read_b64_tr_b16 v[94:95], v9 offset:4608
    v_mfma_f32_16x16x32_bf16 v[140:143], v[100:103], v[64:67], v[140:143]
    ds_read_b128 v[48:51], v3 offset:11520
    v_mfma_f32_16x16x32_bf16 v[136:139], v[100:103], v[60:63], v[136:139]
    ds_read_b128 v[44:47], v3 offset:9216
    v_mfma_f32_16x16x32_bf16 v[132:135], v[100:103], v[56:59], v[132:135]
    v_mfma_f32_16x16x32_bf16 v[128:131], v[100:103], v[52:55], v[128:131]
    s_add_u32 s70, s70, 1
    s_cmp_lt_u32 s70, 4
    s_cbranch_scc1 L_sf0
    s_mov_b32 s70, 0
L_sf1:
    s_waitcnt lgkmcnt(7)
    v_mfma_f32_16x16x32_bf16 v[172:175], v[88:91], v[36:39], v[172:175]
    ds_read_b64_tr_b16 v[96:97], v9 offset:8192
    v_mfma_f32_16x16x32_bf16 v[168:171], v[88:91], v[32:35], v[168:171]
    ds_read_b64_tr_b16 v[98:99], v9 offset:8704
    v_mfma_f32_16x16x32_bf16 v[164:167], v[88:91], v[28:31], v[164:167]
    ds_read_b128 v[40:43], v3 offset:6912
    s_waitcnt lgkmcnt(9)
    v_mfma_f32_16x16x32_bf16 v[160:163], v[88:91], v[24:27], v[160:163]
    s_waitcnt lgkmcnt(8)
    v_mfma_f32_16x16x32_bf16 v[156:159], v[88:91], v[20:23], v[156:159]
    s_waitcnt lgkmcnt(7)
    v_mfma_f32_16x16x32_bf16 v[152:155], v[88:91], v[16:19], v[152:155]
    s_waitcnt lgkmcnt(5)
    v_mfma_f32_16x16x32_bf16 v[172:175], v[92:95], v[32:35], v[172:175]
    ds_read_b64_tr_b16 v[88:89], v9 offset:12288
    v_mfma_f32_16x16x32_bf16 v[168:171], v[92:95], v[28:31], v[168:171]
    ds_read_b64_tr_b16 v[90:91], v9 offset:12800
    v_mfma_f32_16x16x32_bf16 v[164:167], v[92:95], v[24:27], v[164:167]
    ds_read_b128 v[36:39], v3 offset:4608
    v_mfma_f32_16x16x32_bf16 v[160:163], v[92:95], v[20:23], v[160:163]
    v_mfma_f32_16x16x32_bf16 v[156:159], v[92:95], v[16:19], v[156:159]
    s_waitcnt lgkmcnt(7)
    v_mfma_f32_16x16x32_bf16 v[152:155], v[92:95], v[48:51], v[152:155]
    s_waitcnt lgkmcnt(4)
    v_mfma_f32_16x16x32_bf16 v[172:175], v[96:99], v[28:31], v[172:175]
    ds_read_b64_tr_b16 v[92:93], v9 offset:16384
    v_mfma_f32_16x16x32_bf16 v[168:171], v[96:99], v[24:27], v[168:171]
    ds_read_b64_tr_b16 v[94:95], v9 offset:16896
    v_mfma_f32_16x16x32_bf16 v[164:167], v[96:99], v[20:23], v[164:167]
    ds_read_b128 v[32:35], v3 offset:2304
    v_mfma_f32_16x16x32_bf16 v[160:163], v[96:99], v[16:19], v[160:163]
    v_mfma_f32_16x16x32_bf16 v[156:159], v[96:99], v[48:51], v[156:159]
    v_mfma_f32_16x16x32_bf16 v[152:155], v[96:99], v[44:47], v[152:155]
    s_waitcnt lgkmcnt(4)
    v_mfma_f32_16x16x32_bf16 v[172:175], v[88:91], v[24:27], v[172:175]
    ds_read_b64_tr_b16 v[96:97], v9 offset:20480
    v_mfma_f32_16x16x32_bf16 v[168:171], v[88:91], v[20:23], v[168:171]
    ds_read_b64_tr_b16 v[98:99], v9 offset:20992
    v_mfma_f32_16x16x32_bf16 v[164:167], v[88:91], v[16:19], v[164:167]
    ds_read_b128 v[28:31], v3 offset:0
    v_mfma_f32_16x16x32_bf16 v[160:163], v[88:91], v[48:51], v[160:163]
    v_mfma_f32_16x16x32_bf16 v[156:159], v[88:91], v[44:47], v[156:159]
    v_mfma_f32_16x16x32_bf16 v[152:155], v[88:91], v[40:43], v[152:155]
    s_waitcnt lgkmcnt(4)
    v_mfma_f32_16x16x32_bf16 v[172:175], v[92:95], v[20:23], v[172:175]
    ds_read_b64_tr_b16 v[88:89], v9 offset:24576
    v_mfma_f32_16x16x32_bf16 v[168:171], v[92:95], v[16:19], v[168:171]
    ds_read_b64_tr_b16 v[90:91], v9 offset:25088
    v_mfma_f32_16x16x32_bf16 v[164:167], v[92:95], v[48:51], v[164:167]
    ds_read_b128 v[24:27], v4 offset:11520
    v_mfma_f32_16x16x32_bf16 v[160:163], v[92:95], v[44:47], v[160:163]
    v_mfma_f32_16x16x32_bf16 v[156:159], v[92:95], v[40:43], v[156:159]
    v_mfma_f32_16x16x32_bf16 v[152:155], v[92:95], v[36:39], v[152:155]
    s_waitcnt lgkmcnt(4)
    v_mfma_f32_16x16x32_bf16 v[172:175], v[96:99], v[16:19], v[172:175]
    ds_read_b64_tr_b16 v[92:93], v9 offset:28672
    v_mfma_f32_16x16x32_bf16 v[168:171], v[96:99], v[48:51], v[168:171]
    ds_read_b64_tr_b16 v[94:95], v9 offset:29184
    v_mfma_f32_16x16x32_bf16 v[164:167], v[96:99], v[44:47], v[164:167]
    ds_read_b128 v[20:23], v4 offset:9216
    v_mfma_f32_16x16x32_bf16 v[160:163], v[96:99], v[40:43], v[160:163]
    v_mfma_f32_16x16x32_bf16 v[156:159], v[96:99], v[36:39], v[156:159]
    v_mfma_f32_16x16x32_bf16 v[152:155], v[96:99], v[32:35], v[152:155]
    s_waitcnt lgkmcnt(4)
    v_mfma_f32_16x16x32_bf16 v[172:175], v[88:91], v[48:51], v[172:175]
    ds_read_b64_tr_b16 v[96:97], v9 offset:32768
    v_mfma_f32_16x16x32_bf16 v[168:171], v[88:91], v[44:47], v[168:171]
    ds_read_b64_tr_b16 v[98:99], v9 offset:33280
    v_mfma_f32_16x16x32_bf16 v[164:167], v[88:91], v[40:43], v[164:167]
    v_add_u32 v5, s68, v5
    ds_read_b128 v[16:19], v4 offset:6912
    v_mfma_f32_16x16x32_bf16 v[160:163], v[88:91], v[36:39], v[160:163]
    v_add_u32 v6, s68, v6
    v_mfma_f32_16x16x32_bf16 v[156:159], v[88:91], v[32:35], v[156:159]
    v_add_u32 v7, s68, v7
    v_mfma_f32_16x16x32_bf16 v[152:155], v[88:91], v[28:31], v[152:155]
    v_add_u32 v10, s69, v8
    s_add_u32 s69, s69, 45056
    s_cmp_eq_u32 s69, 163840
    s_cselect_b32 s69, 28672, s69
    s_waitcnt lgkmcnt(0)
    s_barrier
    v_mfma_f32_16x16x32_bf16 v[172:175], v[92:95], v[44:47], v[172:175]
    ds_read_b64_tr_b16 v[88:89], v9 offset:36864
    v_mfma_f32_16x16x32_bf16 v[168:171], v[92:95], v[40:43], v[168:171]
    ds_read_b64_tr_b16 v[90:91], v9 offset:37376
    v_mfma_f32_16x16x32_bf16 v[164:167], v[92:95], v[36:39], v[164:167]
    ds_read_b128 v[72:75], v5 offset:11520
    v_mfma_f32_16x16x32_bf16 v[160:163], v[92:95], v[32:35], v[160:163]
    ds_read_b128 v[68:71], v5 offset:9216
    v_mfma_f32_16x16x32_bf16 v[156:159], v[92:95], v[28:31], v[156:159]
    ds_read_b128 v[64:67], v5 offset:6912
    v_mfma_f32_16x16x32_bf16 v[152:155], v[92:95], v[24:27], v[152:155]
    v_mfma_f32_16x16x32_bf16 v[172:175], v[96:99], v[40:43], v[172:175]
    ds_read_b64_tr_b16 v[100:101], v10 offset:0
    v_mfma_f32_16x16x32_bf16 v[168:171], v[96:99], v[36:39], v[168:171]
    ds_read_b64_tr_b16 v[102:103], v10 offset:512
    v_mfma_f32_16x16x32_bf16 v[164:167], v[96:99], v[32:35], v[164:167]
    ds_read_b128 v[60:63], v5 offset:4608
    v_mfma_f32_16x16x32_bf16 v[160:163], v[96:99], v[28:31], v[160:163]
    ds_read_b128 v[56:59], v5 offset:2304
    v_mfma_f32_16x16x32_bf16 v[156:159], v[96:99], v[24:27], v[156:159]
    ds_read_b128 v[52:55], v5 offset:0
    v_mfma_f32_16x16x32_bf16 v[152:155], v[96:99], v[20:23], v[152:155]
    s_waitcnt lgkmcnt(8)
    v_mfma_f32_16x16x32_bf16 v[172:175], v[88:91], v[36:39], v[172:175]
    ds_read_b64_tr_b16 v[104:105], v10 offset:4096
    v_mfma_f32_16x16x32_bf16 v[168:171], v[88:91], v[32:35], v[168:171]
    ds_read_b64_tr_b16 v[106:107], v10 offset:4608
    v_mfma_f32_16x16x32_bf16 v[164:167], v[88:91], v[28:31], v[164:167]
    ds_read_b128 v[84:87], v6 offset:11520
    v_mfma_f32_16x16x32_bf16 v[160:163], v[88:91], v[24:27], v[160:163]
    ds_read_b128 v[80:83], v6 offset:9216
    v_mfma_f32_16x16x32_bf16 v[156:159], v[88:91], v[20:23], v[156:159]
    v_mfma_f32_16x16x32_bf16 v[152:155], v[88:91], v[16:19], v[152:155]
    s_waitcnt lgkmcnt(7)
    v_mfma_f32_16x16x32_bf16 v[172:175], v[100:103], v[72:75], v[172:175]
    ds_read_b64_tr_b16 v[108:109], v10 offset:8192
    v_mfma_f32_16x16x32_bf16 v[168:171], v[100:103], v[68:71], v[168:171]
    ds_read_b64_tr_b16 v[110:111], v10 offset:8704
    v_mfma_f32_16x16x32_bf16 v[164:167], v[100:103], v[64:67], v[164:167]
    ds_read_b128 v[76:79], v6 offset:6912
    s_waitcnt lgkmcnt(9)
    v_mfma_f32_16x16x32_bf16 v[160:163], v[100:103], v[60:63], v[160:163]
    s_waitcnt lgkmcnt(8)
    v_mfma_f32_16x16x32_bf16 v[156:159], v[100:103], v[56:59], v[156:159]
    s_waitcnt lgkmcnt(7)
    v_mfma_f32_16x16x32_bf16 v[152:155], v[100:103], v[52:55], v[152:155]
    s_waitcnt lgkmcnt(5)
    v_mfma_f32_16x16x32_bf16 v[172:175], v[104:107], v[68:71], v[172:175]
    ds_read_b64_tr_b16 v[100:101], v10 offset:12288
    v_mfma_f32_16x16x32_bf16 v[168:171], v[104:107], v[64:67], v[168:171]
    ds_read_b64_tr_b16 v[102:103], v10 offset:12800
    v_mfma_f32_16x16x32_bf16 v[164:167], v[104:107], v[60:63], v[164:167]
    ds_read_b128 v[72:75], v6 offset:4608
    v_mfma_f32_16x16x32_bf16 v[160:163], v[104:107], v[56:59], v[160:163]
    v_mfma_f32_16x16x32_bf16 v[156:159], v[104:107], v[52:55], v[156:159]
    s_waitcnt lgkmcnt(7)
    v_mfma_f32_16x16x32_bf16 v[152:155], v[104:107], v[84:87], v[152:155]
    s_waitcnt lgkmcnt(4)
    v_mfma_f32_16x16x32_bf16 v[172:175], v[108:111], v[64:67], v[172:175]
    ds_read_b64_tr_b16 v[104:105], v10 offset:16384
    v_mfma_f32_16x16x32_bf16 v[168:171], v[108:111], v[60:63], v[168:171]
    ds_read_b64_tr_b16 v[106:107], v10 offset:16896
    v_mfma_f32_16x16x32_bf16 v[164:167], v[108:111], v[56:59], v[164:167]
    ds_read_b128 v[68:71], v6 offset:2304
    v_mfma_f32_16x16x32_bf16 v[160:163], v[108:111], v[52:55], v[160:163]
    v_mfma_f32_16x16x32_bf16 v[156:159], v[108:111], v[84:87], v[156:159]
    v_mfma_f32_16x16x32_bf16 v[152:155], v[108:111], v[80:83], v[152:155]
    s_waitcnt lgkmcnt(4)
    v_mfma_f32_16x16x32_bf16 v[172:175], v[100:103], v[60:63], v[172:175]
    ds_read_b64_tr_b16 v[108:109], v10 offset:20480
    v_mfma_f32_16x16x32_bf16 v[168:171], v[100:103], v[56:59], v[168:171]
    ds_read_b64_tr_b16 v[110:111], v10 offset:20992
    v_mfma_f32_16x16x32_bf16 v[164:167], v[100:103], v[52:55], v[164:167]
    ds_read_b128 v[64:67], v6 offset:0
    v_mfma_f32_16x16x32_bf16 v[160:163], v[100:103], v[84:87], v[160:163]
    v_mfma_f32_16x16x32_bf16 v[156:159], v[100:103], v[80:83], v[156:159]
    v_mfma_f32_16x16x32_bf16 v[152:155], v[100:103], v[76:79], v[152:155]
    s_waitcnt lgkmcnt(4)
    v_mfma_f32_16x16x32_bf16 v[172:175], v[104:107], v[56:59], v[172:175]
    ds_read_b64_tr_b16 v[100:101], v10 offset:24576
    v_mfma_f32_16x16x32_bf16 v[168:171], v[104:107], v[52:55], v[168:171]
    ds_read_b64_tr_b16 v[102:103], v10 offset:25088
    v_mfma_f32_16x16x32_bf16 v[164:167], v[104:107], v[84:87], v[164:167]
    ds_read_b128 v[60:63], v7 offset:11520
    v_mfma_f32_16x16x32_bf16 v[160:163], v[104:107], v[80:83], v[160:163]
    v_mfma_f32_16x16x32_bf16 v[156:159], v[104:107], v[76:79], v[156:159]
    v_mfma_f32_16x16x32_bf16 v[152:155], v[104:107], v[72:75], v[152:155]
    s_waitcnt lgkmcnt(4)
    v_mfma_f32_16x16x32_bf16 v[172:175], v[108:111], v[52:55], v[172:175]
    ds_read_b64_tr_b16 v[104:105], v10 offset:28672
    v_mfma_f32_16x16x32_bf16 v[168:171], v[108:111], v[84:87], v[168:171]
    ds_read_b64_tr_b16 v[106:107], v10 offset:29184
    v_mfma_f32_16x16x32_bf16 v[164:167], v[108:111], v[80:83], v[164:167]
    ds_read_b128 v[56:59], v7 offset:9216
    v_mfma_f32_16x16x32_bf16 v[160:163], v[108:111], v[76:79], v[160:163]
    v_mfma_f32_16x16x32_bf16 v[156:159], v[108:111], v[72:75], v[156:159]
    v_mfma_f32_16x16x32_bf16 v[152:155], v[108:111], v[68:71], v[152:155]
    s_waitcnt lgkmcnt(4)
    v_mfma_f32_16x16x32_bf16 v[172:175], v[100:103], v[84:87], v[172:175]
    ds_read_b64_tr_b16 v[108:109], v10 offset:32768
    v_mfma_f32_16x16x32_bf16 v[168:171], v[100:103], v[80:83], v[168:171]
    ds_read_b64_tr_b16 v[110:111], v10 offset:33280
    v_mfma_f32_16x16x32_bf16 v[164:167], v[100:103], v[76:79], v[164:167]
    s_sub_u32 s68, 0, s68
    v_add_u32 v2, s68, v2
    ds_read_b128 v[52:55], v7 offset:6912
    v_mfma_f32_16x16x32_bf16 v[160:163], v[100:103], v[72:75], v[160:163]
    v_add_u32 v3, s68, v3
    v_mfma_f32_16x16x32_bf16 v[156:159], v[100:103], v[68:71], v[156:159]
    v_add_u32 v4, s68, v4
    v_mfma_f32_16x16x32_bf16 v[152:155], v[100:103], v[64:67], v[152:155]
    v_add_u32 v9, s69, v8
    s_add_u32 s69, s69, 45056
    s_cmp_eq_u32 s69, 163840
    s_cselect_b32 s69, 28672, s69
    s_waitcnt lgkmcnt(0)
    s_barrier
    v_mfma_f32_16x16x32_bf16 v[172:175], v[104:107], v[80:83], v[172:175]
    ds_read_b64_tr_b16 v[100:101], v10 offset:36864
    v_mfma_f32_16x16x32_bf16 v[168:171], v[104:107], v[76:79], v[168:171]
    ds_read_b64_tr_b16 v[102:103], v10 offset:37376
    v_mfma_f32_16x16x32_bf16 v[164:167], v[104:107], v[72:75], v[164:167]
    ds_read_b128 v[36:39], v2 offset:11520
    v_mfma_f32_16x16x32_bf16 v[160:163], v[104:107], v[68:71], v[160:163]
    ds_read_b128 v[32:35], v2 offset:9216
    v_mfma_f32_16x16x32_bf16 v[156:159], v[104:107], v[64:67], v[156:159]
    ds_read_b128 v[28:31], v2 offset:6912
    v_mfma_f32_16x16x32_bf16 v[152:155], v[104:107], v[60:63], v[152:155]
    v_mfma_f32_16x16x32_bf16 v[172:175], v[108:111], v[76:79], v[172:175]
    ds_read_b64_tr_b16 v[88:89], v9 offset:0
    v_mfma_f32_16x16x32_bf16 v[168:171], v[108:111], v[72:75], v[168:171]
    ds_read_b64_tr_b16 v[90:91], v9 offset:512
    v_mfma_f32_16x16x32_bf16 v[164:167], v[108:111], v[68:71], v[164:167]
    ds_read_b128 v[24:27], v2 offset:4608
    v_mfma_f32_16x16x32_bf16 v[160:163], v[108:111], v[64:67], v[160:163]
    ds_read_b128 v[20:23], v2 offset:2304
    v_mfma_f32_16x16x32_bf16 v[156:159], v[108:111], v[60:63], v[156:159]
    ds_read_b128 v[16:19], v2 offset:0
    v_mfma_f32_16x16x32_bf16 v[152:155], v[108:111], v[56:59], v[152:155]
    s_waitcnt lgkmcnt(8)
    v_mfma_f32_16x16x32_bf16 v[172:175], v[100:103], v[72:75], v[172:175]
    ds_read_b64_tr_b16 v[92:93], v9 offset:4096
    v_mfma_f32_16x16x32_bf16 v[168:171], v[100:103], v[68:71], v[168:171]
    ds_read_b64_tr_b16 v[94:95], v9 offset:4608
    v_mfma_f32_16x16x32_bf16 v[164:167], v[100:103], v[64:67], v[164:167]
    ds_read_b128 v[48:51], v3 offset:11520
    v_mfma_f32_16x16x32_bf16 v[160:163], v[100:103], v[60:63], v[160:163]
    ds_read_b128 v[44:47], v3 offset:9216
    v_mfma_f32_16x16x32_bf16 v[156:159], v[100:103], v[56:59], v[156:159]
    v_mfma_f32_16x16x32_bf16 v[152:155], v[100:103], v[52:55], v[152:155]
    s_add_u32 s70, s70, 1
    s_cmp_lt_u32 s70, 4
    s_cbranch_scc1 L_sf1
    s_mov_b32 s70, 0
L_sf2:
    s_waitcnt lgkmcnt(7)
    v_mfma_f32_16x16x32_bf16 v[196:199], v[88:91], v[36:39], v[196:199]
    ds_read_b64_tr_b16 v[96:97], v9 offset:8192
    v_mfma_f32_16x16x32_bf16 v[192:195], v[88:91], v[32:35], v[192:195]
    ds_read_b64_tr_b16 v[98:99], v9 offset:8704
    v_mfma_f32_16x16x32_bf16 v[188:191], v[88:91], v[28:31], v[188:191]
    ds_read_b128 v[40:43], v3 offset:6912
    s_waitcnt lgkmcnt(9)
    v_mfma_f32_16x16x32_bf16 v[184:187], v[88:91], v[24:27], v[184:187]
    s_waitcnt lgkmcnt(8)
    v_mfma_f32_16x16x32_bf16 v[180:183], v[88:91], v[20:23], v[180:183]
    s_waitcnt lgkmcnt(7)
    v_mfma_f32_16x16x32_bf16 v[176:179], v[88:91], v[16:19], v[176:179]
    s_waitcnt lgkmcnt(5)
    v_mfma_f32_16x16x32_bf16 v[196:199], v[92:95], v[32:35], v[196:199]
    ds_read_b64_tr_b16 v[88:89], v9 offset:12288
    v_mfma_f32_16x16x32_bf16 v[192:195], v[92:95], v[28:31], v[192:195]
    ds_read_b64_tr_b16 v[90:91], v9 offset:12800
    v_mfma_f32_16x16x32_bf16 v[188:191], v[92:95], v[24:27], v[188:191]
    ds_read_b128 v[36:39], v3 offset:4608
    v_mfma_f32_16x16x32_bf16 v[184:187], v[92:95], v[20:23], v[184:187]
    v_mfma_f32_16x16x32_bf16 v[180:183], v[92:95], v[16:19], v[180:183]
    s_waitcnt lgkmcnt(7)
    v_mfma_f32_16x16x32_bf16 v[176:179], v[92:95], v[48:51], v[176:179]
    s_waitcnt lgkmcnt(4)
    v_mfma_f32_16x16x32_bf16 v[196:199], v[96:99], v[28:31], v[196:199]
    ds_read_b64_tr_b16 v[92:93], v9 offset:16384
    v_mfma_f32_16x16x32_bf16 v[192:195], v[96:99], v[24:27], v[192:195]
    ds_read_b64_tr_b16 v[94:95], v9 offset:16896
    v_mfma_f32_16x16x32_bf16 v[188:191], v[96:99], v[20:23], v[188:191]
    ds_read_b128 v[32:35], v3 offset:2304
    v_mfma_f32_16x16x32_bf16 v[184:187], v[96:99], v[16:19], v[184:187]
    v_mfma_f32_16x16x32_bf16 v[180:183], v[96:99], v[48:51], v[180:183]
    v_mfma_f32_16x16x32_bf16 v[176:179], v[96:99], v[44:47], v[176:179]
    s_waitcnt lgkmcnt(4)
    v_mfma_f32_16x16x32_bf16 v[196:199], v[88:91], v[24:27], v[196:199]
    ds_read_b64_tr_b16 v[96:97], v9 offset:20480
    v_mfma_f32_16x16x32_bf16 v[192:195], v[88:91], v[20:23], v[192:195]
    ds_read_b64_tr_b16 v[98:99], v9 offset:20992
    v_mfma_f32_16x16x32_bf16 v[188:191], v[88:91], v[16:19], v[188:191]
    ds_read_b128 v[28:31], v3 offset:0
    v_mfma_f32_16x16x32_bf16 v[184:187], v[88:91], v[48:51], v[184:187]
    v_mfma_f32_16x16x32_bf16 v[180:183], v[88:91], v[44:47], v[180:183]
    v_mfma_f32_16x16x32_bf16 v[176:179], v[88:91], v[40:43], v[176:179]
    s_waitcnt lgkmcnt(4)
    v_mfma_f32_16x16x32_bf16 v[196:199], v[92:95], v[20:23], v[196:199]
    ds_read_b64_tr_b16 v[88:89], v9 offset:24576
    v_mfma_f32_16x16x32_bf16 v[192:195], v[92:95], v[16:19], v[192:195]
    ds_read_b64_tr_b16 v[90:91], v9 offset:25088
    v_mfma_f32_16x16x32_bf16 v[188:191], v[92:95], v[48:51], v[188:191]
    ds_read_b128 v[24:27], v4 offset:11520
    v_mfma_f32_16x16x32_bf16 v[184:187], v[92:95], v[44:47], v[184:187]
    v_mfma_f32_16x16x32_bf16 v[180:183], v[92:95], v[40:43], v[180:183]
    v_mfma_f32_16x16x32_bf16 v[176:179], v[92:95], v[36:39], v[176:179]
    s_waitcnt lgkmcnt(4)
    v_mfma_f32_16x16x32_bf16 v[196:199], v[96:99], v[16:19], v[196:199]
    ds_read_b64_tr_b16 v[92:93], v9 offset:28672
    v_mfma_f32_16x16x32_bf16 v[192:195], v[96:99], v[48:51], v[192:195]
    ds_read_b64_tr_b16 v[94:95], v9 offset:29184
    v_mfma_f32_16x16x32_bf16 v[188:191], v[96:99], v[44:47], v[188:191]
    ds_read_b128 v[20:23], v4 offset:9216
    v_mfma_f32_16x16x32_bf16 v[184:187], v[96:99], v[40:43], v[184:187]
    v_mfma_f32_16x16x32_bf16 v[180:183], v[96:99], v[36:39], v[180:183]
    v_mfma_f32_16x16x32_bf16 v[176:179], v[96:99], v[32:35], v[176:179]
    s_waitcnt lgkmcnt(4)
    v_mfma_f32_16x16x32_bf16 v[196:199], v[88:91], v[48:51], v[196:199]
    ds_read_b64_tr_b16 v[96:97], v9 offset:32768
    v_mfma_f32_16x16x32_bf16 v[192:195], v[88:91], v[44:47], v[192:195]
    ds_read_b64_tr_b16 v[98:99], v9 offset:33280
    v_mfma_f32_16x16x32_bf16 v[188:191], v[88:91], v[40:43], v[188:191]
    ds_read_b128 v[16:19], v4 offset:6912
    v_mfma_f32_16x16x32_bf16 v[184:187], v[88:91], v[36:39], v[184:187]
    v_mfma_f32_16x16x32_bf16 v[180:183], v[88:91], v[32:35], v[180:183]
    v_mfma_f32_16x16x32_bf16 v[176:179], v[88:91], v[28:31], v[176:179]
    s_waitcnt lgkmcnt(4)
    v_mfma_f32_16x16x32_bf16 v[196:199], v[92:95], v[44:47], v[196:199]
    ds_read_b64_tr_b16 v[88:89], v9 offset:36864
    v_mfma_f32_16x16x32_bf16 v[192:195], v[92:95], v[40:43], v[192:195]
    ds_read_b64_tr_b16 v[90:91], v9 offset:37376
    v_mfma_f32_16x16x32_bf16 v[188:191], v[92:95], v[36:39], v[188:191]
    v_add_u32 v5, s68, v5
    ds_read_b128 v[48:51], v4 offset:4608
    v_mfma_f32_16x16x32_bf16 v[184:187], v[92:95], v[32:35], v[184:187]
    v_add_u32 v6, s68, v6
    v_mfma_f32_16x16x32_bf16 v[180:183], v[92:95], v[28:31], v[180:183]
    v_add_u32 v7, s68, v7
    v_mfma_f32_16x16x32_bf16 v[176:179], v[92:95], v[24:27], v[176:179]
    v_add_u32 v10, s69, v8
    s_add_u32 s69, s69, 45056
    s_cmp_eq_u32 s69, 163840
    s_cselect_b32 s69, 28672, s69
    s_waitcnt lgkmcnt(0)
    s_barrier
    v_mfma_f32_16x16x32_bf16 v[196:199], v[96:99], v[40:43], v[196:199]
    ds_read_b64_tr_b16 v[92:93], v9 offset:40960
    v_mfma_f32_16x16x32_bf16 v[192:195], v[96:99], v[36:39], v[192:195]
    ds_read_b64_tr_b16 v[94:95], v9 offset:41472
    v_mfma_f32_16x16x32_bf16 v[188:191], v[96:99], v[32:35], v[188:191]
    ds_read_b128 v[72:75], v5 offset:11520
    v_mfma_f32_16x16x32_bf16 v[184:187], v[96:99], v[28:31], v[184:187]
    ds_read_b128 v[68:71], v5 offset:9216
    v_mfma_f32_16x16x32_bf16 v[180:183], v[96:99], v[24:27], v[180:183]
    ds_read_b128 v[64:67], v5 offset:6912
    v_mfma_f32_16x16x32_bf16 v[176:179], v[96:99], v[20:23], v[176:179]
    v_mfma_f32_16x16x32_bf16 v[196:199], v[88:91], v[36:39], v[196:199]
    ds_read_b64_tr_b16 v[100:101], v10 offset:0
    v_mfma_f32_16x16x32_bf16 v[192:195], v[88:91], v[32:35], v[192:195]
    ds_read_b64_tr_b16 v[102:103], v10 offset:512
    v_mfma_f32_16x16x32_bf16 v[188:191], v[88:91], v[28:31], v[188:191]
    ds_read_b128 v[60:63], v5 offset:4608
    v_mfma_f32_16x16x32_bf16 v[184:187], v[88:91], v[24:27], v[184:187]
    ds_read_b128 v[56:59], v5 offset:2304
    v_mfma_f32_16x16x32_bf16 v[180:183], v[88:91], v[20:23], v[180:183]
    ds_read_b128 v[52:55], v5 offset:0
    v_mfma_f32_16x16x32_bf16 v[176:179], v[88:91], v[16:19], v[176:179]
    s_waitcnt lgkmcnt(8)
    v_mfma_f32_16x16x32_bf16 v[196:199], v[92:95], v[32:35], v[196:199]
    ds_read_b64_tr_b16 v[104:105], v10 offset:4096
    v_mfma_f32_16x16x32_bf16 v[192:195], v[92:95], v[28:31], v[192:195]
    ds_read_b64_tr_b16 v[106:107], v10 offset:4608
    v_mfma_f32_16x16x32_bf16 v[188:191], v[92:95], v[24:27], v[188:191]
    ds_read_b128 v[84:87], v6 offset:11520
    v_mfma_f32_16x16x32_bf16 v[184:187], v[92:95], v[20:23], v[184:187]
    ds_read_b128 v[80:83], v6 offset:9216
    v_mfma_f32_16x16x32_bf16 v[180:183], v[92:95], v[16:19], v[180:183]
    v_mfma_f32_16x16x32_bf16 v[176:179], v[92:95], v[48:51], v[176:179]
    s_waitcnt lgkmcnt(7)
    v_mfma_f32_16x16x32_bf16 v[196:199], v[100:103], v[72:75], v[196:199]
    ds_read_b64_tr_b16 v[108:109], v10 offset:8192
    v_mfma_f32_16x16x32_bf16 v[192:195], v[100:103], v[68:71], v[192:195]
    ds_read_b64_tr_b16 v[110:111], v10 offset:8704
    v_mfma_f32_16x16x32_bf16 v[188:191], v[100:103], v[64:67], v[188:191]
    ds_read_b128 v[76:79], v6 offset:6912
    s_waitcnt lgkmcnt(9)
    v_mfma_f32_16x16x32_bf16 v[184:187], v[100:103], v[60:63], v[184:187]
    s_waitcnt lgkmcnt(8)
    v_mfma_f32_16x16x32_bf16 v[180:183], v[100:103], v[56:59], v[180:183]
    s_waitcnt lgkmcnt(7)
    v_mfma_f32_16x16x32_bf16 v[176:179], v[100:103], v[52:55], v[176:179]
    s_waitcnt lgkmcnt(5)
    v_mfma_f32_16x16x32_bf16 v[196:199], v[104:107], v[68:71], v[196:199]
    ds_read_b64_tr_b16 v[100:101], v10 offset:12288
    v_mfma_f32_16x16x32_bf16 v[192:195], v[104:107], v[64:67], v[192:195]
    ds_read_b64_tr_b16 v[102:103], v10 offset:12800
    v_mfma_f32_16x16x32_bf16 v[188:191], v[104:107], v[60:63], v[188:191]
    ds_read_b128 v[72:75], v6 offset:4608
    v_mfma_f32_16x16x32_bf16 v[184:187], v[104:107], v[56:59], v[184:187]
    v_mfma_f32_16x16x32_bf16 v[180:183], v[104:107], v[52:55], v[180:183]
    s_waitcnt lgkmcnt(7)
    v_mfma_f32_16x16x32_bf16 v[176:179], v[104:107], v[84:87], v[176:179]
    s_waitcnt lgkmcnt(4)
    v_mfma_f32_16x16x32_bf16 v[196:199], v[108:111], v[64:67], v[196:199]
    ds_read_b64_tr_b16 v[104:105], v10 offset:16384
    v_mfma_f32_16x16x32_bf16 v[192:195], v[108:111], v[60:63], v[192:195]
    ds_read_b64_tr_b16 v[106:107], v10 offset:16896
    v_mfma_f32_16x16x32_bf16 v[188:191], v[108:111], v[56:59], v[188:191]
    ds_read_b128 v[68:71], v6 offset:2304
    v_mfma_f32_16x16x32_bf16 v[184:187], v[108:111], v[52:55], v[184:187]
    v_mfma_f32_16x16x32_bf16 v[180:183], v[108:111], v[84:87], v[180:183]
    v_mfma_f32_16x16x32_bf16 v[176:179], v[108:111], v[80:83], v[176:179]
    s_waitcnt lgkmcnt(4)
    v_mfma_f32_16x16x32_bf16 v[196:199], v[100:103], v[60:63], v[196:199]
    ds_read_b64_tr_b16 v[108:109], v10 offset:20480
    v_mfma_f32_16x16x32_bf16 v[192:195], v[100:103], v[56:59], v[192:195]
    ds_read_b64_tr_b16 v[110:111], v10 offset:20992
    v_mfma_f32_16x16x32_bf16 v[188:191], v[100:103], v[52:55], v[188:191]
    ds_read_b128 v[64:67], v6 offset:0
    v_mfma_f32_16x16x32_bf16 v[184:187], v[100:103], v[84:87], v[184:187]
    v_mfma_f32_16x16x32_bf16 v[180:183], v[100:103], v[80:83], v[180:183]
    v_mfma_f32_16x16x32_bf16 v[176:179], v[100:103], v[76:79], v[176:179]
    s_waitcnt lgkmcnt(4)
    v_mfma_f32_16x16x32_bf16 v[196:199], v[104:107], v[56:59], v[196:199]
    ds_read_b64_tr_b16 v[100:101], v10 offset:24576
    v_mfma_f32_16x16x32_bf16 v[192:195], v[104:107], v[52:55], v[192:195]
    ds_read_b64_tr_b16 v[102:103], v10 offset:25088
    v_mfma_f32_16x16x32_bf16 v[188:191], v[104:107], v[84:87], v[188:191]
    ds_read_b128 v[60:63], v7 offset:11520
    v_mfma_f32_16x16x32_bf16 v[184:187], v[104:107], v[80:83], v[184:187]
    v_mfma_f32_16x16x32_bf16 v[180:183], v[104:107], v[76:79], v[180:183]
    v_mfma_f32_16x16x32_bf16 v[176:179], v[104:107], v[72:75], v[176:179]
    s_waitcnt lgkmcnt(4)
    v_mfma_f32_16x16x32_bf16 v[196:199], v[108:111], v[52:55], v[196:199]
    ds_read_b64_tr_b16 v[104:105], v10 offset:28672
    v_mfma_f32_16x16x32_bf16 v[192:195], v[108:111], v[84:87], v[192:195]
    ds_read_b64_tr_b16 v[106:107], v10 offset:29184
    v_mfma_f32_16x16x32_bf16 v[188:191], v[108:111], v[80:83], v[188:191]
    ds_read_b128 v[56:59], v7 offset:9216
    v_mfma_f32_16x16x32_bf16 v[184:187], v[108:111], v[76:79], v[184:187]
    v_mfma_f32_16x16x32_bf16 v[180:183], v[108:111], v[72:75], v[180:183]
    v_mfma_f32_16x16x32_bf16 v[176:179], v[108:111], v[68:71], v[176:179]
    s_waitcnt lgkmcnt(4)
    v_mfma_f32_16x16x32_bf16 v[196:199], v[100:103], v[84:87], v[196:199]
    ds_read_b64_tr_b16 v[108:109], v10 offset:32768
    v_mfma_f32_16x16x32_bf16 v[192:195], v[100:103], v[80:83], v[192:195]
    ds_read_b64_tr_b16 v[110:111], v10 offset:33280
    v_mfma_f32_16x16x32_bf16 v[188:191], v[100:103], v[76:79], v[188:191]
    ds_read_b128 v[52:55], v7 offset:6912
    v_mfma_f32_16x16x32_bf16 v[184:187], v[100:103], v[72:75], v[184:187]
    v_mfma_f32_16x16x32_bf16 v[180:183], v[100:103], v[68:71], v[180:183]
    v_mfma_f32_16x16x32_bf16 v[176:179], v[100:103], v[64:67], v[176:179]
    s_waitcnt lgkmcnt(4)
    v_mfma_f32_16x16x32_bf16 v[196:199], v[104:107], v[80:83], v[196:199]
    ds_read_b64_tr_b16 v[100:101], v10 offset:36864
    v_mfma_f32_16x16x32_bf16 v[192:195], v[104:107], v[76:79], v[192:195]
    ds_read_b64_tr_b16 v[102:103], v10 offset:37376
    v_mfma_f32_16x16x32_bf16 v[188:191], v[104:107], v[72:75], v[188:191]
    s_sub_u32 s68, 0, s68
    v_add_u32 v2, s68, v2
    ds_read_b128 v[84:87], v7 offset:4608
    v_mfma_f32_16x16x32_bf16 v[184:187], v[104:107], v[68:71], v[184:187]
    v_add_u32 v3, s68, v3
    v_mfma_f32_16x16x32_bf16 v[180:183], v[104:107], v[64:67], v[180:183]
    v_add_u32 v4, s68, v4
    v_mfma_f32_16x16x32_bf16 v[176:179], v[104:107], v[60:63], v[176:179]
    v_add_u32 v9, s69, v8
    s_add_u32 s69, s69, 45056
    s_cmp_eq_u32 s69, 163840
    s_cselect_b32 s69, 28672, s69
    s_waitcnt lgkmcnt(0)
    s_barrier
    v_mfma_f32_16x16x32_bf16 v[196:199], v[108:111], v[76:79], v[196:199]
    ds_read_b64_tr_b16 v[104:105], v10 offset:40960
    v_mfma_f32_16x16x32_bf16 v[192:195], v[108:111], v[72:75], v[192:195]
    ds_read_b64_tr_b16 v[106:107], v10 offset:41472
    v_mfma_f32_16x16x32_bf16 v[188:191], v[108:111], v[68:71], v[188:191]
    ds_read_b128 v[36:39], v2 offset:11520
    v_mfma_f32_16x16x32_bf16 v[184:187], v[108:111], v[64:67], v[184:187]
    ds_read_b128 v[32:35], v2 offset:9216
    v_mfma_f32_16x16x32_bf16 v[180:183], v[108:111], v[60:63], v[180:183]
    ds_read_b128 v[28:31], v2 offset:6912
    v_mfma_f32_16x16x32_bf16 v[176:179], v[108:111], v[56:59], v[176:179]
    v_mfma_f32_16x16x32_bf16 v[196:199], v[100:103], v[72:75], v[196:199]
    ds_read_b64_tr_b16 v[88:89], v9 offset:0
    v_mfma_f32_16x16x32_bf16 v[192:195], v[100:103], v[68:71], v[192:195]
    ds_read_b64_tr_b16 v[90:91], v9 offset:512
    v_mfma_f32_16x16x32_bf16 v[188:191], v[100:103], v[64:67], v[188:191]
    ds_read_b128 v[24:27], v2 offset:4608
    v_mfma_f32_16x16x32_bf16 v[184:187], v[100:103], v[60:63], v[184:187]
    ds_read_b128 v[20:23], v2 offset:2304
    v_mfma_f32_16x16x32_bf16 v[180:183], v[100:103], v[56:59], v[180:183]
    ds_read_b128 v[16:19], v2 offset:0
    v_mfma_f32_16x16x32_bf16 v[176:179], v[100:103], v[52:55], v[176:179]
    s_waitcnt lgkmcnt(8)
    v_mfma_f32_16x16x32_bf16 v[196:199], v[104:107], v[68:71], v[196:199]
    ds_read_b64_tr_b16 v[92:93], v9 offset:4096
    v_mfma_f32_16x16x32_bf16 v[192:195], v[104:107], v[64:67], v[192:195]
    ds_read_b64_tr_b16 v[94:95], v9 offset:4608
    v_mfma_f32_16x16x32_bf16 v[188:191], v[104:107], v[60:63], v[188:191]
    ds_read_b128 v[48:51], v3 offset:11520
    v_mfma_f32_16x16x32_bf16 v[184:187], v[104:107], v[56:59], v[184:187]
    ds_read_b128 v[44:47], v3 offset:9216
    v_mfma_f32_16x16x32_bf16 v[180:183], v[104:107], v[52:55], v[180:183]
    v_mfma_f32_16x16x32_bf16 v[176:179], v[104:107], v[84:87], v[176:179]
    s_add_u32 s70, s70, 1
    s_cmp_lt_u32 s70, 4
    s_cbranch_scc1 L_sf2
    s_mov_b32 s70, 0
L_sf3:
    s_waitcnt lgkmcnt(7)
    v_mfma_f32_16x16x32_bf16 v[220:223], v[88:91], v[36:39], v[220:223]
    ds_read_b64_tr_b16 v[96:97], v9 offset:8192
    v_mfma_f32_16x16x32_bf16 v[216:219], v[88:91], v[32:35], v[216:219]
    ds_read_b64_tr_b16 v[98:99], v9 offset:8704
    v_mfma_f32_16x16x32_bf16 v[212:215], v[88:91], v[28:31], v[212:215]
    ds_read_b128 v[40:43], v3 offset:6912
    s_waitcnt lgkmcnt(9)
    v_mfma_f32_16x16x32_bf16 v[208:211], v[88:91], v[24:27], v[208:211]
    s_waitcnt lgkmcnt(8)
    v_mfma_f32_16x16x32_bf16 v[204:207], v[88:91], v[20:23], v[204:207]
    s_waitcnt lgkmcnt(7)
    v_mfma_f32_16x16x32_bf16 v[200:203], v[88:91], v[16:19], v[200:203]
    s_waitcnt lgkmcnt(5)
    v_mfma_f32_16x16x32_bf16 v[220:223], v[92:95], v[32:35], v[220:223]
    ds_read_b64_tr_b16 v[88:89], v9 offset:12288
    v_mfma_f32_16x16x32_bf16 v[216:219], v[92:95], v[28:31], v[216:219]
    ds_read_b64_tr_b16 v[90:91], v9 offset:12800
    v_mfma_f32_16x16x32_bf16 v[212:215], v[92:95], v[24:27], v[212:215]
    ds_read_b128 v[36:39], v3 offset:4608
    v_mfma_f32_16x16x32_bf16 v[208:211], v[92:95], v[20:23], v[208:211]
    v_mfma_f32_16x16x32_bf16 v[204:207], v[92:95], v[16:19], v[204:207]
    s_waitcnt lgkmcnt(7)
    v_mfma_f32_16x16x32_bf16 v[200:203], v[92:95], v[48:51], v[200:203]
    s_waitcnt lgkmcnt(4)
    v_mfma_f32_16x16x32_bf16 v[220:223], v[96:99], v[28:31], v[220:223]
    ds_read_b64_tr_b16 v[92:93], v9 offset:16384
    v_mfma_f32_16x16x32_bf16 v[216:219], v[96:99], v[24:27], v[216:219]
    ds_read_b64_tr_b16 v[94:95], v9 offset:16896
    v_mfma_f32_16x16x32_bf16 v[212:215], v[96:99], v[20:23], v[212:215]
    ds_read_b128 v[32:35], v3 offset:2304
    v_mfma_f32_16x16x32_bf16 v[208:211], v[96:99], v[16:19], v[208:211]
    v_mfma_f32_16x16x32_bf16 v[204:207], v[96:99], v[48:51], v[204:207]
    v_mfma_f32_16x16x32_bf16 v[200:203], v[96:99], v[44:47], v[200:203]
    s_waitcnt lgkmcnt(4)
    v_mfma_f32_16x16x32_bf16 v[220:223], v[88:91], v[24:27], v[220:223]
    ds_read_b64_tr_b16 v[96:97], v9 offset:20480
    v_mfma_f32_16x16x32_bf16 v[216:219], v[88:91], v[20:23], v[216:219]
    ds_read_b64_tr_b16 v[98:99], v9 offset:20992
    v_mfma_f32_16x16x32_bf16 v[212:215], v[88:91], v[16:19], v[212:215]
    ds_read_b128 v[28:31], v3 offset:0
    v_mfma_f32_16x16x32_bf16 v[208:211], v[88:91], v[48:51], v[208:211]
    v_mfma_f32_16x16x32_bf16 v[204:207], v[88:91], v[44:47], v[204:207]
    v_mfma_f32_16x16x32_bf16 v[200:203], v[88:91], v[40:43], v[200:203]
    s_waitcnt lgkmcnt(4)
    v_mfma_f32_16x16x32_bf16 v[220:223], v[92:95], v[20:23], v[220:223]
    ds_read_b64_tr_b16 v[88:89], v9 offset:24576
    v_mfma_f32_16x16x32_bf16 v[216:219], v[92:95], v[16:19], v[216:219]
    ds_read_b64_tr_b16 v[90:91], v9 offset:25088
    v_mfma_f32_16x16x32_bf16 v[212:215], v[92:95], v[48:51], v[212:215]
    ds_read_b128 v[24:27], v4 offset:11520
    v_mfma_f32_16x16x32_bf16 v[208:211], v[92:95], v[44:47], v[208:211]
    v_mfma_f32_16x16x32_bf16 v[204:207], v[92:95], v[40:43], v[204:207]
    v_mfma_f32_16x16x32_bf16 v[200:203], v[92:95], v[36:39], v[200:203]
    s_waitcnt lgkmcnt(4)
    v_mfma_f32_16x16x32_bf16 v[220:223], v[96:99], v[16:19], v[220:223]
    ds_read_b64_tr_b16 v[92:93], v9 offset:28672
    v_mfma_f32_16x16x32_bf16 v[216:219], v[96:99], v[48:51], v[216:219]
    ds_read_b64_tr_b16 v[94:95], v9 offset:29184
    v_mfma_f32_16x16x32_bf16 v[212:215], v[96:99], v[44:47], v[212:215]
    ds_read_b128 v[20:23], v4 offset:9216
    v_mfma_f32_16x16x32_bf16 v[208:211], v[96:99], v[40:43], v[208:211]
    v_mfma_f32_16x16x32_bf16 v[204:207], v[96:99], v[36:39], v[204:207]
    v_mfma_f32_16x16x32_bf16 v[200:203], v[96:99], v[32:35], v[200:203]
    s_waitcnt lgkmcnt(4)
    v_mfma_f32_16x16x32_bf16 v[220:223], v[88:91], v[48:51], v[220:223]
    ds_read_b64_tr_b16 v[96:97], v9 offset:32768
    v_mfma_f32_16x16x32_bf16 v[216:219], v[88:91], v[44:47], v[216:219]
    ds_read_b64_tr_b16 v[98:99], v9 offset:33280
    v_mfma_f32_16x16x32_bf16 v[212:215], v[88:91], v[40:43], v[212:215]
    ds_read_b128 v[16:19], v4 offset:6912
    v_mfma_f32_16x16x32_bf16 v[208:211], v[88:91], v[36:39], v[208:211]
    v_mfma_f32_16x16x32_bf16 v[204:207], v[88:91], v[32:35], v[204:207]
    v_mfma_f32_16x16x32_bf16 v[200:203], v[88:91], v[28:31], v[200:203]
    s_waitcnt lgkmcnt(4)
    v_mfma_f32_16x16x32_bf16 v[220:223], v[92:95], v[44:47], v[220:223]
    ds_read_b64_tr_b16 v[88:89], v9 offset:36864
    v_mfma_f32_16x16x32_bf16 v[216:219], v[92:95], v[40:43], v[216:219]
    ds_read_b64_tr_b16 v[90:91], v9 offset:37376
    v_mfma_f32_16x16x32_bf16 v[212:215], v[92:95], v[36:39], v[212:215]
    v_add_u32 v5, s68, v5
    ds_read_b128 v[48:51], v4 offset:4608
    v_mfma_f32_16x16x32_bf16 v[208:211], v[92:95], v[32:35], v[208:211]
    v_add_u32 v6, s68, v6
    v_mfma_f32_16x16x32_bf16 v[204:207], v[92:95], v[28:31], v[204:207]
    v_add_u32 v7, s68, v7
    v_mfma_f32_16x16x32_bf16 v[200:203], v[92:95], v[24:27], v[200:203]
    v_add_u32 v10, s69, v8
    s_add_u32 s69, s69, 45056
    s_cmp_eq_u32 s69, 163840
    s_cselect_b32 s69, 28672, s69
    s_waitcnt lgkmcnt(0)
    s_barrier
    v_mfma_f32_16x16x32_bf16 v[220:223], v[96:99], v[40:43], v[220:223]
    ds_read_b64_tr_b16 v[92:93], v9 offset:40960
    v_mfma_f32_16x16x32_bf16 v[216:219], v[96:99], v[36:39], v[216:219]
    ds_read_b64_tr_b16 v[94:95], v9 offset:41472
    v_mfma_f32_16x16x32_bf16 v[212:215], v[96:99], v[32:35], v[212:215]
    ds_read_b128 v[72:75], v5 offset:11520
    v_mfma_f32_16x16x32_bf16 v[208:211], v[96:99], v[28:31], v[208:211]
    ds_read_b128 v[68:71], v5 offset:9216
    v_mfma_f32_16x16x32_bf16 v[204:207], v[96:99], v[24:27], v[204:207]
    ds_read_b128 v[64:67], v5 offset:6912
    v_mfma_f32_16x16x32_bf16 v[200:203], v[96:99], v[20:23], v[200:203]
    v_mfma_f32_16x16x32_bf16 v[220:223], v[88:91], v[36:39], v[220:223]
    ds_read_b64_tr_b16 v[100:101], v10 offset:0
    v_mfma_f32_16x16x32_bf16 v[216:219], v[88:91], v[32:35], v[216:219]
    ds_read_b64_tr_b16 v[102:103], v10 offset:512
    v_mfma_f32_16x16x32_bf16 v[212:215], v[88:91], v[28:31], v[212:215]
    ds_read_b128 v[60:63], v5 offset:4608
    v_mfma_f32_16x16x32_bf16 v[208:211], v[88:91], v[24:27], v[208:211]
    ds_read_b128 v[56:59], v5 offset:2304
    v_mfma_f32_16x16x32_bf16 v[204:207], v[88:91], v[20:23], v[204:207]
    ds_read_b128 v[52:55], v5 offset:0
    v_mfma_f32_16x16x32_bf16 v[200:203], v[88:91], v[16:19], v[200:203]
    s_waitcnt lgkmcnt(8)
    v_mfma_f32_16x16x32_bf16 v[220:223], v[92:95], v[32:35], v[220:223]
    ds_read_b64_tr_b16 v[104:105], v10 offset:4096
    v_mfma_f32_16x16x32_bf16 v[216:219], v[92:95], v[28:31], v[216:219]
    ds_read_b64_tr_b16 v[106:107], v10 offset:4608
    v_mfma_f32_16x16x32_bf16 v[212:215], v[92:95], v[24:27], v[212:215]
    ds_read_b128 v[84:87], v6 offset:11520
    v_mfma_f32_16x16x32_bf16 v[208:211], v[92:95], v[20:23], v[208:211]
    ds_read_b128 v[80:83], v6 offset:9216
    v_mfma_f32_16x16x32_bf16 v[204:207], v[92:95], v[16:19], v[204:207]
    v_mfma_f32_16x16x32_bf16 v[200:203], v[92:95], v[48:51], v[200:203]
    s_waitcnt lgkmcnt(7)
    v_mfma_f32_16x16x32_bf16 v[220:223], v[100:103], v[72:75], v[220:223]
    ds_read_b64_tr_b16 v[108:109], v10 offset:8192
    v_mfma_f32_16x16x32_bf16 v[216:219], v[100:103], v[68:71], v[216:219]
    ds_read_b64_tr_b16 v[110:111], v10 offset:8704
    v_mfma_f32_16x16x32_bf16 v[212:215], v[100:103], v[64:67], v[212:215]
    ds_read_b128 v[76:79], v6 offset:6912
    s_waitcnt lgkmcnt(9)
    v_mfma_f32_16x16x32_bf16 v[208:211], v[100:103], v[60:63], v[208:211]
    s_waitcnt lgkmcnt(8)
    v_mfma_f32_16x16x32_bf16 v[204:207], v[100:103], v[56:59], v[204:207]
    s_waitcnt lgkmcnt(7)
    v_mfma_f32_16x16x32_bf16 v[200:203], v[100:103], v[52:55], v[200:203]
    s_waitcnt lgkmcnt(5)
    v_mfma_f32_16x16x32_bf16 v[220:223], v[104:107], v[68:71], v[220:223]
    ds_read_b64_tr_b16 v[100:101], v10 offset:12288
    v_mfma_f32_16x16x32_bf16 v[216:219], v[104:107], v[64:67], v[216:219]
    ds_read_b64_tr_b16 v[102:103], v10 offset:12800
    v_mfma_f32_16x16x32_bf16 v[212:215], v[104:107], v[60:63], v[212:215]
    ds_read_b128 v[72:75], v6 offset:4608
    v_mfma_f32_16x16x32_bf16 v[208:211], v[104:107], v[56:59], v[208:211]
    v_mfma_f32_16x16x32_bf16 v[204:207], v[104:107], v[52:55], v[204:207]
    s_waitcnt lgkmcnt(7)
    v_mfma_f32_16x16x32_bf16 v[200:203], v[104:107], v[84:87], v[200:203]
    s_waitcnt lgkmcnt(4)
    v_mfma_f32_16x16x32_bf16 v[220:223], v[108:111], v[64:67], v[220:223]
    ds_read_b64_tr_b16 v[104:105], v10 offset:16384
    v_mfma_f32_16x16x32_bf16 v[216:219], v[108:111], v[60:63], v[216:219]
    ds_read_b64_tr_b16 v[106:107], v10 offset:16896
    v_mfma_f32_16x16x32_bf16 v[212:215], v[108:111], v[56:59], v[212:215]
    ds_read_b128 v[68:71], v6 offset:2304
    v_mfma_f32_16x16x32_bf16 v[208:211], v[108:111], v[52:55], v[208:211]
    v_mfma_f32_16x16x32_bf16 v[204:207], v[108:111], v[84:87], v[204:207]
    v_mfma_f32_16x16x32_bf16 v[200:203], v[108:111], v[80:83], v[200:203]
    s_waitcnt lgkmcnt(4)
    v_mfma_f32_16x16x32_bf16 v[220:223], v[100:103], v[60:63], v[220:223]
    ds_read_b64_tr_b16 v[108:109], v10 offset:20480
    v_mfma_f32_16x16x32_bf16 v[216:219], v[100:103], v[56:59], v[216:219]
    ds_read_b64_tr_b16 v[110:111], v10 offset:20992
    v_mfma_f32_16x16x32_bf16 v[212:215], v[100:103], v[52:55], v[212:215]
    ds_read_b128 v[64:67], v6 offset:0
    v_mfma_f32_16x16x32_bf16 v[208:211], v[100:103], v[84:87], v[208:211]
    v_mfma_f32_16x16x32_bf16 v[204:207], v[100:103], v[80:83], v[204:207]
    v_mfma_f32_16x16x32_bf16 v[200:203], v[100:103], v[76:79], v[200:203]
    s_waitcnt lgkmcnt(4)
    v_mfma_f32_16x16x32_bf16 v[220:223], v[104:107], v[56:59], v[220:223]
    ds_read_b64_tr_b16 v[100:101], v10 offset:24576
    v_mfma_f32_16x16x32_bf16 v[216:219], v[104:107], v[52:55], v[216:219]
    ds_read_b64_tr_b16 v[102:103], v10 offset:25088
    v_mfma_f32_16x16x32_bf16 v[212:215], v[104:107], v[84:87], v[212:215]
    ds_read_b128 v[60:63], v7 offset:11520
    v_mfma_f32_16x16x32_bf16 v[208:211], v[104:107], v[80:83], v[208:211]
    v_mfma_f32_16x16x32_bf16 v[204:207], v[104:107], v[76:79], v[204:207]
    v_mfma_f32_16x16x32_bf16 v[200:203], v[104:107], v[72:75], v[200:203]
    s_waitcnt lgkmcnt(4)
    v_mfma_f32_16x16x32_bf16 v[220:223], v[108:111], v[52:55], v[220:223]
    ds_read_b64_tr_b16 v[104:105], v10 offset:28672
    v_mfma_f32_16x16x32_bf16 v[216:219], v[108:111], v[84:87], v[216:219]
    ds_read_b64_tr_b16 v[106:107], v10 offset:29184
    v_mfma_f32_16x16x32_bf16 v[212:215], v[108:111], v[80:83], v[212:215]
    ds_read_b128 v[56:59], v7 offset:9216
    v_mfma_f32_16x16x32_bf16 v[208:211], v[108:111], v[76:79], v[208:211]
    v_mfma_f32_16x16x32_bf16 v[204:207], v[108:111], v[72:75], v[204:207]
    v_mfma_f32_16x16x32_bf16 v[200:203], v[108:111], v[68:71], v[200:203]
    s_waitcnt lgkmcnt(4)
    v_mfma_f32_16x16x32_bf16 v[220:223], v[100:103], v[84:87], v[220:223]
    ds_read_b64_tr_b16 v[108:109], v10 offset:32768
    v_mfma_f32_16x16x32_bf16 v[216:219], v[100:103], v[80:83], v[216:219]
    ds_read_b64_tr_b16 v[110:111], v10 offset:33280
    v_mfma_f32_16x16x32_bf16 v[212:215], v[100:103], v[76:79], v[212:215]
    ds_read_b128 v[52:55], v7 offset:6912
    v_mfma_f32_16x16x32_bf16 v[208:211], v[100:103], v[72:75], v[208:211]
    v_mfma_f32_16x16x32_bf16 v[204:207], v[100:103], v[68:71], v[204:207]
    v_mfma_f32_16x16x32_bf16 v[200:203], v[100:103], v[64:67], v[200:203]
    s_waitcnt lgkmcnt(4)
    v_mfma_f32_16x16x32_bf16 v[220:223], v[104:107], v[80:83], v[220:223]
    ds_read_b64_tr_b16 v[100:101], v10 offset:36864
    v_mfma_f32_16x16x32_bf16 v[216:219], v[104:107], v[76:79], v[216:219]
    ds_read_b64_tr_b16 v[102:103], v10 offset:37376
    v_mfma_f32_16x16x32_bf16 v[212:215], v[104:107], v[72:75], v[212:215]
    s_sub_u32 s68, 0, s68
    v_add_u32 v2, s68, v2
    ds_read_b128 v[84:87], v7 offset:4608
    v_mfma_f32_16x16x32_bf16 v[208:211], v[104:107], v[68:71], v[208:211]
    v_add_u32 v3, s68, v3
    v_mfma_f32_16x16x32_bf16 v[204:207], v[104:107], v[64:67], v[204:207]
    v_add_u32 v4, s68, v4
    v_mfma_f32_16x16x32_bf16 v[200:203], v[104:107], v[60:63], v[200:203]
    v_add_u32 v9, s69, v8
    s_add_u32 s69, s69, 45056
    s_cmp_eq_u32 s69, 163840
    s_cselect_b32 s69, 28672, s69
    s_waitcnt lgkmcnt(0)
    s_barrier
    v_mfma_f32_16x16x32_bf16 v[220:223], v[108:111], v[76:79], v[220:223]
    ds_read_b64_tr_b16 v[104:105], v10 offset:40960
    v_mfma_f32_16x16x32_bf16 v[216:219], v[108:111], v[72:75], v[216:219]
    ds_read_b64_tr_b16 v[106:107], v10 offset:41472
    v_mfma_f32_16x16x32_bf16 v[212:215], v[108:111], v[68:71], v[212:215]
    ds_read_b128 v[36:39], v2 offset:11520
    v_mfma_f32_16x16x32_bf16 v[208:211], v[108:111], v[64:67], v[208:211]
    ds_read_b128 v[32:35], v2 offset:9216
    v_mfma_f32_16x16x32_bf16 v[204:207], v[108:111], v[60:63], v[204:207]
    ds_read_b128 v[28:31], v2 offset:6912
    v_mfma_f32_16x16x32_bf16 v[200:203], v[108:111], v[56:59], v[200:203]
    v_mfma_f32_16x16x32_bf16 v[220:223], v[100:103], v[72:75], v[220:223]
    ds_read_b64_tr_b16 v[88:89], v9 offset:0
    v_mfma_f32_16x16x32_bf16 v[216:219], v[100:103], v[68:71], v[216:219]
    ds_read_b64_tr_b16 v[90:91], v9 offset:512
    v_mfma_f32_16x16x32_bf16 v[212:215], v[100:103], v[64:67], v[212:215]
    ds_read_b128 v[24:27], v2 offset:4608
    v_mfma_f32_16x16x32_bf16 v[208:211], v[100:103], v[60:63], v[208:211]
    ds_read_b128 v[20:23], v2 offset:2304
    v_mfma_f32_16x16x32_bf16 v[204:207], v[100:103], v[56:59], v[204:207]
    ds_read_b128 v[16:19], v2 offset:0
    v_mfma_f32_16x16x32_bf16 v[200:203], v[100:103], v[52:55], v[200:203]
    s_waitcnt lgkmcnt(8)
    v_mfma_f32_16x16x32_bf16 v[220:223], v[104:107], v[68:71], v[220:223]
    ds_read_b64_tr_b16 v[92:93], v9 offset:4096
    v_mfma_f32_16x16x32_bf16 v[216:219], v[104:107], v[64:67], v[216:219]
    ds_read_b64_tr_b16 v[94:95], v9 offset:4608
    v_mfma_f32_16x16x32_bf16 v[212:215], v[104:107], v[60:63], v[212:215]
    ds_read_b128 v[48:51], v3 offset:11520
    v_mfma_f32_16x16x32_bf16 v[208:211], v[104:107], v[56:59], v[208:211]
    ds_read_b128 v[44:47], v3 offset:9216
    v_mfma_f32_16x16x32_bf16 v[204:207], v[104:107], v[52:55], v[204:207]
    v_mfma_f32_16x16x32_bf16 v[200:203], v[104:107], v[84:87], v[200:203]
    s_add_u32 s70, s70, 1
    s_cmp_lt_u32 s70, 4
    s_cbranch_scc1 L_sf3
    s_mov_b32 s70, 0
L_sf4:
    s_waitcnt lgkmcnt(7)
    v_mfma_f32_16x16x32_bf16 v[244:247], v[88:91], v[36:39], v[244:247]
    ds_read_b64_tr_b16 v[96:97], v9 offset:8192
    v_mfma_f32_16x16x32_bf16 v[240:243], v[88:91], v[32:35], v[240:243]
    ds_read_b64_tr_b16 v[98:99], v9 offset:8704
    v_mfma_f32_16x16x32_bf16 v[236:239], v[88:91], v[28:31], v[236:239]
    ds_read_b128 v[40:43], v3 offset:6912
    s_waitcnt lgkmcnt(9)
    v_mfma_f32_16x16x32_bf16 v[232:235], v[88:91], v[24:27], v[232:235]
    s_waitcnt lgkmcnt(8)
    v_mfma_f32_16x16x32_bf16 v[228:231], v[88:91], v[20:23], v[228:231]
    s_waitcnt lgkmcnt(7)
    v_mfma_f32_16x16x32_bf16 v[224:227], v[88:91], v[16:19], v[224:227]
    s_waitcnt lgkmcnt(5)
    v_mfma_f32_16x16x32_bf16 v[244:247], v[92:95], v[32:35], v[244:247]
    ds_read_b64_tr_b16 v[88:89], v9 offset:12288
    v_mfma_f32_16x16x32_bf16 v[240:243], v[92:95], v[28:31], v[240:243]
    ds_read_b64_tr_b16 v[90:91], v9 offset:12800
    v_mfma_f32_16x16x32_bf16 v[236:239], v[92:95], v[24:27], v[236:239]
    ds_read_b128 v[36:39], v3 offset:4608
    v_mfma_f32_16x16x32_bf16 v[232:235], v[92:95], v[20:23], v[232:235]
    v_mfma_f32_16x16x32_bf16 v[228:231], v[92:95], v[16:19], v[228:231]
    s_waitcnt lgkmcnt(7)
    v_mfma_f32_16x16x32_bf16 v[224:227], v[92:95], v[48:51], v[224:227]
    s_waitcnt lgkmcnt(4)
    v_mfma_f32_16x16x32_bf16 v[244:247], v[96:99], v[28:31], v[244:247]
    ds_read_b64_tr_b16 v[92:93], v9 offset:16384
    v_mfma_f32_16x16x32_bf16 v[240:243], v[96:99], v[24:27], v[240:243]
    ds_read_b64_tr_b16 v[94:95], v9 offset:16896
    v_mfma_f32_16x16x32_bf16 v[236:239], v[96:99], v[20:23], v[236:239]
    ds_read_b128 v[32:35], v3 offset:2304
    v_mfma_f32_16x16x32_bf16 v[232:235], v[96:99], v[16:19], v[232:235]
    v_mfma_f32_16x16x32_bf16 v[228:231], v[96:99], v[48:51], v[228:231]
    v_mfma_f32_16x16x32_bf16 v[224:227], v[96:99], v[44:47], v[224:227]
    s_waitcnt lgkmcnt(4)
    v_mfma_f32_16x16x32_bf16 v[244:247], v[88:91], v[24:27], v[244:247]
    ds_read_b64_tr_b16 v[96:97], v9 offset:20480
    v_mfma_f32_16x16x32_bf16 v[240:243], v[88:91], v[20:23], v[240:243]
    ds_read_b64_tr_b16 v[98:99], v9 offset:20992
    v_mfma_f32_16x16x32_bf16 v[236:239], v[88:91], v[16:19], v[236:239]
    ds_read_b128 v[28:31], v3 offset:0
    v_mfma_f32_16x16x32_bf16 v[232:235], v[88:91], v[48:51], v[232:235]
    v_mfma_f32_16x16x32_bf16 v[228:231], v[88:91], v[44:47], v[228:231]
    v_mfma_f32_16x16x32_bf16 v[224:227], v[88:91], v[40:43], v[224:227]
    s_waitcnt lgkmcnt(4)
    v_mfma_f32_16x16x32_bf16 v[244:247], v[92:95], v[20:23], v[244:247]
    ds_read_b64_tr_b16 v[88:89], v9 offset:24576
    v_mfma_f32_16x16x32_bf16 v[240:243], v[92:95], v[16:19], v[240:243]
    ds_read_b64_tr_b16 v[90:91], v9 offset:25088
    v_mfma_f32_16x16x32_bf16 v[236:239], v[92:95], v[48:51], v[236:239]
    ds_read_b128 v[24:27], v4 offset:11520
    v_mfma_f32_16x16x32_bf16 v[232:235], v[92:95], v[44:47], v[232:235]
    v_mfma_f32_16x16x32_bf16 v[228:231], v[92:95], v[40:43], v[228:231]
    v_mfma_f32_16x16x32_bf16 v[224:227], v[92:95], v[36:39], v[224:227]
    s_waitcnt lgkmcnt(4)
    v_mfma_f32_16x16x32_bf16 v[244:247], v[96:99], v[16:19], v[244:247]
    ds_read_b64_tr_b16 v[92:93], v9 offset:28672
    v_mfma_f32_16x16x32_bf16 v[240:243], v[96:99], v[48:51], v[240:243]
    ds_read_b64_tr_b16 v[94:95], v9 offset:29184
    v_mfma_f32_16x16x32_bf16 v[236:239], v[96:99], v[44:47], v[236:239]
    ds_read_b128 v[20:23], v4 offset:9216
    v_mfma_f32_16x16x32_bf16 v[232:235], v[96:99], v[40:43], v[232:235]
    v_mfma_f32_16x16x32_bf16 v[228:231], v[96:99], v[36:39], v[228:231]
    v_mfma_f32_16x16x32_bf16 v[224:227], v[96:99], v[32:35], v[224:227]
    s_waitcnt lgkmcnt(4)
    v_mfma_f32_16x16x32_bf16 v[244:247], v[88:91], v[48:51], v[244:247]
    ds_read_b64_tr_b16 v[96:97], v9 offset:32768
    v_mfma_f32_16x16x32_bf16 v[240:243], v[88:91], v[44:47], v[240:243]
    ds_read_b64_tr_b16 v[98:99], v9 offset:33280
    v_mfma_f32_16x16x32_bf16 v[236:239], v[88:91], v[40:43], v[236:239]
    ds_read_b128 v[16:19], v4 offset:6912
    v_mfma_f32_16x16x32_bf16 v[232:235], v[88:91], v[36:39], v[232:235]
    v_mfma_f32_16x16x32_bf16 v[228:231], v[88:91], v[32:35], v[228:231]
    v_mfma_f32_16x16x32_bf16 v[224:227], v[88:91], v[28:31], v[224:227]
    s_waitcnt lgkmcnt(4)
    v_mfma_f32_16x16x32_bf16 v[244:247], v[92:95], v[44:47], v[244:247]
    ds_read_b64_tr_b16 v[88:89], v9 offset:36864
    v_mfma_f32_16x16x32_bf16 v[240:243], v[92:95], v[40:43], v[240:243]
    ds_read_b64_tr_b16 v[90:91], v9 offset:37376
    v_mfma_f32_16x16x32_bf16 v[236:239], v[92:95], v[36:39], v[236:239]
    v_add_u32 v5, s68, v5
    ds_read_b128 v[48:51], v4 offset:4608
    v_mfma_f32_16x16x32_bf16 v[232:235], v[92:95], v[32:35], v[232:235]
    v_add_u32 v6, s68, v6
    v_mfma_f32_16x16x32_bf16 v[228:231], v[92:95], v[28:31], v[228:231]
    v_add_u32 v7, s68, v7
    v_mfma_f32_16x16x32_bf16 v[224:227], v[92:95], v[24:27], v[224:227]
    v_add_u32 v10, s69, v8
    s_add_u32 s69, s69, 45056
    s_cmp_eq_u32 s69, 163840
    s_cselect_b32 s69, 28672, s69
    s_waitcnt lgkmcnt(0)
    s_barrier
    v_mfma_f32_16x16x32_bf16 v[244:247], v[96:99], v[40:43], v[244:247]
    ds_read_b64_tr_b16 v[92:93], v9 offset:40960
    v_mfma_f32_16x16x32_bf16 v[240:243], v[96:99], v[36:39], v[240:243]
    ds_read_b64_tr_b16 v[94:95], v9 offset:41472
    v_mfma_f32_16x16x32_bf16 v[236:239], v[96:99], v[32:35], v[236:239]
    ds_read_b128 v[72:75], v5 offset:11520
    v_mfma_f32_16x16x32_bf16 v[232:235], v[96:99], v[28:31], v[232:235]
    ds_read_b128 v[68:71], v5 offset:9216
    v_mfma_f32_16x16x32_bf16 v[228:231], v[96:99], v[24:27], v[228:231]
    ds_read_b128 v[64:67], v5 offset:6912
    v_mfma_f32_16x16x32_bf16 v[224:227], v[96:99], v[20:23], v[224:227]
    v_mfma_f32_16x16x32_bf16 v[244:247], v[88:91], v[36:39], v[244:247]
    ds_read_b64_tr_b16 v[100:101], v10 offset:0
    v_mfma_f32_16x16x32_bf16 v[240:243], v[88:91], v[32:35], v[240:243]
    ds_read_b64_tr_b16 v[102:103], v10 offset:512
    v_mfma_f32_16x16x32_bf16 v[236:239], v[88:91], v[28:31], v[236:239]
    ds_read_b128 v[60:63], v5 offset:4608
    v_mfma_f32_16x16x32_bf16 v[232:235], v[88:91], v[24:27], v[232:235]
    ds_read_b128 v[56:59], v5 offset:2304
    v_mfma_f32_16x16x32_bf16 v[228:231], v[88:91], v[20:23], v[228:231]
    ds_read_b128 v[52:55], v5 offset:0
    v_mfma_f32_16x16x32_bf16 v[224:227], v[88:91], v[16:19], v[224:227]
    s_waitcnt lgkmcnt(8)
    v_mfma_f32_16x16x32_bf16 v[244:247], v[92:95], v[32:35], v[244:247]
    ds_read_b64_tr_b16 v[104:105], v10 offset:4096
    v_mfma_f32_16x16x32_bf16 v[240:243], v[92:95], v[28:31], v[240:243]
    ds_read_b64_tr_b16 v[106:107], v10 offset:4608
    v_mfma_f32_16x16x32_bf16 v[236:239], v[92:95], v[24:27], v[236:239]
    ds_read_b128 v[84:87], v6 offset:11520
    v_mfma_f32_16x16x32_bf16 v[232:235], v[92:95], v[20:23], v[232:235]
    ds_read_b128 v[80:83], v6 offset:9216
    v_mfma_f32_16x16x32_bf16 v[228:231], v[92:95], v[16:19], v[228:231]
    v_mfma_f32_16x16x32_bf16 v[224:227], v[92:95], v[48:51], v[224:227]
    s_waitcnt lgkmcnt(7)
    v_mfma_f32_16x16x32_bf16 v[244:247], v[100:103], v[72:75], v[244:247]
    ds_read_b64_tr_b16 v[108:109], v10 offset:8192
    v_mfma_f32_16x16x32_bf16 v[240:243], v[100:103], v[68:71], v[240:243]
    ds_read_b64_tr_b16 v[110:111], v10 offset:8704
    v_mfma_f32_16x16x32_bf16 v[236:239], v[100:103], v[64:67], v[236:239]
    ds_read_b128 v[76:79], v6 offset:6912
    s_waitcnt lgkmcnt(9)
    v_mfma_f32_16x16x32_bf16 v[232:235], v[100:103], v[60:63], v[232:235]
    s_waitcnt lgkmcnt(8)
    v_mfma_f32_16x16x32_bf16 v[228:231], v[100:103], v[56:59], v[228:231]
    s_waitcnt lgkmcnt(7)
    v_mfma_f32_16x16x32_bf16 v[224:227], v[100:103], v[52:55], v[224:227]
    s_waitcnt lgkmcnt(5)
    v_mfma_f32_16x16x32_bf16 v[244:247], v[104:107], v[68:71], v[244:247]
    ds_read_b64_tr_b16 v[100:101], v10 offset:12288
    v_mfma_f32_16x16x32_bf16 v[240:243], v[104:107], v[64:67], v[240:243]
    ds_read_b64_tr_b16 v[102:103], v10 offset:12800
    v_mfma_f32_16x16x32_bf16 v[236:239], v[104:107], v[60:63], v[236:239]
    ds_read_b128 v[72:75], v6 offset:4608
    v_mfma_f32_16x16x32_bf16 v[232:235], v[104:107], v[56:59], v[232:235]
    v_mfma_f32_16x16x32_bf16 v[228:231], v[104:107], v[52:55], v[228:231]
    s_waitcnt lgkmcnt(7)
    v_mfma_f32_16x16x32_bf16 v[224:227], v[104:107], v[84:87], v[224:227]
    s_waitcnt lgkmcnt(4)
    v_mfma_f32_16x16x32_bf16 v[244:247], v[108:111], v[64:67], v[244:247]
    ds_read_b64_tr_b16 v[104:105], v10 offset:16384
    v_mfma_f32_16x16x32_bf16 v[240:243], v[108:111], v[60:63], v[240:243]
    ds_read_b64_tr_b16 v[106:107], v10 offset:16896
    v_mfma_f32_16x16x32_bf16 v[236:239], v[108:111], v[56:59], v[236:239]
    ds_read_b128 v[68:71], v6 offset:2304
    v_mfma_f32_16x16x32_bf16 v[232:235], v[108:111], v[52:55], v[232:235]
    v_mfma_f32_16x16x32_bf16 v[228:231], v[108:111], v[84:87], v[228:231]
    v_mfma_f32_16x16x32_bf16 v[224:227], v[108:111], v[80:83], v[224:227]
    s_waitcnt lgkmcnt(4)
    v_mfma_f32_16x16x32_bf16 v[244:247], v[100:103], v[60:63], v[244:247]
    ds_read_b64_tr_b16 v[108:109], v10 offset:20480
    v_mfma_f32_16x16x32_bf16 v[240:243], v[100:103], v[56:59], v[240:243]
    ds_read_b64_tr_b16 v[110:111], v10 offset:20992
    v_mfma_f32_16x16x32_bf16 v[236:239], v[100:103], v[52:55], v[236:239]
    ds_read_b128 v[64:67], v6 offset:0
    v_mfma_f32_16x16x32_bf16 v[232:235], v[100:103], v[84:87], v[232:235]
    v_mfma_f32_16x16x32_bf16 v[228:231], v[100:103], v[80:83], v[228:231]
    v_mfma_f32_16x16x32_bf16 v[224:227], v[100:103], v[76:79], v[224:227]
    s_waitcnt lgkmcnt(4)
    v_mfma_f32_16x16x32_bf16 v[244:247], v[104:107], v[56:59], v[244:247]
    ds_read_b64_tr_b16 v[100:101], v10 offset:24576
    v_mfma_f32_16x16x32_bf16 v[240:243], v[104:107], v[52:55], v[240:243]
    ds_read_b64_tr_b16 v[102:103], v10 offset:25088
    v_mfma_f32_16x16x32_bf16 v[236:239], v[104:107], v[84:87], v[236:239]
    ds_read_b128 v[60:63], v7 offset:11520
    v_mfma_f32_16x16x32_bf16 v[232:235], v[104:107], v[80:83], v[232:235]
    v_mfma_f32_16x16x32_bf16 v[228:231], v[104:107], v[76:79], v[228:231]
    v_mfma_f32_16x16x32_bf16 v[224:227], v[104:107], v[72:75], v[224:227]
    s_waitcnt lgkmcnt(4)
    v_mfma_f32_16x16x32_bf16 v[244:247], v[108:111], v[52:55], v[244:247]
    ds_read_b64_tr_b16 v[104:105], v10 offset:28672
    v_mfma_f32_16x16x32_bf16 v[240:243], v[108:111], v[84:87], v[240:243]
    ds_read_b64_tr_b16 v[106:107], v10 offset:29184
    v_mfma_f32_16x16x32_bf16 v[236:239], v[108:111], v[80:83], v[236:239]
    ds_read_b128 v[56:59], v7 offset:9216
    v_mfma_f32_16x16x32_bf16 v[232:235], v[108:111], v[76:79], v[232:235]
    v_mfma_f32_16x16x32_bf16 v[228:231], v[108:111], v[72:75], v[228:231]
    v_mfma_f32_16x16x32_bf16 v[224:227], v[108:111], v[68:71], v[224:227]
    s_waitcnt lgkmcnt(4)
    v_mfma_f32_16x16x32_bf16 v[244:247], v[100:103], v[84:87], v[244:247]
    ds_read_b64_tr_b16 v[108:109], v10 offset:32768
    v_mfma_f32_16x16x32_bf16 v[240:243], v[100:103], v[80:83], v[240:243]
    ds_read_b64_tr_b16 v[110:111], v10 offset:33280
    v_mfma_f32_16x16x32_bf16 v[236:239], v[100:103], v[76:79], v[236:239]
    ds_read_b128 v[52:55], v7 offset:6912
    v_mfma_f32_16x16x32_bf16 v[232:235], v[100:103], v[72:75], v[232:235]
    v_mfma_f32_16x16x32_bf16 v[228:231], v[100:103], v[68:71], v[228:231]
    v_mfma_f32_16x16x32_bf16 v[224:227], v[100:103], v[64:67], v[224:227]
    s_waitcnt lgkmcnt(4)
    v_mfma_f32_16x16x32_bf16 v[244:247], v[104:107], v[80:83], v[244:247]
    ds_read_b64_tr_b16 v[100:101], v10 offset:36864
    v_mfma_f32_16x16x32_bf16 v[240:243], v[104:107], v[76:79], v[240:243]
    ds_read_b64_tr_b16 v[102:103], v10 offset:37376
    v_mfma_f32_16x16x32_bf16 v[236:239], v[104:107], v[72:75], v[236:239]
    s_sub_u32 s68, 0, s68
    v_add_u32 v2, s68, v2
    ds_read_b128 v[84:87], v7 offset:4608
    v_mfma_f32_16x16x32_bf16 v[232:235], v[104:107], v[68:71], v[232:235]
    v_add_u32 v3, s68, v3
    v_mfma_f32_16x16x32_bf16 v[228:231], v[104:107], v[64:67], v[228:231]
    v_add_u32 v4, s68, v4
    v_mfma_f32_16x16x32_bf16 v[224:227], v[104:107], v[60:63], v[224:227]
    v_add_u32 v9, s69, v8
    s_add_u32 s69, s69, 45056
    s_cmp_eq_u32 s69, 163840
    s_cselect_b32 s69, 28672, s69
    s_waitcnt lgkmcnt(0)
    s_barrier
    v_mfma_f32_16x16x32_bf16 v[244:247], v[108:111], v[76:79], v[244:247]
    ds_read_b64_tr_b16 v[104:105], v10 offset:40960
    v_mfma_f32_16x16x32_bf16 v[240:243], v[108:111], v[72:75], v[240:243]
    ds_read_b64_tr_b16 v[106:107], v10 offset:41472
    v_mfma_f32_16x16x32_bf16 v[236:239], v[108:111], v[68:71], v[236:239]
    ds_read_b128 v[36:39], v2 offset:11520
    v_mfma_f32_16x16x32_bf16 v[232:235], v[108:111], v[64:67], v[232:235]
    ds_read_b128 v[32:35], v2 offset:9216
    v_mfma_f32_16x16x32_bf16 v[228:231], v[108:111], v[60:63], v[228:231]
    ds_read_b128 v[28:31], v2 offset:6912
    v_mfma_f32_16x16x32_bf16 v[224:227], v[108:111], v[56:59], v[224:227]
    v_mfma_f32_16x16x32_bf16 v[244:247], v[100:103], v[72:75], v[244:247]
    ds_read_b64_tr_b16 v[88:89], v9 offset:0
    v_mfma_f32_16x16x32_bf16 v[240:243], v[100:103], v[68:71], v[240:243]
    ds_read_b64_tr_b16 v[90:91], v9 offset:512
    v_mfma_f32_16x16x32_bf16 v[236:239], v[100:103], v[64:67], v[236:239]
    ds_read_b128 v[24:27], v2 offset:4608
    v_mfma_f32_16x16x32_bf16 v[232:235], v[100:103], v[60:63], v[232:235]
    ds_read_b128 v[20:23], v2 offset:2304
    v_mfma_f32_16x16x32_bf16 v[228:231], v[100:103], v[56:59], v[228:231]
    ds_read_b128 v[16:19], v2 offset:0
    v_mfma_f32_16x16x32_bf16 v[224:227], v[100:103], v[52:55], v[224:227]
    s_waitcnt lgkmcnt(8)
    v_mfma_f32_16x16x32_bf16 v[244:247], v[104:107], v[68:71], v[244:247]
    ds_read_b64_tr_b16 v[92:93], v9 offset:4096
    v_mfma_f32_16x16x32_bf16 v[240:243], v[104:107], v[64:67], v[240:243]
    ds_read_b64_tr_b16 v[94:95], v9 offset:4608
    v_mfma_f32_16x16x32_bf16 v[236:239], v[104:107], v[60:63], v[236:239]
    ds_read_b128 v[48:51], v3 offset:11520
    v_mfma_f32_16x16x32_bf16 v[232:235], v[104:107], v[56:59], v[232:235]
    ds_read_b128 v[44:47], v3 offset:9216
    v_mfma_f32_16x16x32_bf16 v[228:231], v[104:107], v[52:55], v[228:231]
    v_mfma_f32_16x16x32_bf16 v[224:227], v[104:107], v[84:87], v[224:227]
    s_add_u32 s70, s70, 1
    s_cmp_lt_u32 s70, 4
    s_cbranch_scc1 L_sf4
    s_waitcnt lgkmcnt(0)
    s_barrier
    s_mov_b32 s52, 0.5
    s_mov_b32 s53, 0.5
    s_mov_b32 s56, -4.0
    s_mov_b32 s57, -4.0
    s_mov_b32 s58, 0xc1800000
    s_mov_b32 s59, 0xc1800000
    s_mov_b32 s60, 0x3e2aaaab
    s_mov_b32 s61, 0x3e2aaaab
    s_nop 7
    v_pk_add_f32 v[32:33], v[196:197], v[220:221]
    v_pk_add_f32 v[40:41], v[198:199], v[222:223]
    v_pk_add_f32 v[16:17], v[176:177], v[200:201]
    v_pk_add_f32 v[24:25], v[178:179], v[202:203]
    v_pk_add_f32 v[34:35], v[196:197], v[220:221] neg_lo:[0,1] neg_hi:[0,1]
    v_pk_add_f32 v[42:43], v[198:199], v[222:223] neg_lo:[0,1] neg_hi:[0,1]
    v_pk_add_f32 v[18:19], v[176:177], v[200:201] neg_lo:[0,1] neg_hi:[0,1]
    v_pk_add_f32 v[26:27], v[178:179], v[202:203] neg_lo:[0,1] neg_hi:[0,1]
    v_pk_add_f32 v[36:37], v[148:149], v[172:173]
    v_pk_add_f32 v[44:45], v[150:151], v[174:175]
    v_pk_add_f32 v[20:21], v[128:129], v[152:153]
    v_pk_add_f32 v[28:29], v[130:131], v[154:155]
    v_pk_add_f32 v[38:39], v[244:245], v[148:149] neg_lo:[0,1] neg_hi:[0,1]
    v_pk_add_f32 v[46:47], v[246:247], v[150:151] neg_lo:[0,1] neg_hi:[0,1]
    v_pk_add_f32 v[22:23], v[224:225], v[128:129] neg_lo:[0,1] neg_hi:[0,1]
    v_pk_add_f32 v[30:31], v[226:227], v[130:131] neg_lo:[0,1] neg_hi:[0,1]
    v_pk_fma_f32 v[196:197], v[32:33], s[52:53], v[36:37] neg_lo:[0,0,1] neg_hi:[0,0,1]
    v_pk_fma_f32 v[198:199], v[40:41], s[52:53], v[44:45] neg_lo:[0,0,1] neg_hi:[0,0,1]
    v_pk_fma_f32 v[176:177], v[16:17], s[52:53], v[20:21] neg_lo:[0,0,1] neg_hi:[0,0,1]
    v_pk_fma_f32 v[178:179], v[24:25], s[52:53], v[28:29] neg_lo:[0,0,1] neg_hi:[0,0,1]
    v_pk_fma_f32 v[38:39], v[172:173], s[58:59], v[38:39]
    v_pk_fma_f32 v[46:47], v[174:175], s[58:59], v[46:47]
    v_pk_fma_f32 v[22:23], v[152:153], s[58:59], v[22:23]
    v_pk_fma_f32 v[30:31], v[154:155], s[58:59], v[30:31]
    v_pk_add_f32 v[38:39], v[38:39], v[34:35] neg_lo:[0,1] neg_hi:[0,1]
    v_pk_add_f32 v[46:47], v[46:47], v[42:43] neg_lo:[0,1] neg_hi:[0,1]
    v_pk_add_f32 v[22:23], v[22:23], v[18:19] neg_lo:[0,1] neg_hi:[0,1]
    v_pk_add_f32 v[30:31], v[30:31], v[26:27] neg_lo:[0,1] neg_hi:[0,1]
    v_pk_fma_f32 v[38:39], v[196:197], s[56:57], v[38:39]
    v_pk_fma_f32 v[46:47], v[198:199], s[56:57], v[46:47]
    v_pk_fma_f32 v[22:23], v[176:177], s[56:57], v[22:23]
    v_pk_fma_f32 v[30:31], v[178:179], s[56:57], v[30:31]
    v_pk_mul_f32 v[244:245], v[38:39], s[60:61]
    v_pk_mul_f32 v[246:247], v[46:47], s[60:61]
    v_pk_mul_f32 v[224:225], v[22:23], s[60:61]
    v_pk_mul_f32 v[226:227], v[30:31], s[60:61]
    v_pk_fma_f32 v[220:221], v[34:35], s[52:53], v[244:245] neg_lo:[0,0,1] neg_hi:[0,0,1]
    v_pk_fma_f32 v[222:223], v[42:43], s[52:53], v[246:247] neg_lo:[0,0,1] neg_hi:[0,0,1]
    v_pk_fma_f32 v[200:201], v[18:19], s[52:53], v[224:225] neg_lo:[0,0,1] neg_hi:[0,0,1]
    v_pk_fma_f32 v[202:203], v[26:27], s[52:53], v[226:227] neg_lo:[0,0,1] neg_hi:[0,0,1]
    ds_bpermute_b32 v80, v112, v244
    ds_bpermute_b32 v84, v112, v172
    ds_bpermute_b32 v81, v112, v245
    ds_bpermute_b32 v85, v112, v173
    ds_bpermute_b32 v82, v112, v246
    ds_bpermute_b32 v86, v112, v174
    ds_bpermute_b32 v83, v112, v247
    ds_bpermute_b32 v87, v112, v175
    v_pk_add_f32 v[32:33], v[180:181], v[204:205]
    v_pk_add_f32 v[40:41], v[182:183], v[206:207]
    v_pk_add_f32 v[16:17], v[184:185], v[208:209]
    v_pk_add_f32 v[24:25], v[186:187], v[210:211]
    v_pk_add_f32 v[34:35], v[180:181], v[204:205] neg_lo:[0,1] neg_hi:[0,1]
    v_pk_add_f32 v[42:43], v[182:183], v[206:207] neg_lo:[0,1] neg_hi:[0,1]
    v_pk_add_f32 v[18:19], v[184:185], v[208:209] neg_lo:[0,1] neg_hi:[0,1]
    v_pk_add_f32 v[26:27], v[186:187], v[210:211] neg_lo:[0,1] neg_hi:[0,1]
    v_pk_add_f32 v[36:37], v[132:133], v[156:157]
    v_pk_add_f32 v[44:45], v[134:135], v[158:159]
    v_pk_add_f32 v[20:21], v[136:137], v[160:161]
    v_pk_add_f32 v[28:29], v[138:139], v[162:163]
    v_pk_add_f32 v[38:39], v[228:229], v[132:133] neg_lo:[0,1] neg_hi:[0,1]
    v_pk_add_f32 v[46:47], v[230:231], v[134:135] neg_lo:[0,1] neg_hi:[0,1]
    v_pk_add_f32 v[22:23], v[232:233], v[136:137] neg_lo:[0,1] neg_hi:[0,1]
    v_pk_add_f32 v[30:31], v[234:235], v[138:139] neg_lo:[0,1] neg_hi:[0,1]
    v_pk_fma_f32 v[180:181], v[32:33], s[52:53], v[36:37] neg_lo:[0,0,1] neg_hi:[0,0,1]
    v_pk_fma_f32 v[182:183], v[40:41], s[52:53], v[44:45] neg_lo:[0,0,1] neg_hi:[0,0,1]
    v_pk_fma_f32 v[184:185], v[16:17], s[52:53], v[20:21] neg_lo:[0,0,1] neg_hi:[0,0,1]
    v_pk_fma_f32 v[186:187], v[24:25], s[52:53], v[28:29] neg_lo:[0,0,1] neg_hi:[0,0,1]
    v_pk_fma_f32 v[38:39], v[156:157], s[58:59], v[38:39]
    v_pk_fma_f32 v[46:47], v[158:159], s[58:59], v[46:47]
    v_pk_fma_f32 v[22:23], v[160:161], s[58:59], v[22:23]
    v_pk_fma_f32 v[30:31], v[162:163], s[58:59], v[30:31]
    v_pk_add_f32 v[38:39], v[38:39], v[34:35] neg_lo:[0,1] neg_hi:[0,1]
    v_pk_add_f32 v[46:47], v[46:47], v[42:43] neg_lo:[0,1] neg_hi:[0,1]
    v_pk_add_f32 v[22:23], v[22:23], v[18:19] neg_lo:[0,1] neg_hi:[0,1]
    v_pk_add_f32 v[30:31], v[30:31], v[26:27] neg_lo:[0,1] neg_hi:[0,1]
    v_pk_fma_f32 v[38:39], v[180:181], s[56:57], v[38:39]
    v_pk_fma_f32 v[46:47], v[182:183], s[56:57], v[46:47]
    v_pk_fma_f32 v[22:23], v[184:185], s[56:57], v[22:23]
    v_pk_fma_f32 v[30:31], v[186:187], s[56:57], v[30:31]
    v_pk_mul_f32 v[228:229], v[38:39], s[60:61]
    v_pk_mul_f32 v[230:231], v[46:47], s[60:61]
    v_pk_mul_f32 v[232:233], v[22:23], s[60:61]
    v_pk_mul_f32 v[234:235], v[30:31], s[60:61]
    v_pk_fma_f32 v[204:205], v[34:35], s[52:53], v[228:229] neg_lo:[0,0,1] neg_hi:[0,0,1]
    v_pk_fma_f32 v[206:207], v[42:43], s[52:53], v[230:231] neg_lo:[0,0,1] neg_hi:[0,0,1]
    v_pk_fma_f32 v[208:209], v[18:19], s[52:53], v[232:233] neg_lo:[0,0,1] neg_hi:[0,0,1]
    v_pk_fma_f32 v[210:211], v[26:27], s[52:53], v[234:235] neg_lo:[0,0,1] neg_hi:[0,0,1]
    v_pk_add_f32 v[72:73], v[132:133], v[224:225]
    v_pk_add_f32 v[74:75], v[134:135], v[226:227]
    v_cvt_pk_bf16_f32 v76, v72, v73
    v_cvt_pk_bf16_f32 v77, v74, v75
    ds_write_b64 v114, v[76:77] offset:384
    v_pk_add_f32 v[48:49], v[204:205], v[152:153]
    v_pk_add_f32 v[50:51], v[206:207], v[154:155]
    v_cvt_pk_bf16_f32 v52, v48, v49
    v_cvt_pk_bf16_f32 v53, v50, v51
    ds_write_b64 v114, v[52:53] offset:512
    v_cvt_pk_bf16_f32 v60, v180, v181
    v_cvt_pk_bf16_f32 v61, v182, v183
    ds_write_b64 v114, v[60:61] offset:640
    v_pk_add_f32 v[64:65], v[136:137], v[228:229]
    v_pk_add_f32 v[66:67], v[138:139], v[230:231]
    v_cvt_pk_bf16_f32 v68, v64, v65
    v_cvt_pk_bf16_f32 v69, v66, v67
    ds_write_b64 v114, v[68:69] offset:768
    v_pk_add_f32 v[72:73], v[208:209], v[156:157]
    v_pk_add_f32 v[74:75], v[210:211], v[158:159]
    v_cvt_pk_bf16_f32 v76, v72, v73
    v_cvt_pk_bf16_f32 v77, v74, v75
    ds_write_b64 v114, v[76:77] offset:896
    v_cvt_pk_bf16_f32 v52, v184, v185
    v_cvt_pk_bf16_f32 v53, v186, v187
    ds_write_b64 v114, v[52:53] offset:1024
    v_pk_add_f32 v[32:33], v[188:189], v[212:213]
    v_pk_add_f32 v[40:41], v[190:191], v[214:215]
    v_pk_add_f32 v[16:17], v[192:193], v[216:217]
    v_pk_add_f32 v[24:25], v[194:195], v[218:219]
    v_pk_add_f32 v[34:35], v[188:189], v[212:213] neg_lo:[0,1] neg_hi:[0,1]
    v_pk_add_f32 v[42:43], v[190:191], v[214:215] neg_lo:[0,1] neg_hi:[0,1]
    v_pk_add_f32 v[18:19], v[192:193], v[216:217] neg_lo:[0,1] neg_hi:[0,1]
    v_pk_add_f32 v[26:27], v[194:195], v[218:219] neg_lo:[0,1] neg_hi:[0,1]
    v_pk_add_f32 v[36:37], v[140:141], v[164:165]
    v_pk_add_f32 v[44:45], v[142:143], v[166:167]
    v_pk_add_f32 v[20:21], v[144:145], v[168:169]
    v_pk_add_f32 v[28:29], v[146:147], v[170:171]
    v_pk_add_f32 v[38:39], v[236:237], v[140:141] neg_lo:[0,1] neg_hi:[0,1]
    v_pk_add_f32 v[46:47], v[238:239], v[142:143] neg_lo:[0,1] neg_hi:[0,1]
    v_pk_add_f32 v[22:23], v[240:241], v[144:145] neg_lo:[0,1] neg_hi:[0,1]
    v_pk_add_f32 v[30:31], v[242:243], v[146:147] neg_lo:[0,1] neg_hi:[0,1]
    v_pk_fma_f32 v[188:189], v[32:33], s[52:53], v[36:37] neg_lo:[0,0,1] neg_hi:[0,0,1]
    v_pk_fma_f32 v[190:191], v[40:41], s[52:53], v[44:45] neg_lo:[0,0,1] neg_hi:[0,0,1]
    v_pk_fma_f32 v[192:193], v[16:17], s[52:53], v[20:21] neg_lo:[0,0,1] neg_hi:[0,0,1]
    v_pk_fma_f32 v[194:195], v[24:25], s[52:53], v[28:29] neg_lo:[0,0,1] neg_hi:[0,0,1]
    v_pk_fma_f32 v[38:39], v[164:165], s[58:59], v[38:39]
    v_pk_fma_f32 v[46:47], v[166:167], s[58:59], v[46:47]
    v_pk_fma_f32 v[22:23], v[168:169], s[58:59], v[22:23]
    v_pk_fma_f32 v[30:31], v[170:171], s[58:59], v[30:31]
    v_pk_add_f32 v[38:39], v[38:39], v[34:35] neg_lo:[0,1] neg_hi:[0,1]
    v_pk_add_f32 v[46:47], v[46:47], v[42:43] neg_lo:[0,1] neg_hi:[0,1]
    v_pk_add_f32 v[22:23], v[22:23], v[18:19] neg_lo:[0,1] neg_hi:[0,1]
    v_pk_add_f32 v[30:31], v[30:31], v[26:27] neg_lo:[0,1] neg_hi:[0,1]
    v_pk_fma_f32 v[38:39], v[188:189], s[56:57], v[38:39]
    v_pk_fma_f32 v[46:47], v[190:191], s[56:57], v[46:47]
    v_pk_fma_f32 v[22:23], v[192:193], s[56:57], v[22:23]
    v_pk_fma_f32 v[30:31], v[194:195], s[56:57], v[30:31]
    v_pk_mul_f32 v[236:237], v[38:39], s[60:61]
    v_pk_mul_f32 v[238:239], v[46:47], s[60:61]
    v_pk_mul_f32 v[240:241], v[22:23], s[60:61]
    v_pk_mul_f32 v[242:243], v[30:31], s[60:61]
    v_pk_fma_f32 v[212:213], v[34:35], s[52:53], v[236:237] neg_lo:[0,0,1] neg_hi:[0,0,1]
    v_pk_fma_f32 v[214:215], v[42:43], s[52:53], v[238:239] neg_lo:[0,0,1] neg_hi:[0,0,1]
    v_pk_fma_f32 v[216:217], v[18:19], s[52:53], v[240:241] neg_lo:[0,0,1] neg_hi:[0,0,1]
    v_pk_fma_f32 v[218:219], v[26:27], s[52:53], v[242:243] neg_lo:[0,0,1] neg_hi:[0,0,1]
    v_pk_add_f32 v[56:57], v[140:141], v[232:233]
    v_pk_add_f32 v[58:59], v[142:143], v[234:235]
    v_cvt_pk_bf16_f32 v60, v56, v57
    v_cvt_pk_bf16_f32 v61, v58, v59
    ds_write_b64 v114, v[60:61] offset:1152
    v_pk_add_f32 v[64:65], v[212:213], v[160:161]
    v_pk_add_f32 v[66:67], v[214:215], v[162:163]
    v_cvt_pk_bf16_f32 v68, v64, v65
    v_cvt_pk_bf16_f32 v69, v66, v67
    ds_write_b64 v114, v[68:69] offset:1280
    v_cvt_pk_bf16_f32 v76, v188, v189
    v_cvt_pk_bf16_f32 v77, v190, v191
    ds_write_b64 v114, v[76:77] offset:1408
    v_pk_add_f32 v[48:49], v[144:145], v[236:237]
    v_pk_add_f32 v[50:51], v[146:147], v[238:239]
    v_cvt_pk_bf16_f32 v52, v48, v49
    v_cvt_pk_bf16_f32 v53, v50, v51
    ds_write_b64 v114, v[52:53] offset:1536
    v_pk_add_f32 v[56:57], v[216:217], v[164:165]
    v_pk_add_f32 v[58:59], v[218:219], v[166:167]
    v_cvt_pk_bf16_f32 v60, v56, v57
    v_cvt_pk_bf16_f32 v61, v58, v59
    ds_write_b64 v114, v[60:61] offset:1664
    v_cvt_pk_bf16_f32 v68, v192, v193
    v_cvt_pk_bf16_f32 v69, v194, v195
    ds_write_b64 v114, v[68:69] offset:1792
    v_pk_add_f32 v[72:73], v[148:149], v[240:241]
    v_pk_add_f32 v[74:75], v[150:151], v[242:243]
    v_cvt_pk_bf16_f32 v76, v72, v73
    v_cvt_pk_bf16_f32 v77, v74, v75
    ds_write_b64 v114, v[76:77] offset:1920
    v_pk_add_f32 v[48:49], v[220:221], v[168:169]
    v_pk_add_f32 v[50:51], v[222:223], v[170:171]
    v_cvt_pk_bf16_f32 v52, v48, v49
    v_cvt_pk_bf16_f32 v53, v50, v51
    ds_write_b64 v114, v[52:53] offset:2048
    v_cvt_pk_bf16_f32 v60, v196, v197
    v_cvt_pk_bf16_f32 v61, v198, v199
    ds_write_b64 v114, v[60:61] offset:2176
    s_waitcnt lgkmcnt(0)
    v_pk_add_f32 v[48:49], v[128:129], v[80:81]
    v_pk_add_f32 v[50:51], v[130:131], v[82:83]
    v_cvt_pk_bf16_f32 v52, v48, v49
    v_cvt_pk_bf16_f32 v53, v50, v51
    ds_write_b64 v113, v[52:53] offset:0
    v_pk_add_f32 v[56:57], v[200:201], v[84:85]
    v_pk_add_f32 v[58:59], v[202:203], v[86:87]
    v_cvt_pk_bf16_f32 v60, v56, v57
    v_cvt_pk_bf16_f32 v61, v58, v59
    ds_write_b64 v113, v[60:61] offset:128
    v_cvt_pk_bf16_f32 v68, v176, v177
    v_cvt_pk_bf16_f32 v69, v178, v179
    ds_write_b64 v113, v[68:69] offset:256
    s_waitcnt lgkmcnt(0)
    s_branch L_join
L_join:
    s_barrier
    s_mul_i32 s52, s66, 36864
    v_add_u32 v40, 0, v0
    v_lshrrev_b32 v41, 3, v40
    v_and_b32 v42, 7, v40
    v_add_u32 v43, 3, v41
    v_mul_u32_u24 v43, 3641, v43
    v_lshrrev_b32 v43, 16, v43
    v_and_b32 v43, 7, v43
    v_xor_b32 v43, v43, v42
    v_lshlrev_b32 v43, 4, v43
    v_lshl_add_u32 v43, v41, 7, v43
    ds_read_b128 v[48:51], v43 offset:1024
    v_lshlrev_b32 v45, 4, v40
    v_add_u32 v45, s52, v45
    v_mov_b32 v68, v45
    v_add_u32 v40, 512, v0
    v_lshrrev_b32 v41, 3, v40
    v_and_b32 v42, 7, v40
    v_add_u32 v43, 3, v41
    v_mul_u32_u24 v43, 3641, v43
    v_lshrrev_b32 v43, 16, v43
    v_and_b32 v43, 7, v43
    v_xor_b32 v43, v43, v42
    v_lshlrev_b32 v43, 4, v43
    v_lshl_add_u32 v43, v41, 7, v43
    ds_read_b128 v[52:55], v43 offset:1024
    v_lshlrev_b32 v45, 4, v40
    v_add_u32 v45, s52, v45
    v_mov_b32 v69, v45
    v_add_u32 v40, 1024, v0
    v_lshrrev_b32 v41, 3, v40
    v_and_b32 v42, 7, v40
    v_add_u32 v43, 3, v41
    v_mul_u32_u24 v43, 3641, v43
    v_lshrrev_b32 v43, 16, v43
    v_and_b32 v43, 7, v43
    v_xor_b32 v43, v43, v42
    v_lshlrev_b32 v43, 4, v43
    v_lshl_add_u32 v43, v41, 7, v43
    ds_read_b128 v[56:59], v43 offset:1024
    v_lshlrev_b32 v45, 4, v40
    v_add_u32 v45, s52, v45
    v_mov_b32 v70, v45
    v_add_u32 v40, 1536, v0
    v_lshrrev_b32 v41, 3, v40
    v_and_b32 v42, 7, v40
    v_add_u32 v43, 3, v41
    v_mul_u32_u24 v43, 3641, v43
    v_lshrrev_b32 v43, 16, v43
    v_and_b32 v43, 7, v43
    v_xor_b32 v43, v43, v42
    v_lshlrev_b32 v43, 4, v43
    v_lshl_add_u32 v43, v41, 7, v43
    ds_read_b128 v[60:63], v43 offset:1024
    v_lshlrev_b32 v45, 4, v40
    v_add_u32 v45, s52, v45
    v_mov_b32 v71, v45
    v_add_u32 v40, 2048, v0
    v_lshrrev_b32 v41, 3, v40
    v_and_b32 v42, 7, v40
    v_add_u32 v43, 3, v41
    v_mul_u32_u24 v43, 3641, v43
    v_lshrrev_b32 v43, 16, v43
    v_and_b32 v43, 7, v43
    v_xor_b32 v43, v43, v42
    v_lshlrev_b32 v43, 4, v43
    v_lshl_add_u32 v43, v41, 7, v43
    ds_read_b128 v[64:67], v43 offset:1024
    v_lshlrev_b32 v45, 4, v40
    v_add_u32 v45, s52, v45
    s_movk_i32 s54, 285
    v_cmp_gt_u32 vcc, s54, v41
    v_mov_b32 v46, 0x40000000
    s_nop 1
    v_cndmask_b32 v72, v46, v45, vcc
    s_waitcnt lgkmcnt(0)
    buffer_store_dwordx4 v[48:51], v68, s[40:43], 0 offen sc1
    buffer_store_dwordx4 v[52:55], v69, s[40:43], 0 offen sc1
    buffer_store_dwordx4 v[56:59], v70, s[40:43], 0 offen sc1
    buffer_store_dwordx4 v[60:63], v71, s[40:43], 0 offen sc1
    buffer_store_dwordx4 v[64:67], v72, s[40:43], 0 offen sc1
    s_mul_i32 s52, s18, 294912
    s_mul_i32 s53, s17, 4608
    s_add_u32 s52, s52, s53
    s_mul_i32 s60, s17, 36
    s_sub_u32 s53, 285, s60
    s_min_u32 s53, s53, 36
    s_mov_b32 s54, 36864
    s_mul_i32 s61, s20, 285
    s_sub_u32 s61, s61, 1
    s_cmp_eq_u32 s21, 1
    s_cselect_b64 s[58:59], -1, 0
    s_mov_b32 s63, 147456
    s_mov_b32 s64, 0xc038aa3b
    s_mov_b32 s65, 0xbfb8aa3b
    v_lshrrev_b32 v40, 5, v0
    v_and_b32 v41, 31, v0
    v_add_u32 v43, 16, v40
    v_lshrrev_b32 v117, 3, v41
    v_mul_lo_u32 v117, v117, s54
    v_and_b32 v118, 7, v41
    v_lshl_add_u32 v117, v118, 4, v117
    v_lshl_add_u32 v117, v40, 7, v117
    v_add_u32 v117, s52, v117
    v_cmp_gt_u32 vcc, s53, v40
    v_mov_b32 v118, 0x40000000
    s_nop 0
    v_cndmask_b32 v32, v118, v117, vcc
    v_mul_u32_u24 v117, 528, v40
    v_lshl_add_u32 v117, v41, 4, v117
    v_add_u32 v33, 40960, v117
    v_lshrrev_b32 v117, 3, v41
    v_mul_lo_u32 v117, v117, s54
    v_and_b32 v118, 7, v41
    v_lshl_add_u32 v117, v118, 4, v117
    v_lshl_add_u32 v117, v43, 7, v117
    v_add_u32 v117, s52, v117
    v_cmp_gt_u32 vcc, s53, v43
    v_mov_b32 v118, 0x40000000
    s_nop 0
    v_cndmask_b32 v34, v118, v117, vcc
    v_mul_u32_u24 v117, 528, v43
    v_lshl_add_u32 v117, v41, 4, v117
    v_add_u32 v35, 40960, v117
    s_cmp_ge_u32 s16, 4
    s_cbranch_scc1 L_fin_g
    v_add_u32 v42, 8, v40
    v_add_u32 v44, 24, v40
    v_add_u32 v45, 32, v40
    v_lshrrev_b32 v117, 3, v41
    v_mul_lo_u32 v117, v117, s54
    v_and_b32 v118, 7, v41
    v_lshl_add_u32 v117, v118, 4, v117
    v_lshl_add_u32 v117, v45, 7, v117
    v_add_u32 v117, s52, v117
    v_cmp_gt_u32 vcc, s53, v45
    v_mov_b32 v118, 0x40000000
    s_nop 0
    v_cndmask_b32 v38, v118, v117, vcc
    v_mul_u32_u24 v117, 528, v45
    v_lshl_add_u32 v117, v41, 4, v117
    v_add_u32 v39, 40960, v117
    v_add_u32 v100, 69632, v117
    v_add_u32 v117, s60, v45
    v_add_u32 v118, s61, v117
    v_mov_b32 v119, s19
    v_cmp_le_i32 vcc, 0, v118
    v_mul_u32_u24 v120, 911, v117
    v_lshrrev_b32 v120, 16, v120
    v_mul_u32_u24 v121, 72, v120
    v_sub_u32 v121, v117, v121
    v_subrev_u32 v121, 33, v121
    v_cmp_gt_u32 s[56:57], 6, v121
    v_add_u32 v121, 1994, v121
    v_cndmask_b32 v118, v118, v121, s[58:59]
    v_cndmask_b32 v119, v119, v120, s[58:59]
    s_and_b64 s[56:57], s[56:57], s[58:59]
    s_andn2_b64 vcc, vcc, s[58:59]
    s_or_b64 vcc, vcc, s[56:57]
    v_cmp_gt_u32 s[56:57], s53, v45
    s_and_b64 vcc, vcc, s[56:57]
    v_lshrrev_b32 v120, 1, v119
    v_mul_u32_u24 v120, 4000, v120
    v_and_b32 v119, 1, v119
    v_lshl_add_u32 v118, v118, 1, v119
    v_add_u32 v118, v118, v120
    v_lshlrev_b32 v118, 9, v118
    v_lshl_add_u32 v118, v41, 4, v118
    v_mov_b32 v119, 0x40000000
    s_nop 0
    v_cndmask_b32 v101, v119, v118, vcc
    v_mul_u32_u24 v117, 528, v40
    v_lshl_add_u32 v117, v41, 4, v117
    v_add_u32 v92, 69632, v117
    v_add_u32 v117, s60, v40
    v_add_u32 v118, s61, v117
    v_mov_b32 v119, s19
    v_cmp_le_i32 vcc, 0, v118
    v_mul_u32_u24 v120, 911, v117
    v_lshrrev_b32 v120, 16, v120
    v_mul_u32_u24 v121, 72, v120
    v_sub_u32 v121, v117, v121
    v_subrev_u32 v121, 33, v121
    v_cmp_gt_u32 s[56:57], 6, v121
    v_add_u32 v121, 1994, v121
    v_cndmask_b32 v118, v118, v121, s[58:59]
    v_cndmask_b32 v119, v119, v120, s[58:59]
    s_and_b64 s[56:57], s[56:57], s[58:59]
    s_andn2_b64 vcc, vcc, s[58:59]
    s_or_b64 vcc, vcc, s[56:57]
    v_cmp_gt_u32 s[56:57], s53, v40
    s_and_b64 vcc, vcc, s[56:57]
    v_lshrrev_b32 v120, 1, v119
    v_mul_u32_u24 v120, 4000, v120
    v_and_b32 v119, 1, v119
    v_lshl_add_u32 v118, v118, 1, v119
    v_add_u32 v118, v118, v120
    v_lshlrev_b32 v118, 9, v118
    v_lshl_add_u32 v118, v41, 4, v118
    v_mov_b32 v119, 0x40000000
    s_nop 0
    v_cndmask_b32 v93, v119, v118, vcc
    v_mul_u32_u24 v117, 528, v42
    v_lshl_add_u32 v117, v41, 4, v117
    v_add_u32 v94, 69632, v117
    v_add_u32 v117, s60, v42
    v_add_u32 v118, s61, v117
    v_mov_b32 v119, s19
    v_cmp_le_i32 vcc, 0, v118
    v_mul_u32_u24 v120, 911, v117
    v_lshrrev_b32 v120, 16, v120
    v_mul_u32_u24 v121, 72, v120
    v_sub_u32 v121, v117, v121
    v_subrev_u32 v121, 33, v121
    v_cmp_gt_u32 s[56:57], 6, v121
    v_add_u32 v121, 1994, v121
    v_cndmask_b32 v118, v118, v121, s[58:59]
    v_cndmask_b32 v119, v119, v120, s[58:59]
    s_and_b64 s[56:57], s[56:57], s[58:59]
    s_andn2_b64 vcc, vcc, s[58:59]
    s_or_b64 vcc, vcc, s[56:57]
    v_cmp_gt_u32 s[56:57], s53, v42
    s_and_b64 vcc, vcc, s[56:57]
    v_lshrrev_b32 v120, 1, v119
    v_mul_u32_u24 v120, 4000, v120
    v_and_b32 v119, 1, v119
    v_lshl_add_u32 v118, v118, 1, v119
    v_add_u32 v118, v118, v120
    v_lshlrev_b32 v118, 9, v118
    v_lshl_add_u32 v118, v41, 4, v118
    v_mov_b32 v119, 0x40000000
    s_nop 0
    v_cndmask_b32 v95, v119, v118, vcc
    v_mul_u32_u24 v117, 528, v43
    v_lshl_add_u32 v117, v41, 4, v117
    v_add_u32 v96, 69632, v117
    v_add_u32 v117, s60, v43
    v_add_u32 v118, s61, v117
    v_mov_b32 v119, s19
    v_cmp_le_i32 vcc, 0, v118
    v_mul_u32_u24 v120, 911, v117
    v_lshrrev_b32 v120, 16, v120
    v_mul_u32_u24 v121, 72, v120
    v_sub_u32 v121, v117, v121
    v_subrev_u32 v121, 33, v121
    v_cmp_gt_u32 s[56:57], 6, v121
    v_add_u32 v121, 1994, v121
    v_cndmask_b32 v118, v118, v121, s[58:59]
    v_cndmask_b32 v119, v119, v120, s[58:59]
    s_and_b64 s[56:57], s[56:57], s[58:59]
    s_andn2_b64 vcc, vcc, s[58:59]
    s_or_b64 vcc, vcc, s[56:57]
    v_cmp_gt_u32 s[56:57], s53, v43
    s_and_b64 vcc, vcc, s[56:57]
    v_lshrrev_b32 v120, 1, v119
    v_mul_u32_u24 v120, 4000, v120
    v_and_b32 v119, 1, v119
    v_lshl_add_u32 v118, v118, 1, v119
    v_add_u32 v118, v118, v120
    v_lshlrev_b32 v118, 9, v118
    v_lshl_add_u32 v118, v41, 4, v118
    v_mov_b32 v119, 0x40000000
    s_nop 0
    v_cndmask_b32 v97, v119, v118, vcc
    v_mul_u32_u24 v117, 528, v44
    v_lshl_add_u32 v117, v41, 4, v117
    v_add_u32 v98, 69632, v117
    v_add_u32 v117, s60, v44
    v_add_u32 v118, s61, v117
    v_mov_b32 v119, s19
    v_cmp_le_i32 vcc, 0, v118
    v_mul_u32_u24 v120, 911, v117
    v_lshrrev_b32 v120, 16, v120
    v_mul_u32_u24 v121, 72, v120
    v_sub_u32 v121, v117, v121
    v_subrev_u32 v121, 33, v121
    v_cmp_gt_u32 s[56:57], 6, v121
    v_add_u32 v121, 1994, v121
    v_cndmask_b32 v118, v118, v121, s[58:59]
    v_cndmask_b32 v119, v119, v120, s[58:59]
    s_and_b64 s[56:57], s[56:57], s[58:59]
    s_andn2_b64 vcc, vcc, s[58:59]
    s_or_b64 vcc, vcc, s[56:57]
    v_cmp_gt_u32 s[56:57], s53, v44
    s_and_b64 vcc, vcc, s[56:57]
    v_lshrrev_b32 v120, 1, v119
    v_mul_u32_u24 v120, 4000, v120
    v_and_b32 v119, 1, v119
    v_lshl_add_u32 v118, v118, 1, v119
    v_add_u32 v118, v118, v120
    v_lshlrev_b32 v118, 9, v118
    v_lshl_add_u32 v118, v41, 4, v118
    v_mov_b32 v119, 0x40000000
    s_nop 0
    v_cndmask_b32 v99, v119, v118, vcc
    s_waitcnt vmcnt(0)
    s_mov_b32 s62, 100000
L_zp_41:
    buffer_load_dwordx4 v[8:11], v32, s[40:43], 0 offen sc1
    buffer_load_dwordx4 v[12:15], v32, s[40:43], s63 offen sc1
    buffer_load_dwordx4 v[16:19], v34, s[40:43], 0 offen sc1
    buffer_load_dwordx4 v[20:23], v34, s[40:43], s63 offen sc1
    buffer_load_dwordx4 v[64:67], v38, s[40:43], 0 offen sc1
    buffer_load_dwordx4 v[68:71], v38, s[40:43], s63 offen sc1
    s_waitcnt vmcnt(0)
    v_max3_u32 v122, v8, v9, v10
    v_max3_u32 v121, v11, v12, v13
    v_max3_u32 v122, v122, v14, v15
    v_max3_u32 v122, v122, v16, v17
    v_max3_u32 v121, v121, v18, v19
    v_max3_u32 v122, v122, v20, v21
    v_max3_u32 v121, v121, v22, v23
    v_max3_u32 v122, v122, v64, v65
    v_max3_u32 v121, v121, v66, v67
    v_max3_u32 v122, v122, v68, v69
    v_max3_u32 v121, v121, v70, v71
    v_max_u32 v122, v122, v121
    v_cmp_eq_u32 vcc, -1, v122
    s_nop 3
    s_cmp_eq_u64 vcc, 0
    s_cbranch_scc1 L_zd_42
    s_sub_u32 s62, s62, 1
    s_cmp_lg_u32 s62, 0
    s_cbranch_scc1 L_zp_41
L_zd_42:
    v_lshlrev_b32 v48, 16, v8
    v_and_b32 v49, 0xffff0000, v8
    v_lshlrev_b32 v56, 16, v12
    v_and_b32 v57, 0xffff0000, v12
    v_lshlrev_b32 v50, 16, v9
    v_and_b32 v51, 0xffff0000, v9
    v_lshlrev_b32 v58, 16, v13
    v_and_b32 v59, 0xffff0000, v13
    v_lshlrev_b32 v52, 16, v10
    v_and_b32 v53, 0xffff0000, v10
    v_lshlrev_b32 v60, 16, v14
    v_and_b32 v61, 0xffff0000, v14
    v_lshlrev_b32 v54, 16, v11
    v_and_b32 v55, 0xffff0000, v11
    v_lshlrev_b32 v62, 16, v15
    v_and_b32 v63, 0xffff0000, v15
    v_mul_f32 v48, s64, v48
    v_mul_f32 v56, s65, v56
    v_mul_f32 v49, s64, v49
    v_mul_f32 v57, s65, v57
    v_mul_f32 v50, s64, v50
    v_mul_f32 v58, s65, v58
    v_mul_f32 v51, s64, v51
    v_mul_f32 v59, s65, v59
    v_mul_f32 v52, s64, v52
    v_mul_f32 v60, s65, v60
    v_mul_f32 v53, s64, v53
    v_mul_f32 v61, s65, v61
    v_mul_f32 v54, s64, v54
    v_mul_f32 v62, s65, v62
    v_mul_f32 v55, s64, v55
    v_mul_f32 v63, s65, v63
    v_exp_f32 v48, v48
    v_exp_f32 v56, v56
    v_exp_f32 v49, v49
    v_exp_f32 v57, v57
    v_exp_f32 v50, v50
    v_exp_f32 v58, v58
    v_exp_f32 v51, v51
    v_exp_f32 v59, v59
    v_exp_f32 v52, v52
    v_exp_f32 v60, v60
    v_exp_f32 v53, v53
    v_exp_f32 v61, v61
    v_exp_f32 v54, v54
    v_exp_f32 v62, v62
    v_exp_f32 v55, v55
    v_exp_f32 v63, v63
    v_add_f32 v48, 1.0, v48
    v_add_f32 v56, 1.0, v56
    v_add_f32 v49, 1.0, v49
    v_add_f32 v57, 1.0, v57
    v_add_f32 v50, 1.0, v50
    v_add_f32 v58, 1.0, v58
    v_add_f32 v51, 1.0, v51
    v_add_f32 v59, 1.0, v59
    v_add_f32 v52, 1.0, v52
    v_add_f32 v60, 1.0, v60
    v_add_f32 v53, 1.0, v53
    v_add_f32 v61, 1.0, v61
    v_add_f32 v54, 1.0, v54
    v_add_f32 v62, 1.0, v62
    v_add_f32 v55, 1.0, v55
    v_add_f32 v63, 1.0, v63
    v_rcp_f32 v48, v48
    v_rcp_f32 v56, v56
    v_rcp_f32 v49, v49
    v_rcp_f32 v57, v57
    v_rcp_f32 v50, v50
    v_rcp_f32 v58, v58
    v_rcp_f32 v51, v51
    v_rcp_f32 v59, v59
    v_rcp_f32 v52, v52
    v_rcp_f32 v60, v60
    v_rcp_f32 v53, v53
    v_rcp_f32 v61, v61
    v_rcp_f32 v54, v54
    v_rcp_f32 v62, v62
    v_rcp_f32 v55, v55
    v_rcp_f32 v63, v63
    v_fma_f32 v48, 2.0, v48, -1.0
    v_fma_f32 v49, 2.0, v49, -1.0
    v_fma_f32 v50, 2.0, v50, -1.0
    v_fma_f32 v51, 2.0, v51, -1.0
    v_fma_f32 v52, 2.0, v52, -1.0
    v_fma_f32 v53, 2.0, v53, -1.0
    v_fma_f32 v54, 2.0, v54, -1.0
    v_fma_f32 v55, 2.0, v55, -1.0
    v_mul_f32 v48, v48, v56
    v_mul_f32 v49, v49, v57
    v_mul_f32 v50, v50, v58
    v_mul_f32 v51, v51, v59
    v_mul_f32 v52, v52, v60
    v_mul_f32 v53, v53, v61
    v_mul_f32 v54, v54, v62
    v_mul_f32 v55, v55, v63
    v_cvt_pk_bf16_f32 v8, v48, v49
    v_cvt_pk_bf16_f32 v9, v50, v51
    v_cvt_pk_bf16_f32 v10, v52, v53
    v_cvt_pk_bf16_f32 v11, v54, v55
    ds_write_b128 v33, v[8:11]
    v_lshlrev_b32 v48, 16, v16
    v_and_b32 v49, 0xffff0000, v16
    v_lshlrev_b32 v56, 16, v20
    v_and_b32 v57, 0xffff0000, v20
    v_lshlrev_b32 v50, 16, v17
    v_and_b32 v51, 0xffff0000, v17
    v_lshlrev_b32 v58, 16, v21
    v_and_b32 v59, 0xffff0000, v21
    v_lshlrev_b32 v52, 16, v18
    v_and_b32 v53, 0xffff0000, v18
    v_lshlrev_b32 v60, 16, v22
    v_and_b32 v61, 0xffff0000, v22
    v_lshlrev_b32 v54, 16, v19
    v_and_b32 v55, 0xffff0000, v19
    v_lshlrev_b32 v62, 16, v23
    v_and_b32 v63, 0xffff0000, v23
    v_mul_f32 v48, s64, v48
    v_mul_f32 v56, s65, v56
    v_mul_f32 v49, s64, v49
    v_mul_f32 v57, s65, v57
    v_mul_f32 v50, s64, v50
    v_mul_f32 v58, s65, v58
    v_mul_f32 v51, s64, v51
    v_mul_f32 v59, s65, v59
    v_mul_f32 v52, s64, v52
    v_mul_f32 v60, s65, v60
    v_mul_f32 v53, s64, v53
    v_mul_f32 v61, s65, v61
    v_mul_f32 v54, s64, v54
    v_mul_f32 v62, s65, v62
    v_mul_f32 v55, s64, v55
    v_mul_f32 v63, s65, v63
    v_exp_f32 v48, v48
    v_exp_f32 v56, v56
    v_exp_f32 v49, v49
    v_exp_f32 v57, v57
    v_exp_f32 v50, v50
    v_exp_f32 v58, v58
    v_exp_f32 v51, v51
    v_exp_f32 v59, v59
    v_exp_f32 v52, v52
    v_exp_f32 v60, v60
    v_exp_f32 v53, v53
    v_exp_f32 v61, v61
    v_exp_f32 v54, v54
    v_exp_f32 v62, v62
    v_exp_f32 v55, v55
    v_exp_f32 v63, v63
    v_add_f32 v48, 1.0, v48
    v_add_f32 v56, 1.0, v56
    v_add_f32 v49, 1.0, v49
    v_add_f32 v57, 1.0, v57
    v_add_f32 v50, 1.0, v50
    v_add_f32 v58, 1.0, v58
    v_add_f32 v51, 1.0, v51
    v_add_f32 v59, 1.0, v59
    v_add_f32 v52, 1.0, v52
    v_add_f32 v60, 1.0, v60
    v_add_f32 v53, 1.0, v53
    v_add_f32 v61, 1.0, v61
    v_add_f32 v54, 1.0, v54
    v_add_f32 v62, 1.0, v62
    v_add_f32 v55, 1.0, v55
    v_add_f32 v63, 1.0, v63
    v_rcp_f32 v48, v48
    v_rcp_f32 v56, v56
    v_rcp_f32 v49, v49
    v_rcp_f32 v57, v57
    v_rcp_f32 v50, v50
    v_rcp_f32 v58, v58
    v_rcp_f32 v51, v51
    v_rcp_f32 v59, v59
    v_rcp_f32 v52, v52
    v_rcp_f32 v60, v60
    v_rcp_f32 v53, v53
    v_rcp_f32 v61, v61
    v_rcp_f32 v54, v54
    v_rcp_f32 v62, v62
    v_rcp_f32 v55, v55
    v_rcp_f32 v63, v63
    v_fma_f32 v48, 2.0, v48, -1.0
    v_fma_f32 v49, 2.0, v49, -1.0
    v_fma_f32 v50, 2.0, v50, -1.0
    v_fma_f32 v51, 2.0, v51, -1.0
    v_fma_f32 v52, 2.0, v52, -1.0
    v_fma_f32 v53, 2.0, v53, -1.0
    v_fma_f32 v54, 2.0, v54, -1.0
    v_fma_f32 v55, 2.0, v55, -1.0
    v_mul_f32 v48, v48, v56
    v_mul_f32 v49, v49, v57
    v_mul_f32 v50, v50, v58
    v_mul_f32 v51, v51, v59
    v_mul_f32 v52, v52, v60
    v_mul_f32 v53, v53, v61
    v_mul_f32 v54, v54, v62
    v_mul_f32 v55, v55, v63
    v_cvt_pk_bf16_f32 v16, v48, v49
    v_cvt_pk_bf16_f32 v17, v50, v51
    v_cvt_pk_bf16_f32 v18, v52, v53
    v_cvt_pk_bf16_f32 v19, v54, v55
    ds_write_b128 v35, v[16:19]
    s_waitcnt lgkmcnt(0)
    s_barrier
    s_cmp_ge_u32 s16, 2
    s_cbranch_scc1 L_zc_43
    v_lshlrev_b32 v48, 16, v64
    v_and_b32 v49, 0xffff0000, v64
    v_lshlrev_b32 v56, 16, v68
    v_and_b32 v57, 0xffff0000, v68
    v_lshlrev_b32 v50, 16, v65
    v_and_b32 v51, 0xffff0000, v65
    v_lshlrev_b32 v58, 16, v69
    v_and_b32 v59, 0xffff0000, v69
    v_lshlrev_b32 v52, 16, v66
    v_and_b32 v53, 0xffff0000, v66
    v_lshlrev_b32 v60, 16, v70
    v_and_b32 v61, 0xffff0000, v70
    v_lshlrev_b32 v54, 16, v67
    v_and_b32 v55, 0xffff0000, v67
    v_lshlrev_b32 v62, 16, v71
    v_and_b32 v63, 0xffff0000, v71
    v_mul_f32 v48, s64, v48
    v_mul_f32 v56, s65, v56
    v_mul_f32 v49, s64, v49
    v_mul_f32 v57, s65, v57
    v_mul_f32 v50, s64, v50
    v_mul_f32 v58, s65, v58
    v_mul_f32 v51, s64, v51
    v_mul_f32 v59, s65, v59
    v_mul_f32 v52, s64, v52
    v_mul_f32 v60, s65, v60
    v_mul_f32 v53, s64, v53
    v_mul_f32 v61, s65, v61
    v_mul_f32 v54, s64, v54
    v_mul_f32 v62, s65, v62
    v_mul_f32 v55, s64, v55
    v_mul_f32 v63, s65, v63
    v_exp_f32 v48, v48
    v_exp_f32 v56, v56
    v_exp_f32 v49, v49
    v_exp_f32 v57, v57
    v_exp_f32 v50, v50
    v_exp_f32 v58, v58
    v_exp_f32 v51, v51
    v_exp_f32 v59, v59
    v_exp_f32 v52, v52
    v_exp_f32 v60, v60
    v_exp_f32 v53, v53
    v_exp_f32 v61, v61
    v_exp_f32 v54, v54
    v_exp_f32 v62, v62
    v_exp_f32 v55, v55
    v_exp_f32 v63, v63
    v_add_f32 v48, 1.0, v48
    v_add_f32 v56, 1.0, v56
    v_add_f32 v49, 1.0, v49
    v_add_f32 v57, 1.0, v57
    v_add_f32 v50, 1.0, v50
    v_add_f32 v58, 1.0, v58
    v_add_f32 v51, 1.0, v51
    v_add_f32 v59, 1.0, v59
    v_add_f32 v52, 1.0, v52
    v_add_f32 v60, 1.0, v60
    v_add_f32 v53, 1.0, v53
    v_add_f32 v61, 1.0, v61
    v_add_f32 v54, 1.0, v54
    v_add_f32 v62, 1.0, v62
    v_add_f32 v55, 1.0, v55
    v_add_f32 v63, 1.0, v63
    v_rcp_f32 v48, v48
    v_rcp_f32 v56, v56
    v_rcp_f32 v49, v49
    v_rcp_f32 v57, v57
    v_rcp_f32 v50, v50
    v_rcp_f32 v58, v58
    v_rcp_f32 v51, v51
    v_rcp_f32 v59, v59
    v_rcp_f32 v52, v52
    v_rcp_f32 v60, v60
    v_rcp_f32 v53, v53
    v_rcp_f32 v61, v61
    v_rcp_f32 v54, v54
    v_rcp_f32 v62, v62
    v_rcp_f32 v55, v55
    v_rcp_f32 v63, v63
    v_fma_f32 v48, 2.0, v48, -1.0
    v_fma_f32 v49, 2.0, v49, -1.0
    v_fma_f32 v50, 2.0, v50, -1.0
    v_fma_f32 v51, 2.0, v51, -1.0
    v_fma_f32 v52, 2.0, v52, -1.0
    v_fma_f32 v53, 2.0, v53, -1.0
    v_fma_f32 v54, 2.0, v54, -1.0
    v_fma_f32 v55, 2.0, v55, -1.0
    v_mul_f32 v48, v48, v56
    v_mul_f32 v49, v49, v57
    v_mul_f32 v50, v50, v58
    v_mul_f32 v51, v51, v59
    v_mul_f32 v52, v52, v60
    v_mul_f32 v53, v53, v61
    v_mul_f32 v54, v54, v62
    v_mul_f32 v55, v55, v63
    v_cvt_pk_bf16_f32 v64, v48, v49
    v_cvt_pk_bf16_f32 v65, v50, v51
    v_cvt_pk_bf16_f32 v66, v52, v53
    v_cvt_pk_bf16_f32 v67, v54, v55
    ds_write_b128 v39, v[64:67]
    s_waitcnt lgkmcnt(0)
L_zc_43:
    s_barrier
    ds_read_b128 v[72:75], v92
    ds_read_b128 v[76:79], v94
    ds_read_b128 v[80:83], v96
    ds_read_b128 v[84:87], v98
    s_waitcnt lgkmcnt(0)
    buffer_store_dwordx4 v[72:75], v93, s[48:51], 0 offen sc0 sc1
    buffer_store_dwordx4 v[76:79], v95, s[48:51], 0 offen sc0 sc1
    buffer_store_dwordx4 v[80:83], v97, s[48:51], 0 offen sc0 sc1
    buffer_store_dwordx4 v[84:87], v99, s[48:51], 0 offen sc0 sc1
    s_barrier
    ds_read_b128 v[88:91], v100
    s_waitcnt lgkmcnt(0)
    buffer_store_dwordx4 v[88:91], v101, s[48:51], 0 offen sc0 sc1
    s_branch L_fin_end
L_fin_g:
    v_and_b32 v2, 63, v0
    v_and_b32 v3, 15, v2
    v_lshrrev_b32 v4, 4, v2
    v_mul_u32_u24 v112, 528, v3
    v_lshl_add_u32 v113, v4, 4, v112
    v_add_u32 v112, 40960, v113
    s_sub_u32 s55, s16, 4
    s_lshl_b32 s55, s55, 7
    s_add_u32 s55, s55, 69632
    v_add_u32 v113, s55, v113
    v_mov_b64 v[64:65], 0
    v_mov_b64 v[66:67], 0
    v_mov_b64 v[68:69], 0
    v_mov_b64 v[70:71], 0
    v_mov_b64 v[72:73], 0
    v_mov_b64 v[74:75], 0
    v_mov_b64 v[76:77], 0
    v_mov_b64 v[78:79], 0
    v_mov_b64 v[80:81], 0
    v_mov_b64 v[82:83], 0
    v_mov_b64 v[84:85], 0
    v_mov_b64 v[86:87], 0
    v_mov_b64 v[88:89], 0
    v_mov_b64 v[90:91], 0
    v_mov_b64 v[92:93], 0
    v_mov_b64 v[94:95], 0
    v_mov_b64 v[96:97], 0
    v_mov_b64 v[98:99], 0
    v_mov_b64 v[100:101], 0
    v_mov_b64 v[102:103], 0
    v_mov_b64 v[104:105], 0
    v_mov_b64 v[106:107], 0
    v_mov_b64 v[108:109], 0
    v_mov_b64 v[110:111], 0
    s_waitcnt vmcnt(0)
    s_mov_b32 s62, 100000
L_zp_44:
    buffer_load_dwordx4 v[8:11], v32, s[40:43], 0 offen sc1
    buffer_load_dwordx4 v[12:15], v32, s[40:43], s63 offen sc1
    buffer_load_dwordx4 v[16:19], v34, s[40:43], 0 offen sc1
    buffer_load_dwordx4 v[20:23], v34, s[40:43], s63 offen sc1
    s_waitcnt vmcnt(0)
    v_max3_u32 v122, v8, v9, v10
    v_max3_u32 v121, v11, v12, v13
    v_max3_u32 v122, v122, v14, v15
    v_max3_u32 v122, v122, v16, v17
    v_max3_u32 v121, v121, v18, v19
    v_max3_u32 v122, v122, v20, v21
    v_max3_u32 v121, v121, v22, v23
    v_max_u32 v122, v122, v121
    v_cmp_eq_u32 vcc, -1, v122
    s_nop 3
    s_cmp_eq_u64 vcc, 0
    s_cbranch_scc1 L_zd_45
    s_sub_u32 s62, s62, 1
    s_cmp_lg_u32 s62, 0
    s_cbranch_scc1 L_zp_44
L_zd_45:
    v_lshlrev_b32 v48, 16, v8
    v_and_b32 v49, 0xffff0000, v8
    v_lshlrev_b32 v56, 16, v12
    v_and_b32 v57, 0xffff0000, v12
    v_lshlrev_b32 v50, 16, v9
    v_and_b32 v51, 0xffff0000, v9
    v_lshlrev_b32 v58, 16, v13
    v_and_b32 v59, 0xffff0000, v13
    v_lshlrev_b32 v52, 16, v10
    v_and_b32 v53, 0xffff0000, v10
    v_lshlrev_b32 v60, 16, v14
    v_and_b32 v61, 0xffff0000, v14
    v_lshlrev_b32 v54, 16, v11
    v_and_b32 v55, 0xffff0000, v11
    v_lshlrev_b32 v62, 16, v15
    v_and_b32 v63, 0xffff0000, v15
    v_mul_f32 v48, s64, v48
    v_mul_f32 v56, s65, v56
    v_mul_f32 v49, s64, v49
    v_mul_f32 v57, s65, v57
    v_mul_f32 v50, s64, v50
    v_mul_f32 v58, s65, v58
    v_mul_f32 v51, s64, v51
    v_mul_f32 v59, s65, v59
    v_mul_f32 v52, s64, v52
    v_mul_f32 v60, s65, v60
    v_mul_f32 v53, s64, v53
    v_mul_f32 v61, s65, v61
    v_mul_f32 v54, s64, v54
    v_mul_f32 v62, s65, v62
    v_mul_f32 v55, s64, v55
    v_mul_f32 v63, s65, v63
    v_exp_f32 v48, v48
    v_exp_f32 v56, v56
    v_exp_f32 v49, v49
    v_exp_f32 v57, v57
    v_exp_f32 v50, v50
    v_exp_f32 v58, v58
    v_exp_f32 v51, v51
    v_exp_f32 v59, v59
    v_exp_f32 v52, v52
    v_exp_f32 v60, v60
    v_exp_f32 v53, v53
    v_exp_f32 v61, v61
    v_exp_f32 v54, v54
    v_exp_f32 v62, v62
    v_exp_f32 v55, v55
    v_exp_f32 v63, v63
    v_add_f32 v48, 1.0, v48
    v_add_f32 v56, 1.0, v56
    v_add_f32 v49, 1.0, v49
    v_add_f32 v57, 1.0, v57
    v_add_f32 v50, 1.0, v50
    v_add_f32 v58, 1.0, v58
    v_add_f32 v51, 1.0, v51
    v_add_f32 v59, 1.0, v59
    v_add_f32 v52, 1.0, v52
    v_add_f32 v60, 1.0, v60
    v_add_f32 v53, 1.0, v53
    v_add_f32 v61, 1.0, v61
    v_add_f32 v54, 1.0, v54
    v_add_f32 v62, 1.0, v62
    v_add_f32 v55, 1.0, v55
    v_add_f32 v63, 1.0, v63
    v_rcp_f32 v48, v48
    v_rcp_f32 v56, v56
    v_rcp_f32 v49, v49
    v_rcp_f32 v57, v57
    v_rcp_f32 v50, v50
    v_rcp_f32 v58, v58
    v_rcp_f32 v51, v51
    v_rcp_f32 v59, v59
    v_rcp_f32 v52, v52
    v_rcp_f32 v60, v60
    v_rcp_f32 v53, v53
    v_rcp_f32 v61, v61
    v_rcp_f32 v54, v54
    v_rcp_f32 v62, v62
    v_rcp_f32 v55, v55
    v_rcp_f32 v63, v63
    v_fma_f32 v48, 2.0, v48, -1.0
    v_fma_f32 v49, 2.0, v49, -1.0
    v_fma_f32 v50, 2.0, v50, -1.0
    v_fma_f32 v51, 2.0, v51, -1.0
    v_fma_f32 v52, 2.0, v52, -1.0
    v_fma_f32 v53, 2.0, v53, -1.0
    v_fma_f32 v54, 2.0, v54, -1.0
    v_fma_f32 v55, 2.0, v55, -1.0
    v_mul_f32 v48, v48, v56
    v_mul_f32 v49, v49, v57
    v_mul_f32 v50, v50, v58
    v_mul_f32 v51, v51, v59
    v_mul_f32 v52, v52, v60
    v_mul_f32 v53, v53, v61
    v_mul_f32 v54, v54, v62
    v_mul_f32 v55, v55, v63
    v_cvt_pk_bf16_f32 v8, v48, v49
    v_cvt_pk_bf16_f32 v9, v50, v51
    v_cvt_pk_bf16_f32 v10, v52, v53
    v_cvt_pk_bf16_f32 v11, v54, v55
    ds_write_b128 v33, v[8:11]
    v_lshlrev_b32 v48, 16, v16
    v_and_b32 v49, 0xffff0000, v16
    v_lshlrev_b32 v56, 16, v20
    v_and_b32 v57, 0xffff0000, v20
    v_lshlrev_b32 v50, 16, v17
    v_and_b32 v51, 0xffff0000, v17
    v_lshlrev_b32 v58, 16, v21
    v_and_b32 v59, 0xffff0000, v21
    v_lshlrev_b32 v52, 16, v18
    v_and_b32 v53, 0xffff0000, v18
    v_lshlrev_b32 v60, 16, v22
    v_and_b32 v61, 0xffff0000, v22
    v_lshlrev_b32 v54, 16, v19
    v_and_b32 v55, 0xffff0000, v19
    v_lshlrev_b32 v62, 16, v23
    v_and_b32 v63, 0xffff0000, v23
    v_mul_f32 v48, s64, v48
    v_mul_f32 v56, s65, v56
    v_mul_f32 v49, s64, v49
    v_mul_f32 v57, s65, v57
    v_mul_f32 v50, s64, v50
    v_mul_f32 v58, s65, v58
    v_mul_f32 v51, s64, v51
    v_mul_f32 v59, s65, v59
    v_mul_f32 v52, s64, v52
    v_mul_f32 v60, s65, v60
    v_mul_f32 v53, s64, v53
    v_mul_f32 v61, s65, v61
    v_mul_f32 v54, s64, v54
    v_mul_f32 v62, s65, v62
    v_mul_f32 v55, s64, v55
    v_mul_f32 v63, s65, v63
    v_exp_f32 v48, v48
    v_exp_f32 v56, v56
    v_exp_f32 v49, v49
    v_exp_f32 v57, v57
    v_exp_f32 v50, v50
    v_exp_f32 v58, v58
    v_exp_f32 v51, v51
    v_exp_f32 v59, v59
    v_exp_f32 v52, v52
    v_exp_f32 v60, v60
    v_exp_f32 v53, v53
    v_exp_f32 v61, v61
    v_exp_f32 v54, v54
    v_exp_f32 v62, v62
    v_exp_f32 v55, v55
    v_exp_f32 v63, v63
    v_add_f32 v48, 1.0, v48
    v_add_f32 v56, 1.0, v56
    v_add_f32 v49, 1.0, v49
    v_add_f32 v57, 1.0, v57
    v_add_f32 v50, 1.0, v50
    v_add_f32 v58, 1.0, v58
    v_add_f32 v51, 1.0, v51
    v_add_f32 v59, 1.0, v59
    v_add_f32 v52, 1.0, v52
    v_add_f32 v60, 1.0, v60
    v_add_f32 v53, 1.0, v53
    v_add_f32 v61, 1.0, v61
    v_add_f32 v54, 1.0, v54
    v_add_f32 v62, 1.0, v62
    v_add_f32 v55, 1.0, v55
    v_add_f32 v63, 1.0, v63
    v_rcp_f32 v48, v48
    v_rcp_f32 v56, v56
    v_rcp_f32 v49, v49
    v_rcp_f32 v57, v57
    v_rcp_f32 v50, v50
    v_rcp_f32 v58, v58
    v_rcp_f32 v51, v51
    v_rcp_f32 v59, v59
    v_rcp_f32 v52, v52
    v_rcp_f32 v60, v60
    v_rcp_f32 v53, v53
    v_rcp_f32 v61, v61
    v_rcp_f32 v54, v54
    v_rcp_f32 v62, v62
    v_rcp_f32 v55, v55
    v_rcp_f32 v63, v63
    v_fma_f32 v48, 2.0, v48, -1.0
    v_fma_f32 v49, 2.0, v49, -1.0
    v_fma_f32 v50, 2.0, v50, -1.0
    v_fma_f32 v51, 2.0, v51, -1.0
    v_fma_f32 v52, 2.0, v52, -1.0
    v_fma_f32 v53, 2.0, v53, -1.0
    v_fma_f32 v54, 2.0, v54, -1.0
    v_fma_f32 v55, 2.0, v55, -1.0
    v_mul_f32 v48, v48, v56
    v_mul_f32 v49, v49, v57
    v_mul_f32 v50, v50, v58
    v_mul_f32 v51, v51, v59
    v_mul_f32 v52, v52, v60
    v_mul_f32 v53, v53, v61
    v_mul_f32 v54, v54, v62
    v_mul_f32 v55, v55, v63
    v_cvt_pk_bf16_f32 v16, v48, v49
    v_cvt_pk_bf16_f32 v17, v50, v51
    v_cvt_pk_bf16_f32 v18, v52, v53
    v_cvt_pk_bf16_f32 v19, v54, v55
    ds_write_b128 v35, v[16:19]
    s_waitcnt lgkmcnt(0)
    s_barrier
    ds_read_b128 v[8:11], v112 offset:0
    ds_read_b128 v[12:15], v112 offset:8448
    ds_read_b128 v[16:19], v112 offset:64
    ds_read_b128 v[20:23], v112 offset:8512
    ds_read_b128 v[24:27], v112 offset:128
    ds_read_b128 v[28:31], v112 offset:8576
    s_waitcnt lgkmcnt(4)
    v_mfma_f32_16x16x32_bf16 v[64:67], v[128:131], v[8:11], v[64:67]
    v_mfma_f32_16x16x32_bf16 v[68:71], v[128:131], v[12:15], v[68:71]
    v_mfma_f32_16x16x32_bf16 v[76:79], v[160:163], v[8:11], v[76:79]
    v_mfma_f32_16x16x32_bf16 v[80:83], v[160:163], v[12:15], v[80:83]
    v_mfma_f32_16x16x32_bf16 v[88:91], v[192:195], v[8:11], v[88:91]
    v_mfma_f32_16x16x32_bf16 v[92:95], v[192:195], v[12:15], v[92:95]
    v_mfma_f32_16x16x32_bf16 v[100:103], v[224:227], v[8:11], v[100:103]
    v_mfma_f32_16x16x32_bf16 v[104:107], v[224:227], v[12:15], v[104:107]
    ds_read_b128 v[8:11], v112 offset:192
    ds_read_b128 v[12:15], v112 offset:8640
    s_waitcnt lgkmcnt(4)
    v_mfma_f32_16x16x32_bf16 v[64:67], v[132:135], v[16:19], v[64:67]
    v_mfma_f32_16x16x32_bf16 v[68:71], v[132:135], v[20:23], v[68:71]
    v_mfma_f32_16x16x32_bf16 v[76:79], v[164:167], v[16:19], v[76:79]
    v_mfma_f32_16x16x32_bf16 v[80:83], v[164:167], v[20:23], v[80:83]
    v_mfma_f32_16x16x32_bf16 v[88:91], v[196:199], v[16:19], v[88:91]
    v_mfma_f32_16x16x32_bf16 v[92:95], v[196:199], v[20:23], v[92:95]
    v_mfma_f32_16x16x32_bf16 v[100:103], v[228:231], v[16:19], v[100:103]
    v_mfma_f32_16x16x32_bf16 v[104:107], v[228:231], v[20:23], v[104:107]
    ds_read_b128 v[16:19], v112 offset:256
    ds_read_b128 v[20:23], v112 offset:8704
    s_waitcnt lgkmcnt(4)
    v_mfma_f32_16x16x32_bf16 v[64:67], v[136:139], v[24:27], v[64:67]
    v_mfma_f32_16x16x32_bf16 v[68:71], v[136:139], v[28:31], v[68:71]
    v_mfma_f32_16x16x32_bf16 v[76:79], v[168:171], v[24:27], v[76:79]
    v_mfma_f32_16x16x32_bf16 v[80:83], v[168:171], v[28:31], v[80:83]
    v_mfma_f32_16x16x32_bf16 v[88:91], v[200:203], v[24:27], v[88:91]
    v_mfma_f32_16x16x32_bf16 v[92:95], v[200:203], v[28:31], v[92:95]
    v_mfma_f32_16x16x32_bf16 v[100:103], v[232:235], v[24:27], v[100:103]
    v_mfma_f32_16x16x32_bf16 v[104:107], v[232:235], v[28:31], v[104:107]
    ds_read_b128 v[24:27], v112 offset:320
    ds_read_b128 v[28:31], v112 offset:8768
    s_waitcnt lgkmcnt(4)
    v_mfma_f32_16x16x32_bf16 v[64:67], v[140:143], v[8:11], v[64:67]
    v_mfma_f32_16x16x32_bf16 v[68:71], v[140:143], v[12:15], v[68:71]
    v_mfma_f32_16x16x32_bf16 v[76:79], v[172:175], v[8:11], v[76:79]
    v_mfma_f32_16x16x32_bf16 v[80:83], v[172:175], v[12:15], v[80:83]
    v_mfma_f32_16x16x32_bf16 v[88:91], v[204:207], v[8:11], v[88:91]
    v_mfma_f32_16x16x32_bf16 v[92:95], v[204:207], v[12:15], v[92:95]
    v_mfma_f32_16x16x32_bf16 v[100:103], v[236:239], v[8:11], v[100:103]
    v_mfma_f32_16x16x32_bf16 v[104:107], v[236:239], v[12:15], v[104:107]
    ds_read_b128 v[8:11], v112 offset:384
    ds_read_b128 v[12:15], v112 offset:8832
    s_waitcnt lgkmcnt(4)
    v_mfma_f32_16x16x32_bf16 v[64:67], v[144:147], v[16:19], v[64:67]
    v_mfma_f32_16x16x32_bf16 v[68:71], v[144:147], v[20:23], v[68:71]
    v_mfma_f32_16x16x32_bf16 v[76:79], v[176:179], v[16:19], v[76:79]
    v_mfma_f32_16x16x32_bf16 v[80:83], v[176:179], v[20:23], v[80:83]
    v_mfma_f32_16x16x32_bf16 v[88:91], v[208:211], v[16:19], v[88:91]
    v_mfma_f32_16x16x32_bf16 v[92:95], v[208:211], v[20:23], v[92:95]
    v_mfma_f32_16x16x32_bf16 v[100:103], v[240:243], v[16:19], v[100:103]
    v_mfma_f32_16x16x32_bf16 v[104:107], v[240:243], v[20:23], v[104:107]
    ds_read_b128 v[16:19], v112 offset:448
    ds_read_b128 v[20:23], v112 offset:8896
    s_waitcnt lgkmcnt(4)
    v_mfma_f32_16x16x32_bf16 v[64:67], v[148:151], v[24:27], v[64:67]
    v_mfma_f32_16x16x32_bf16 v[68:71], v[148:151], v[28:31], v[68:71]
    v_mfma_f32_16x16x32_bf16 v[76:79], v[180:183], v[24:27], v[76:79]
    v_mfma_f32_16x16x32_bf16 v[80:83], v[180:183], v[28:31], v[80:83]
    v_mfma_f32_16x16x32_bf16 v[88:91], v[212:215], v[24:27], v[88:91]
    v_mfma_f32_16x16x32_bf16 v[92:95], v[212:215], v[28:31], v[92:95]
    v_mfma_f32_16x16x32_bf16 v[100:103], v[244:247], v[24:27], v[100:103]
    v_mfma_f32_16x16x32_bf16 v[104:107], v[244:247], v[28:31], v[104:107]
    s_waitcnt lgkmcnt(2)
    v_mfma_f32_16x16x32_bf16 v[64:67], v[152:155], v[8:11], v[64:67]
    v_mfma_f32_16x16x32_bf16 v[68:71], v[152:155], v[12:15], v[68:71]
    v_mfma_f32_16x16x32_bf16 v[76:79], v[184:187], v[8:11], v[76:79]
    v_mfma_f32_16x16x32_bf16 v[80:83], v[184:187], v[12:15], v[80:83]
    v_mfma_f32_16x16x32_bf16 v[88:91], v[216:219], v[8:11], v[88:91]
    v_mfma_f32_16x16x32_bf16 v[92:95], v[216:219], v[12:15], v[92:95]
    v_mfma_f32_16x16x32_bf16 v[100:103], v[248:251], v[8:11], v[100:103]
    v_mfma_f32_16x16x32_bf16 v[104:107], v[248:251], v[12:15], v[104:107]
    s_waitcnt lgkmcnt(0)
    v_mfma_f32_16x16x32_bf16 v[64:67], v[156:159], v[16:19], v[64:67]
    v_mfma_f32_16x16x32_bf16 v[68:71], v[156:159], v[20:23], v[68:71]
    v_mfma_f32_16x16x32_bf16 v[76:79], v[188:191], v[16:19], v[76:79]
    v_mfma_f32_16x16x32_bf16 v[80:83], v[188:191], v[20:23], v[80:83]
    v_mfma_f32_16x16x32_bf16 v[88:91], v[220:223], v[16:19], v[88:91]
    v_mfma_f32_16x16x32_bf16 v[92:95], v[220:223], v[20:23], v[92:95]
    v_mfma_f32_16x16x32_bf16 v[100:103], v[252:255], v[16:19], v[100:103]
    v_mfma_f32_16x16x32_bf16 v[104:107], v[252:255], v[20:23], v[104:107]
    s_nop 7
    s_nop 1
    v_cvt_pk_bf16_f32 v40, v64, v65
    v_cvt_pk_bf16_f32 v41, v66, v67
    v_cvt_pk_bf16_f32 v42, v76, v77
    v_cvt_pk_bf16_f32 v43, v78, v79
    ds_write_b128 v113, v[40:43] offset:0
    v_cvt_pk_bf16_f32 v44, v88, v89
    v_cvt_pk_bf16_f32 v45, v90, v91
    v_cvt_pk_bf16_f32 v46, v100, v101
    v_cvt_pk_bf16_f32 v47, v102, v103
    ds_write_b128 v113, v[44:47] offset:64
    v_cvt_pk_bf16_f32 v48, v68, v69
    v_cvt_pk_bf16_f32 v49, v70, v71
    v_cvt_pk_bf16_f32 v50, v80, v81
    v_cvt_pk_bf16_f32 v51, v82, v83
    ds_write_b128 v113, v[48:51] offset:8448
    v_cvt_pk_bf16_f32 v52, v92, v93
    v_cvt_pk_bf16_f32 v53, v94, v95
    v_cvt_pk_bf16_f32 v54, v104, v105
    v_cvt_pk_bf16_f32 v55, v106, v107
    ds_write_b128 v113, v[52:55] offset:8512
    s_waitcnt lgkmcnt(0)
    s_barrier
    ds_read_b128 v[8:11], v112 offset:16896
    ds_read_b128 v[12:15], v112 offset:16960
    ds_read_b128 v[16:19], v112 offset:17024
    s_waitcnt lgkmcnt(2)
    v_mfma_f32_16x16x32_bf16 v[72:75], v[128:131], v[8:11], v[72:75]
    v_mfma_f32_16x16x32_bf16 v[84:87], v[160:163], v[8:11], v[84:87]
    v_mfma_f32_16x16x32_bf16 v[96:99], v[192:195], v[8:11], v[96:99]
    v_mfma_f32_16x16x32_bf16 v[108:111], v[224:227], v[8:11], v[108:111]
    ds_read_b128 v[8:11], v112 offset:17088
    s_waitcnt lgkmcnt(2)
    v_mfma_f32_16x16x32_bf16 v[72:75], v[132:135], v[12:15], v[72:75]
    v_mfma_f32_16x16x32_bf16 v[84:87], v[164:167], v[12:15], v[84:87]
    v_mfma_f32_16x16x32_bf16 v[96:99], v[196:199], v[12:15], v[96:99]
    v_mfma_f32_16x16x32_bf16 v[108:111], v[228:231], v[12:15], v[108:111]
    ds_read_b128 v[12:15], v112 offset:17152
    s_waitcnt lgkmcnt(2)
    v_mfma_f32_16x16x32_bf16 v[72:75], v[136:139], v[16:19], v[72:75]
    v_mfma_f32_16x16x32_bf16 v[84:87], v[168:171], v[16:19], v[84:87]
    v_mfma_f32_16x16x32_bf16 v[96:99], v[200:203], v[16:19], v[96:99]
    v_mfma_f32_16x16x32_bf16 v[108:111], v[232:235], v[16:19], v[108:111]
    ds_read_b128 v[16:19], v112 offset:17216
    s_waitcnt lgkmcnt(2)
    v_mfma_f32_16x16x32_bf16 v[72:75], v[140:143], v[8:11], v[72:75]
    v_mfma_f32_16x16x32_bf16 v[84:87], v[172:175], v[8:11], v[84:87]
    v_mfma_f32_16x16x32_bf16 v[96:99], v[204:207], v[8:11], v[96:99]
    v_mfma_f32_16x16x32_bf16 v[108:111], v[236:239], v[8:11], v[108:111]
    ds_read_b128 v[8:11], v112 offset:17280
    s_waitcnt lgkmcnt(2)
    v_mfma_f32_16x16x32_bf16 v[72:75], v[144:147], v[12:15], v[72:75]
    v_mfma_f32_16x16x32_bf16 v[84:87], v[176:179], v[12:15], v[84:87]
    v_mfma_f32_16x16x32_bf16 v[96:99], v[208:211], v[12:15], v[96:99]
    v_mfma_f32_16x16x32_bf16 v[108:111], v[240:243], v[12:15], v[108:111]
    ds_read_b128 v[12:15], v112 offset:17344
    s_waitcnt lgkmcnt(2)
    v_mfma_f32_16x16x32_bf16 v[72:75], v[148:151], v[16:19], v[72:75]
    v_mfma_f32_16x16x32_bf16 v[84:87], v[180:183], v[16:19], v[84:87]
    v_mfma_f32_16x16x32_bf16 v[96:99], v[212:215], v[16:19], v[96:99]
    v_mfma_f32_16x16x32_bf16 v[108:111], v[244:247], v[16:19], v[108:111]
    s_waitcnt lgkmcnt(1)
    v_mfma_f32_16x16x32_bf16 v[72:75], v[152:155], v[8:11], v[72:75]
    v_mfma_f32_16x16x32_bf16 v[84:87], v[184:187], v[8:11], v[84:87]
    v_mfma_f32_16x16x32_bf16 v[96:99], v[216:219], v[8:11], v[96:99]
    v_mfma_f32_16x16x32_bf16 v[108:111], v[248:251], v[8:11], v[108:111]
    s_waitcnt lgkmcnt(0)
    v_mfma_f32_16x16x32_bf16 v[72:75], v[156:159], v[12:15], v[72:75]
    v_mfma_f32_16x16x32_bf16 v[84:87], v[188:191], v[12:15], v[84:87]
    v_mfma_f32_16x16x32_bf16 v[96:99], v[220:223], v[12:15], v[96:99]
    v_mfma_f32_16x16x32_bf16 v[108:111], v[252:255], v[12:15], v[108:111]
    s_nop 7
    s_nop 1
    v_cvt_pk_bf16_f32 v40, v72, v73
    v_cvt_pk_bf16_f32 v41, v74, v75
    v_cvt_pk_bf16_f32 v42, v84, v85
    v_cvt_pk_bf16_f32 v43, v86, v87
    ds_write_b128 v113, v[40:43] offset:16896
    v_cvt_pk_bf16_f32 v44, v96, v97
    v_cvt_pk_bf16_f32 v45, v98, v99
    v_cvt_pk_bf16_f32 v46, v108, v109
    v_cvt_pk_bf16_f32 v47, v110, v111
    ds_write_b128 v113, v[44:47] offset:16960
    s_waitcnt lgkmcnt(0)
    s_barrier
L_fin_end:
    s_endpgm
L_service:
    v_and_b32 v1, 63, v0
    s_lshr_b32 s52, s66, 3
    s_lshl_b32 s52, s52, 3
    s_add_u32 s23, s52, s16
    v_mov_b32 v9, 0x40000000
    s_mov_b32 s53, 4329605
    s_add_u32 s52, s23, 0
    s_lshl_b32 s52, s52, 6
    v_add_u32 v10, s52, v1
    v_mul_hi_u32 v11, v10, s53
    v_mul_u32_u24 v12, 992, v11
    v_sub_u32 v12, v10, v12
    v_lshrrev_b32 v13, 5, v12
    v_and_b32 v12, 31, v12
    v_lshl_add_u32 v12, v11, 5, v12
    v_lshlrev_b32 v12, 10, v12
    v_lshl_add_u32 v12, v13, 18, v12
    v_add_u32 v12, s72, v12
    s_movk_i32 s54, 7936
    v_cmp_gt_u32 vcc, s54, v10
    s_nop 1
    v_cndmask_b32 v20, v9, v12, vcc
    s_add_u32 s52, s23, 24
    s_lshl_b32 s52, s52, 6
    v_add_u32 v10, s52, v1
    v_mul_hi_u32 v11, v10, s53
    v_mul_u32_u24 v12, 992, v11
    v_sub_u32 v12, v10, v12
    v_lshrrev_b32 v13, 5, v12
    v_and_b32 v12, 31, v12
    v_lshl_add_u32 v12, v11, 5, v12
    v_lshlrev_b32 v12, 10, v12
    v_lshl_add_u32 v12, v13, 18, v12
    v_add_u32 v12, s72, v12
    s_movk_i32 s54, 7936
    v_cmp_gt_u32 vcc, s54, v10
    s_nop 1
    v_cndmask_b32 v21, v9, v12, vcc
    s_add_u32 s52, s23, 48
    s_lshl_b32 s52, s52, 6
    v_add_u32 v10, s52, v1
    v_mul_hi_u32 v11, v10, s53
    v_mul_u32_u24 v12, 992, v11
    v_sub_u32 v12, v10, v12
    v_lshrrev_b32 v13, 5, v12
    v_and_b32 v12, 31, v12
    v_lshl_add_u32 v12, v11, 5, v12
    v_lshlrev_b32 v12, 10, v12
    v_lshl_add_u32 v12, v13, 18, v12
    v_add_u32 v12, s72, v12
    s_movk_i32 s54, 7936
    v_cmp_gt_u32 vcc, s54, v10
    s_nop 1
    v_cndmask_b32 v22, v9, v12, vcc
    s_add_u32 s52, s23, 72
    s_lshl_b32 s52, s52, 6
    v_add_u32 v10, s52, v1
    v_mul_hi_u32 v11, v10, s53
    v_mul_u32_u24 v12, 992, v11
    v_sub_u32 v12, v10, v12
    v_lshrrev_b32 v13, 5, v12
    v_and_b32 v12, 31, v12
    v_lshl_add_u32 v12, v11, 5, v12
    v_lshlrev_b32 v12, 10, v12
    v_lshl_add_u32 v12, v13, 18, v12
    v_add_u32 v12, s72, v12
    s_movk_i32 s54, 7936
    v_cmp_gt_u32 vcc, s54, v10
    s_nop 1
    v_cndmask_b32 v23, v9, v12, vcc
    s_add_u32 s52, s23, 96
    s_lshl_b32 s52, s52, 6
    v_add_u32 v10, s52, v1
    v_mul_hi_u32 v11, v10, s53
    v_mul_u32_u24 v12, 992, v11
    v_sub_u32 v12, v10, v12
    v_lshrrev_b32 v13, 5, v12
    v_and_b32 v12, 31, v12
    v_lshl_add_u32 v12, v11, 5, v12
    v_lshlrev_b32 v12, 10, v12
    v_lshl_add_u32 v12, v13, 18, v12
    v_add_u32 v12, s72, v12
    s_movk_i32 s54, 7936
    v_cmp_gt_u32 vcc, s54, v10
    s_nop 1
    v_cndmask_b32 v24, v9, v12, vcc
    s_add_u32 s52, s23, 120
    s_lshl_b32 s52, s52, 6
    v_add_u32 v10, s52, v1
    v_mul_hi_u32 v11, v10, s53
    v_mul_u32_u24 v12, 992, v11
    v_sub_u32 v12, v10, v12
    v_lshrrev_b32 v13, 5, v12
    v_and_b32 v12, 31, v12
    v_lshl_add_u32 v12, v11, 5, v12
    v_lshlrev_b32 v12, 10, v12
    v_lshl_add_u32 v12, v13, 18, v12
    v_add_u32 v12, s72, v12
    s_movk_i32 s54, 7936
    v_cmp_gt_u32 vcc, s54, v10
    s_nop 1
    v_cndmask_b32 v25, v9, v12, vcc
    s_mov_b32 s53, 6439232
    s_add_u32 s52, s23, 0
    s_lshl_b32 s52, s52, 6
    v_add_u32 v10, s52, v1
    v_mul_hi_u32 v11, v10, s53
    v_mul_u32_u24 v12, 667, v11
    v_sub_u32 v12, v10, v12
    v_mul_u32_u24 v12, 6, v12
    v_and_b32 v13, 1, v11
    v_add_u32 v12, v12, v13
    v_lshrrev_b32 v13, 1, v11
    v_mul_u32_u24 v13, 4000, v13
    v_add_u32 v13, v13, v12
    v_lshlrev_b32 v13, 9, v13
    s_movk_i32 s54, 2668
    v_cmp_gt_u32 vcc, s54, v10
    s_nop 1
    v_cndmask_b32 v26, v9, v13, vcc
    s_movk_i32 s54, 3996
    v_cmp_gt_u32 s[56:57], s54, v12
    s_and_b64 vcc, vcc, s[56:57]
    s_nop 1
    v_cndmask_b32 v28, v9, v13, vcc
    s_add_u32 s52, s23, 24
    s_lshl_b32 s52, s52, 6
    v_add_u32 v10, s52, v1
    v_mul_hi_u32 v11, v10, s53
    v_mul_u32_u24 v12, 667, v11
    v_sub_u32 v12, v10, v12
    v_mul_u32_u24 v12, 6, v12
    v_and_b32 v13, 1, v11
    v_add_u32 v12, v12, v13
    v_lshrrev_b32 v13, 1, v11
    v_mul_u32_u24 v13, 4000, v13
    v_add_u32 v13, v13, v12
    v_lshlrev_b32 v13, 9, v13
    s_movk_i32 s54, 2668
    v_cmp_gt_u32 vcc, s54, v10
    s_nop 1
    v_cndmask_b32 v27, v9, v13, vcc
    s_movk_i32 s54, 3996
    v_cmp_gt_u32 s[56:57], s54, v12
    s_and_b64 vcc, vcc, s[56:57]
    s_nop 1
    v_cndmask_b32 v29, v9, v13, vcc
    s_waitcnt lgkmcnt(0)
    s_or_b32 s75, s64, 1
    s_mov_b32 s0, s14
    s_mov_b32 s1, s15
    s_mov_b32 s2, 25198592
    s_mov_b32 s3, 0x20000
    s_mov_b32 s24, s4
    s_mov_b32 s25, s5
    s_mov_b32 s26, 4096000
    s_mov_b32 s27, 0x20000
    s_mov_b32 s28, s6
    s_mov_b32 s29, s7
    s_mov_b32 s30, 8126464
    s_mov_b32 s31, 0x20000
    s_mov_b32 s32, s14
    s_mov_b32 s33, s15
    s_mov_b32 s34, 12779520
    s_mov_b32 s35, 0x20000
    s_mov_b32 s36, s14
    s_mov_b32 s37, s15
    s_mov_b32 s38, 1376256
    s_mov_b32 s39, 0x20000
    s_add_u32 s40, s14, 13631488
    s_addc_u32 s41, s15, 0
    s_mov_b32 s42, 8552448
    s_mov_b32 s43, 0x20000
    s_mov_b32 s44, s8
    s_mov_b32 s45, s9
    s_mov_b32 s46, 131072
    s_mov_b32 s47, 0x20000
    s_mov_b32 s48, s10
    s_mov_b32 s49, s11
    s_mov_b32 s50, 4096000
    s_mov_b32 s51, 0x20000
    s_cmp_lg_u32 s16, 0
    s_cbranch_scc1 L_w_46
    s_cmp_lg_u32 s66, 0
    s_cbranch_scc1 L_pub_47
    v_mov_b32 v100, s75
    v_mov_b32 v101, 0
    s_mov_b64 s[54:55], exec
    s_mov_b64 exec, 1
    v_mov_b32 v98, 0
    global_atomic_cmpswap v98, v[100:101], s[12:13]
    s_mov_b64 exec, s[54:55]
    s_nop 3
    s_waitcnt vmcnt(0)
L_pub_47:
    v_mov_b32 v101, 0
    global_load_dword v99, v101, s[12:13] sc1
L_w_46:
    buffer_load_dword v30, v20, s[28:31], 0 offen
    buffer_load_dword v30, v21, s[28:31], 0 offen
    buffer_load_dword v30, v22, s[28:31], 0 offen
    s_cmp_lg_u32 s16, 0
    s_cbranch_scc1 L_w_48
    s_waitcnt vmcnt(3)
    s_mov_b32 s58, 100000
    v_mov_b32 v101, 0
L_tg_49:
    v_readfirstlane_b32 s75, v99
    s_nop 3
    s_cmp_lg_u32 s75, 0
    s_cbranch_scc1 L_tgk_50
    global_load_dword v99, v101, s[12:13] sc1
    s_waitcnt vmcnt(0)
    s_sub_u32 s58, s58, 1
    s_cmp_lg_u32 s58, 0
    s_cbranch_scc1 L_tg_49
L_tgk_50:
    s_add_u32 s60, s66, 232
    s_lshl_b32 s52, s60, 2
    s_add_u32 s52, s52, 25165824
    s_mov_b64 s[54:55], exec
    s_mov_b64 exec, 1
    v_mov_b32 v92, s75
    v_mov_b32 v93, s52
    buffer_store_dword v92, v93, s[0:3], 0 offen sc1
    s_mov_b64 exec, s[54:55]
    s_nop 3
L_w_48:
    buffer_load_dword v30, v23, s[28:31], 0 offen
    buffer_load_dword v30, v24, s[28:31], 0 offen
    buffer_load_dword v30, v25, s[28:31], 0 offen
    s_movk_i32 s52, 256
    buffer_load_dword v30, v26, s[24:27], s52 offen
    buffer_load_dword v30, v27, s[24:27], s52 offen
    s_movk_i32 s52, 384
    buffer_load_dword v30, v26, s[24:27], s52 offen
    buffer_load_dword v30, v27, s[24:27], s52 offen
    v_and_b32 v11, 15, v1
    v_lshrrev_b32 v12, 4, v1
    v_lshrrev_b32 v13, 2, v11
    v_lshlrev_b32 v13, 3, v13
    v_and_b32 v14, 3, v11
    v_add_u32 v13, v13, v14
    v_lshlrev_b32 v13, 1, v13
    v_lshl_add_u32 v13, v12, 12, v13
    s_add_u32 s52, s23, 0
    s_lshr_b32 s53, s52, 3
    s_and_b32 s54, s52, 7
    s_lshl_b32 s54, s54, 14
    s_lshr_b32 s55, s53, 1
    s_lshl_b32 s55, s55, 6
    s_and_b32 s53, s53, 1
    s_lshl_b32 s53, s53, 3
    s_add_u32 s54, s54, s55
    s_add_u32 s54, s54, s53
    s_cmp_ge_u32 s52, 128
    s_cselect_b32 s54, 0x40000000, s54
    buffer_load_ushort v40, v13, s[44:47], s54 offen offset:0
    buffer_load_ushort v41, v13, s[44:47], s54 offen offset:512
    buffer_load_ushort v42, v13, s[44:47], s54 offen offset:1024
    buffer_load_ushort v43, v13, s[44:47], s54 offen offset:1536
    buffer_load_ushort v44, v13, s[44:47], s54 offen offset:2048
    buffer_load_ushort v45, v13, s[44:47], s54 offen offset:2560
    buffer_load_ushort v46, v13, s[44:47], s54 offen offset:3072
    buffer_load_ushort v47, v13, s[44:47], s54 offen offset:3584
    s_lshl_b32 s53, s52, 10
    s_lshl_b32 s54, s17, 17
    s_add_u32 s53, s53, s54
    s_add_u32 s53, s53, 23068672
    s_cmp_ge_u32 s52, 128
    s_cselect_b32 s53, 0x40000000, s53
    v_lshl_add_u32 v110, v1, 4, s53
    s_add_u32 s52, s23, 24
    s_lshr_b32 s53, s52, 3
    s_and_b32 s54, s52, 7
    s_lshl_b32 s54, s54, 14
    s_lshr_b32 s55, s53, 1
    s_lshl_b32 s55, s55, 6
    s_and_b32 s53, s53, 1
    s_lshl_b32 s53, s53, 3
    s_add_u32 s54, s54, s55
    s_add_u32 s54, s54, s53
    s_cmp_ge_u32 s52, 128
    s_cselect_b32 s54, 0x40000000, s54
    buffer_load_ushort v48, v13, s[44:47], s54 offen offset:0
    buffer_load_ushort v49, v13, s[44:47], s54 offen offset:512
    buffer_load_ushort v50, v13, s[44:47], s54 offen offset:1024
    buffer_load_ushort v51, v13, s[44:47], s54 offen offset:1536
    buffer_load_ushort v52, v13, s[44:47], s54 offen offset:2048
    buffer_load_ushort v53, v13, s[44:47], s54 offen offset:2560
    buffer_load_ushort v54, v13, s[44:47], s54 offen offset:3072
    buffer_load_ushort v55, v13, s[44:47], s54 offen offset:3584
    s_lshl_b32 s53, s52, 10
    s_lshl_b32 s54, s17, 17
    s_add_u32 s53, s53, s54
    s_add_u32 s53, s53, 23068672
    s_cmp_ge_u32 s52, 128
    s_cselect_b32 s53, 0x40000000, s53
    v_lshl_add_u32 v111, v1, 4, s53
    s_add_u32 s52, s23, 48
    s_lshr_b32 s53, s52, 3
    s_and_b32 s54, s52, 7
    s_lshl_b32 s54, s54, 14
    s_lshr_b32 s55, s53, 1
    s_lshl_b32 s55, s55, 6
    s_and_b32 s53, s53, 1
    s_lshl_b32 s53, s53, 3
    s_add_u32 s54, s54, s55
    s_add_u32 s54, s54, s53
    s_cmp_ge_u32 s52, 128
    s_cselect_b32 s54, 0x40000000, s54
    buffer_load_ushort v56, v13, s[44:47], s54 offen offset:0
    buffer_load_ushort v57, v13, s[44:47], s54 offen offset:512
    buffer_load_ushort v58, v13, s[44:47], s54 offen offset:1024
    buffer_load_ushort v59, v13, s[44:47], s54 offen offset:1536
    buffer_load_ushort v60, v13, s[44:47], s54 offen offset:2048
    buffer_load_ushort v61, v13, s[44:47], s54 offen offset:2560
    buffer_load_ushort v62, v13, s[44:47], s54 offen offset:3072
    buffer_load_ushort v63, v13, s[44:47], s54 offen offset:3584
    s_lshl_b32 s53, s52, 10
    s_lshl_b32 s54, s17, 17
    s_add_u32 s53, s53, s54
    s_add_u32 s53, s53, 23068672
    s_cmp_ge_u32 s52, 128
    s_cselect_b32 s53, 0x40000000, s53
    v_lshl_add_u32 v112, v1, 4, s53
    s_add_u32 s52, s23, 72
    s_lshr_b32 s53, s52, 3
    s_and_b32 s54, s52, 7
    s_lshl_b32 s54, s54, 14
    s_lshr_b32 s55, s53, 1
    s_lshl_b32 s55, s55, 6
    s_and_b32 s53, s53, 1
    s_lshl_b32 s53, s53, 3
    s_add_u32 s54, s54, s55
    s_add_u32 s54, s54, s53
    s_cmp_ge_u32 s52, 128
    s_cselect_b32 s54, 0x40000000, s54
    buffer_load_ushort v64, v13, s[44:47], s54 offen offset:0
    buffer_load_ushort v65, v13, s[44:47], s54 offen offset:512
    buffer_load_ushort v66, v13, s[44:47], s54 offen offset:1024
    buffer_load_ushort v67, v13, s[44:47], s54 offen offset:1536
    buffer_load_ushort v68, v13, s[44:47], s54 offen offset:2048
    buffer_load_ushort v69, v13, s[44:47], s54 offen offset:2560
    buffer_load_ushort v70, v13, s[44:47], s54 offen offset:3072
    buffer_load_ushort v71, v13, s[44:47], s54 offen offset:3584
    s_lshl_b32 s53, s52, 10
    s_lshl_b32 s54, s17, 17
    s_add_u32 s53, s53, s54
    s_add_u32 s53, s53, 23068672
    s_cmp_ge_u32 s52, 128
    s_cselect_b32 s53, 0x40000000, s53
    v_lshl_add_u32 v113, v1, 4, s53
    s_add_u32 s52, s23, 96
    s_lshr_b32 s53, s52, 3
    s_and_b32 s54, s52, 7
    s_lshl_b32 s54, s54, 14
    s_lshr_b32 s55, s53, 1
    s_lshl_b32 s55, s55, 6
    s_and_b32 s53, s53, 1
    s_lshl_b32 s53, s53, 3
    s_add_u32 s54, s54, s55
    s_add_u32 s54, s54, s53
    s_cmp_ge_u32 s52, 128
    s_cselect_b32 s54, 0x40000000, s54
    buffer_load_ushort v72, v13, s[44:47], s54 offen offset:0
    buffer_load_ushort v73, v13, s[44:47], s54 offen offset:512
    buffer_load_ushort v74, v13, s[44:47], s54 offen offset:1024
    buffer_load_ushort v75, v13, s[44:47], s54 offen offset:1536
    buffer_load_ushort v76, v13, s[44:47], s54 offen offset:2048
    buffer_load_ushort v77, v13, s[44:47], s54 offen offset:2560
    buffer_load_ushort v78, v13, s[44:47], s54 offen offset:3072
    buffer_load_ushort v79, v13, s[44:47], s54 offen offset:3584
    s_lshl_b32 s53, s52, 10
    s_lshl_b32 s54, s17, 17
    s_add_u32 s53, s53, s54
    s_add_u32 s53, s53, 23068672
    s_cmp_ge_u32 s52, 128
    s_cselect_b32 s53, 0x40000000, s53
    v_lshl_add_u32 v114, v1, 4, s53
    s_add_u32 s52, s23, 120
    s_lshr_b32 s53, s52, 3
    s_and_b32 s54, s52, 7
    s_lshl_b32 s54, s54, 14
    s_lshr_b32 s55, s53, 1
    s_lshl_b32 s55, s55, 6
    s_and_b32 s53, s53, 1
    s_lshl_b32 s53, s53, 3
    s_add_u32 s54, s54, s55
    s_add_u32 s54, s54, s53
    s_cmp_ge_u32 s52, 128
    s_cselect_b32 s54, 0x40000000, s54
    buffer_load_ushort v80, v13, s[44:47], s54 offen offset:0
    buffer_load_ushort v81, v13, s[44:47], s54 offen offset:512
    buffer_load_ushort v82, v13, s[44:47], s54 offen offset:1024
    buffer_load_ushort v83, v13, s[44:47], s54 offen offset:1536
    buffer_load_ushort v84, v13, s[44:47], s54 offen offset:2048
    buffer_load_ushort v85, v13, s[44:47], s54 offen offset:2560
    buffer_load_ushort v86, v13, s[44:47], s54 offen offset:3072
    buffer_load_ushort v87, v13, s[44:47], s54 offen offset:3584
    s_lshl_b32 s53, s52, 10
    s_lshl_b32 s54, s17, 17
    s_add_u32 s53, s53, s54
    s_add_u32 s53, s53, 23068672
    s_cmp_ge_u32 s52, 128
    s_cselect_b32 s53, 0x40000000, s53
    v_lshl_add_u32 v115, v1, 4, s53
    s_waitcnt vmcnt(0)
    v_lshl_or_b32 v40, v41, 16, v40
    v_lshl_or_b32 v41, v43, 16, v42
    v_lshl_or_b32 v42, v45, 16, v44
    v_lshl_or_b32 v43, v47, 16, v46
    s_nop 0
    buffer_store_dwordx4 v[40:43], v110, s[0:3], 0 offen sc1
    v_lshl_or_b32 v48, v49, 16, v48
    v_lshl_or_b32 v49, v51, 16, v50
    v_lshl_or_b32 v50, v53, 16, v52
    v_lshl_or_b32 v51, v55, 16, v54
    s_nop 0
    buffer_store_dwordx4 v[48:51], v111, s[0:3], 0 offen sc1
    v_lshl_or_b32 v56, v57, 16, v56
    v_lshl_or_b32 v57, v59, 16, v58
    v_lshl_or_b32 v58, v61, 16, v60
    v_lshl_or_b32 v59, v63, 16, v62
    s_nop 0
    buffer_store_dwordx4 v[56:59], v112, s[0:3], 0 offen sc1
    v_lshl_or_b32 v64, v65, 16, v64
    v_lshl_or_b32 v65, v67, 16, v66
    v_lshl_or_b32 v66, v69, 16, v68
    v_lshl_or_b32 v67, v71, 16, v70
    s_nop 0
    buffer_store_dwordx4 v[64:67], v113, s[0:3], 0 offen sc1
    v_lshl_or_b32 v72, v73, 16, v72
    v_lshl_or_b32 v73, v75, 16, v74
    v_lshl_or_b32 v74, v77, 16, v76
    v_lshl_or_b32 v75, v79, 16, v78
    s_nop 0
    buffer_store_dwordx4 v[72:75], v114, s[0:3], 0 offen sc1
    v_lshl_or_b32 v80, v81, 16, v80
    v_lshl_or_b32 v81, v83, 16, v82
    v_lshl_or_b32 v82, v85, 16, v84
    v_lshl_or_b32 v83, v87, 16, v86
    s_nop 0
    buffer_store_dwordx4 v[80:83], v115, s[0:3], 0 offen sc1
    s_waitcnt vmcnt(0)
    s_barrier
    s_mul_i32 s52, s23, 43
    v_add_u32 v10, s52, v1
    v_lshlrev_b32 v10, 7, v10
    s_lshl_b32 s53, s17, 17
    s_add_u32 s53, s53, 23068672
    v_add_u32 v10, s53, v10
    s_cmp_lg_u32 s16, 0
    s_cbranch_scc1 L_w_51
    s_add_u32 s60, s66, 232
    s_lshl_b32 s52, s60, 2
    s_add_u32 s52, s52, 25166848
    s_mov_b64 s[54:55], exec
    s_mov_b64 exec, 1
    v_mov_b32 v92, s75
    v_mov_b32 v93, s52
    buffer_store_dword v92, v93, s[0:3], 0 offen sc1
    s_mov_b64 exec, s[54:55]
    s_nop 3
L_w_51:
    s_movk_i32 s52, 2048
    buffer_load_dword v30, v28, s[24:27], s52 offen
    buffer_load_dword v30, v29, s[24:27], s52 offen
    s_movk_i32 s52, 2176
    buffer_load_dword v30, v28, s[24:27], s52 offen
    buffer_load_dword v30, v29, s[24:27], s52 offen
    buffer_load_dword v30, v10, s[0:3], 0 offen
    v_mov_b32 v32, -1
    v_mov_b32 v33, -1
    v_mov_b32 v34, -1
    v_mov_b32 v35, -1
    s_lshl_b32 s52, s66, 3
    s_add_u32 s52, s52, s16
    s_lshl_b32 s52, s52, 10
    v_lshl_add_u32 v36, v1, 4, s52
    s_mov_b32 s53, 0
    s_movk_i32 s52, 2304
    buffer_load_dword v30, v28, s[24:27], s52 offen
    buffer_load_dword v30, v29, s[24:27], s52 offen
    s_movk_i32 s52, 2432
    buffer_load_dword v30, v28, s[24:27], s52 offen
    buffer_load_dword v30, v29, s[24:27], s52 offen
    s_movk_i32 s54, 44
L_clr_52:
    buffer_store_dwordx4 v[32:35], v36, s[40:43], s53 offen sc1
    s_add_u32 s53, s53, 196608
    s_sub_u32 s54, s54, 1
    s_cmp_lg_u32 s54, 0
    s_cbranch_scc1 L_clr_52
    s_waitcnt vmcnt(0)
    s_barrier
    s_cmp_lg_u32 s16, 0
    s_cbranch_scc1 L_w_53
    s_add_u32 s60, s66, 232
    s_lshl_b32 s52, s60, 2
    s_add_u32 s52, s52, 25167872
    s_mov_b64 s[54:55], exec
    s_mov_b64 exec, 1
    v_mov_b32 v92, s75
    v_mov_b32 v93, s52
    buffer_store_dword v92, v93, s[0:3], 0 offen sc1
    s_mov_b64 exec, s[54:55]
    s_nop 3
L_w_53:
    s_waitcnt vmcnt(0)
L_end:
    s_endpgm
.section .rodata,"a"
.p2align 6
.amdhsa_kernel standalone__autoregressive_conv_wavenet__speech_kernel
  .amdhsa_next_free_vgpr 256
  .amdhsa_next_free_sgpr 102
  .amdhsa_accum_offset 256
  .amdhsa_group_segment_fixed_size 0
  .amdhsa_kernarg_size 48
  .amdhsa_user_sgpr_count 2
  .amdhsa_user_sgpr_kernarg_segment_ptr 1
  .amdhsa_system_sgpr_workgroup_id_x 1
.end_amdhsa_kernel
```
